```python
import torch

def _softmax(x, axis=-1):
    return torch.softmax(x, dim=axis)
def _gelu(x):
    return torch.nn.functional.gelu(x, approximate="tanh")
def _silu(x):
    return torch.nn.functional.silu(x)
def _sigmoid(x):
    return torch.sigmoid(x)
def _layernorm(x, axis=-1, eps=1e-5):
    m = x.mean(dim=axis, keepdim=True)
    v = x.var(dim=axis, keepdim=True, unbiased=False)
    return (x - m) / torch.sqrt(v + eps)
def _scatter_add(tgt, idx, src, axis=0):
    return tgt.clone().index_add_(axis, idx, src)
def _segment_sum(src, seg, n):
    out = torch.zeros((n,) + src.shape[1:], dtype=src.dtype)
    return out.index_add_(0, seg, src)
def _pad(x, pw):
    flat = tuple(v for pair in reversed(pw) for v in pair)
    return torch.nn.functional.pad(x, flat)

kernel_name = 'standalone__gqa_block_cached__near_ridge'

def setup_inputs():

    _w = (lambda a: (lambda t: t.to(torch.bfloat16) if t.is_floating_point() else t)(torch.as_tensor(a)))
    B, Sq, D = 8, 144, 640
    Hq, Hkv, Sk, Dh = 32, 32, 512, 192
    assert Hq % Hkv == 0, (Hq, Hkv)
    return {
        "x": _w((lambda *s: torch.randn(*s, dtype=torch.bfloat16) * 0.8)(B, Sq, D)),
        "k_cache": _w((lambda *s: torch.randn(*s, dtype=torch.bfloat16) * 0.8)(B, Hkv, Sk, Dh)),
        "v_cache": _w((lambda *s: torch.randn(*s, dtype=torch.bfloat16) * 0.05)(B, Hkv, Sk, Dh)),
        "wq": _w((lambda *s: torch.randn(*s, dtype=torch.bfloat16) * 0.8)(D, Hq * Dh) * (D ** -0.5)),
        "wo": _w((lambda *s: torch.randn(*s, dtype=torch.bfloat16) * 0.05)(Hq * Dh, D) * ((Hq * Dh) ** -0.5)),
    }

def reference(x, k_cache, v_cache, wq, wo):
    B, Sq, D = x.shape
    Hq, Dh = 32, 192
    Hkv = k_cache.shape[1]
    rep = Hq // Hkv
    q = (lambda x, *d: x.permute(*d))((x @ wq).reshape(B, Sq, Hq, Dh), 0, 2, 1, 3)
    k = (lambda x, n, axis: torch.repeat_interleave(x, n, dim=axis))(k_cache, rep, axis=1)
    v = (lambda x, n, axis: torch.repeat_interleave(x, n, dim=axis))(v_cache, rep, axis=1)
    scores = torch.einsum("bhqd,bhkd->bhqk", q, k) * (Dh ** -0.5)
    p = _softmax(scores, axis=-1)
    o = torch.einsum("bhqk,bhkd->bhqd", p, v)
    return (lambda x, *d: x.permute(*d))(o, 0, 2, 1, 3).reshape(B, Sq, Hq * Dh) @ wo
```

```asm
; @launch grid=(256,1,1) block=(256,1,1) lds=163840
.amdgcn_target "amdgcn-amd-amdhsa--gfx950"
.text
.globl standalone__gqa_block_cached__near_ridge_kernel
.p2align 8
.type standalone__gqa_block_cached__near_ridge_kernel,@function
standalone__gqa_block_cached__near_ridge_kernel:
    s_getpc_b64 s[98:99]
    s_cmp_ge_u32 s2, 256
    s_cbranch_scc1 L_end
    s_load_dwordx16 s[4:19], s[0:1], 0
    v_lshrrev_b32 v1, 6, v0
    s_and_b32 s21, s2, 7
    s_lshr_b32 s23, s2, 3
    v_readfirstlane_b32 s20, v1
    s_lshr_b32 s22, s23, 2
    s_and_b32 s23, s23, 3
    s_lshl_b32 s24, s21, 2
    s_add_u32 s24, s24, s23
    v_and_b32 v1, 63, v0
    s_mul_i32 s25, s22, 1
    s_lshr_b32 s25, s25, 1
    s_mul_i32 s26, s23, 0
    s_add_u32 s25, s25, s26
    s_sub_u32 s26, s25, 20
    s_min_u32 s25, s25, s26
    s_and_b32 s26, s25, 3
    s_lshr_b32 s25, s25, 2
    s_cmp_lg_u32 s20, 3
    s_cbranch_scc1 L_comp
    v_lshrrev_b32 v2, 3, v1
    v_and_b32 v3, 7, v1
    v_add_u32 v4, 0, v2
    v_mul_u32_u24 v5, 21846, v4
    v_lshrrev_b32 v5, 16, v5
    v_mul_u32_u24 v6, 3, v5
    v_sub_u32 v6, v4, v6
    v_lshlrev_b32 v7, 1, v5
    v_and_b32 v7, 4, v7
    v_xor_b32 v7, v7, v3
    v_lshlrev_b32 v7, 4, v7
    v_lshl_add_u32 v7, v6, 7, v7
    v_mul_u32_u24 v8, 12288, v5
    v_add_u32 v10, v7, v8
    v_and_b32 v7, 6, v5
    v_xor_b32 v7, v7, v3
    v_lshlrev_b32 v7, 4, v7
    v_lshl_add_u32 v22, v2, 7, v7
    v_add_u32 v4, 8, v2
    v_mul_u32_u24 v5, 21846, v4
    v_lshrrev_b32 v5, 16, v5
    v_mul_u32_u24 v6, 3, v5
    v_sub_u32 v6, v4, v6
    v_lshlrev_b32 v7, 1, v5
    v_and_b32 v7, 4, v7
    v_xor_b32 v7, v7, v3
    v_lshlrev_b32 v7, 4, v7
    v_lshl_add_u32 v7, v6, 7, v7
    v_mul_u32_u24 v8, 12288, v5
    v_add_u32 v11, v7, v8
    v_and_b32 v7, 6, v5
    v_xor_b32 v7, v7, v3
    v_lshlrev_b32 v7, 4, v7
    v_lshl_add_u32 v23, v2, 7, v7
    v_add_u32 v4, 16, v2
    v_mul_u32_u24 v5, 21846, v4
    v_lshrrev_b32 v5, 16, v5
    v_mul_u32_u24 v6, 3, v5
    v_sub_u32 v6, v4, v6
    v_lshlrev_b32 v7, 1, v5
    v_and_b32 v7, 4, v7
    v_xor_b32 v7, v7, v3
    v_lshlrev_b32 v7, 4, v7
    v_lshl_add_u32 v7, v6, 7, v7
    v_mul_u32_u24 v8, 12288, v5
    v_add_u32 v12, v7, v8
    v_and_b32 v7, 6, v5
    v_xor_b32 v7, v7, v3
    v_lshlrev_b32 v7, 4, v7
    v_lshl_add_u32 v24, v2, 7, v7
    v_add_u32 v13, 390144, v10
    v_add_u32 v14, 393216, v11
    v_add_u32 v15, 392192, v12
    v_add_u32 v16, 784384, v10
    v_add_u32 v17, 783360, v11
    v_add_u32 v18, 786432, v12
    v_add_u32 v19, 1178624, v10
    v_add_u32 v20, 1177600, v11
    v_add_u32 v21, 1176576, v12
    v_subrev_u32 v11, 1024, v11
    v_subrev_u32 v12, 2048, v12
    s_add_u32 s60, s25, 0
    s_sub_u32 s27, s60, 5
    s_min_u32 s60, s60, s27
    s_mul_i32 s60, s60, 1572864
    s_add_u32 s61, s25, 1
    s_sub_u32 s27, s61, 5
    s_min_u32 s61, s61, s27
    s_mul_i32 s61, s61, 1572864
    s_add_u32 s62, s25, 2
    s_sub_u32 s27, s62, 5
    s_min_u32 s62, s62, s27
    s_mul_i32 s62, s62, 1572864
    s_add_u32 s63, s25, 3
    s_sub_u32 s27, s63, 5
    s_min_u32 s63, s63, s27
    s_mul_i32 s63, s63, 1572864
    s_add_u32 s64, s25, 4
    s_sub_u32 s27, s64, 5
    s_min_u32 s64, s64, s27
    s_mul_i32 s64, s64, 1572864
    s_add_u32 s65, s26, 0
    s_and_b32 s65, s65, 3
    s_mul_i32 s65, s65, 98304
    s_add_u32 s66, s26, 1
    s_and_b32 s66, s66, 3
    s_mul_i32 s66, s66, 98304
    s_add_u32 s67, s26, 2
    s_and_b32 s67, s67, 3
    s_mul_i32 s67, s67, 98304
    s_add_u32 s96, s26, 3
    s_and_b32 s96, s96, 3
    s_mul_i32 s96, s96, 98304
    s_waitcnt lgkmcnt(0)
    s_mul_i32 s27, s24, 384
    s_sub_u32 s26, 7864320, s27
    s_add_u32 s32, s10, s27
    s_addc_u32 s33, s11, 0
    s_mov_b32 s34, s26
    s_mov_b32 s35, 0x20000
    s_add_u32 s27, s60, s65
    s_mov_b32 m0, 49152
    s_nop 0
    buffer_load_dwordx4 v10, s[32:35], s27 offen offset:0 lds
    buffer_load_dwordx4 v11, s[32:35], s27 offen offset:1024 lds
    buffer_load_dwordx4 v12, s[32:35], s27 offen offset:2048 lds
    buffer_load_dwordx4 v13, s[32:35], s27 offen offset:3072 lds
    s_mov_b32 m0, 53248
    s_nop 0
    buffer_load_dwordx4 v14, s[32:35], s27 offen offset:0 lds
    buffer_load_dwordx4 v15, s[32:35], s27 offen offset:1024 lds
    buffer_load_dwordx4 v16, s[32:35], s27 offen offset:2048 lds
    buffer_load_dwordx4 v17, s[32:35], s27 offen offset:3072 lds
    s_mov_b32 m0, 57344
    s_nop 0
    buffer_load_dwordx4 v18, s[32:35], s27 offen offset:0 lds
    buffer_load_dwordx4 v19, s[32:35], s27 offen offset:1024 lds
    buffer_load_dwordx4 v20, s[32:35], s27 offen offset:2048 lds
    buffer_load_dwordx4 v21, s[32:35], s27 offen offset:3072 lds
    s_add_u32 s27, s60, s66
    s_mov_b32 m0, 61440
    s_nop 0
    buffer_load_dwordx4 v10, s[32:35], s27 offen offset:0 lds
    buffer_load_dwordx4 v11, s[32:35], s27 offen offset:1024 lds
    buffer_load_dwordx4 v12, s[32:35], s27 offen offset:2048 lds
    buffer_load_dwordx4 v13, s[32:35], s27 offen offset:3072 lds
    s_mov_b32 m0, 65536
    s_nop 0
    buffer_load_dwordx4 v14, s[32:35], s27 offen offset:0 lds
    buffer_load_dwordx4 v15, s[32:35], s27 offen offset:1024 lds
    buffer_load_dwordx4 v16, s[32:35], s27 offen offset:2048 lds
    buffer_load_dwordx4 v17, s[32:35], s27 offen offset:3072 lds
    s_mov_b32 m0, 69632
    s_nop 0
    buffer_load_dwordx4 v18, s[32:35], s27 offen offset:0 lds
    buffer_load_dwordx4 v19, s[32:35], s27 offen offset:1024 lds
    buffer_load_dwordx4 v20, s[32:35], s27 offen offset:2048 lds
    buffer_load_dwordx4 v21, s[32:35], s27 offen offset:3072 lds
    s_lshl_b32 s25, s22, 5
    s_add_u32 s25, s25, s24
    s_mul_i32 s27, s25, 196608
    s_add_u32 s36, s6, s27
    s_addc_u32 s37, s7, 0
    s_mov_b32 s38, 196608
    s_mov_b32 s39, 0x20000
    s_add_u32 s40, s8, s27
    s_addc_u32 s41, s9, 0
    s_mov_b32 s42, 196608
    s_mov_b32 s43, 0x20000
    s_mov_b32 s48, s18
    s_mov_b32 s49, s19
    s_mov_b32 s50, 268435456
    s_mov_b32 s51, 0x20000
    s_mov_b32 s56, s16
    s_mov_b32 s57, s17
    s_mov_b32 s58, 256
    s_mov_b32 s59, 0x20000
    s_mov_b32 s44, s12
    s_mov_b32 s45, s13
    s_mov_b32 s46, 7864320
    s_mov_b32 s47, 0x20000
    s_xor_b32 s52, s24, 0
    s_mul_i32 s52, s52, 245760
    s_xor_b32 s53, s24, 2
    s_mul_i32 s53, s53, 245760
    s_xor_b32 s54, s24, 1
    s_mul_i32 s54, s54, 245760
    s_xor_b32 s55, s24, 3
    s_mul_i32 s55, s55, 245760
    s_lshr_b32 s4, s23, 1
    s_mul_i32 s4, s4, 640
    s_and_b32 s5, s23, 1
    s_lshl_b32 s5, s5, 8
    s_add_u32 s5, s5, s4
    s_add_u32 s6, s5, 128
    s_add_u32 s4, s4, 512
    s_add_u32 s27, s60, s67
    s_mov_b32 m0, 0
    s_nop 0
    buffer_load_dwordx4 v10, s[32:35], s27 offen offset:0 lds
    buffer_load_dwordx4 v11, s[32:35], s27 offen offset:1024 lds
    buffer_load_dwordx4 v12, s[32:35], s27 offen offset:2048 lds
    buffer_load_dwordx4 v13, s[32:35], s27 offen offset:3072 lds
    s_mov_b32 m0, 4096
    s_nop 0
    buffer_load_dwordx4 v14, s[32:35], s27 offen offset:0 lds
    buffer_load_dwordx4 v15, s[32:35], s27 offen offset:1024 lds
    buffer_load_dwordx4 v16, s[32:35], s27 offen offset:2048 lds
    buffer_load_dwordx4 v17, s[32:35], s27 offen offset:3072 lds
    s_mov_b32 m0, 8192
    s_nop 0
    buffer_load_dwordx4 v18, s[32:35], s27 offen offset:0 lds
    buffer_load_dwordx4 v19, s[32:35], s27 offen offset:1024 lds
    buffer_load_dwordx4 v20, s[32:35], s27 offen offset:2048 lds
    buffer_load_dwordx4 v21, s[32:35], s27 offen offset:3072 lds
    s_cmp_lg_u32 s2, 0
    s_cbranch_scc1 L_nononce
    s_memrealtime s[100:101]
    s_waitcnt lgkmcnt(0)
    s_lshl_b64 s[100:101], s[100:101], 4
    s_or_b32 s100, s100, 8
    s_or_b32 s101, s101, 0x80000000
    v_mov_b32 v4, s100
    v_mov_b32 v5, s101
    v_mov_b32 v6, 0
    buffer_store_dwordx2 v[4:5], v6, s[56:59], 0 offen sc1
L_nononce:
    s_nop 1
    v_lshrrev_b32 v4, 3, v1
    v_and_b32 v5, 6, v4
    v_and_b32 v6, 7, v1
    v_xor_b32 v5, v5, v6
    v_mul_u32_u24 v4, 1280, v4
    v_lshl_add_u32 v26, v5, 4, v4
    v_add_u32 v27, 9216, v26
    v_add_u32 v28, 18432, v26
    v_add_u32 v29, 27648, v26
    v_lshlrev_b32 v9, 4, v1
    v_lshlrev_b32 v201, 2, v1
    v_add_u32 v201, 160000, v201
    v_min_u32 v202, 2, v1
    v_lshlrev_b32 v202, 8, v202
    v_add_u32 v202, 160256, v202
    s_mov_b32 s28, 20
    s_waitcnt vmcnt(12)
    s_barrier
    s_add_u32 s27, s60, s96
    s_mov_b32 m0, 12288
    s_nop 0
    buffer_load_dwordx4 v10, s[32:35], s27 offen offset:0 lds
    buffer_load_dwordx4 v11, s[32:35], s27 offen offset:1024 lds
    buffer_load_dwordx4 v12, s[32:35], s27 offen offset:2048 lds
    buffer_load_dwordx4 v13, s[32:35], s27 offen offset:3072 lds
    s_mov_b32 m0, 16384
    s_nop 0
    buffer_load_dwordx4 v14, s[32:35], s27 offen offset:0 lds
    buffer_load_dwordx4 v15, s[32:35], s27 offen offset:1024 lds
    buffer_load_dwordx4 v16, s[32:35], s27 offen offset:2048 lds
    buffer_load_dwordx4 v17, s[32:35], s27 offen offset:3072 lds
    s_mov_b32 m0, 20480
    s_nop 0
    buffer_load_dwordx4 v18, s[32:35], s27 offen offset:0 lds
    buffer_load_dwordx4 v19, s[32:35], s27 offen offset:1024 lds
    buffer_load_dwordx4 v20, s[32:35], s27 offen offset:2048 lds
    buffer_load_dwordx4 v21, s[32:35], s27 offen offset:3072 lds
    s_add_u32 s27, s61, s65
    s_mov_b32 m0, 24576
    s_nop 0
    buffer_load_dwordx4 v10, s[32:35], s27 offen offset:0 lds
    buffer_load_dwordx4 v11, s[32:35], s27 offen offset:1024 lds
    buffer_load_dwordx4 v12, s[32:35], s27 offen offset:2048 lds
    buffer_load_dwordx4 v13, s[32:35], s27 offen offset:3072 lds
    s_mov_b32 m0, 28672
    s_nop 0
    buffer_load_dwordx4 v14, s[32:35], s27 offen offset:0 lds
    buffer_load_dwordx4 v15, s[32:35], s27 offen offset:1024 lds
    buffer_load_dwordx4 v16, s[32:35], s27 offen offset:2048 lds
    buffer_load_dwordx4 v17, s[32:35], s27 offen offset:3072 lds
    s_mov_b32 m0, 32768
    s_nop 0
    buffer_load_dwordx4 v18, s[32:35], s27 offen offset:0 lds
    buffer_load_dwordx4 v19, s[32:35], s27 offen offset:1024 lds
    buffer_load_dwordx4 v20, s[32:35], s27 offen offset:2048 lds
    buffer_load_dwordx4 v21, s[32:35], s27 offen offset:3072 lds
    s_waitcnt vmcnt(24)
    s_barrier
    s_add_u32 s27, s61, s66
    s_mov_b32 m0, 36864
    s_nop 0
    buffer_load_dwordx4 v10, s[32:35], s27 offen offset:0 lds
    buffer_load_dwordx4 v11, s[32:35], s27 offen offset:1024 lds
    buffer_load_dwordx4 v12, s[32:35], s27 offen offset:2048 lds
    buffer_load_dwordx4 v13, s[32:35], s27 offen offset:3072 lds
    s_mov_b32 m0, 40960
    s_nop 0
    buffer_load_dwordx4 v14, s[32:35], s27 offen offset:0 lds
    buffer_load_dwordx4 v15, s[32:35], s27 offen offset:1024 lds
    buffer_load_dwordx4 v16, s[32:35], s27 offen offset:2048 lds
    buffer_load_dwordx4 v17, s[32:35], s27 offen offset:3072 lds
    s_mov_b32 m0, 45056
    s_nop 0
    buffer_load_dwordx4 v18, s[32:35], s27 offen offset:0 lds
    buffer_load_dwordx4 v19, s[32:35], s27 offen offset:1024 lds
    buffer_load_dwordx4 v20, s[32:35], s27 offen offset:2048 lds
    buffer_load_dwordx4 v21, s[32:35], s27 offen offset:3072 lds
    s_waitcnt vmcnt(24)
    s_barrier
    s_add_u32 s27, s61, s67
    s_mov_b32 m0, 49152
    s_nop 0
    buffer_load_dwordx4 v10, s[32:35], s27 offen offset:0 lds
    buffer_load_dwordx4 v11, s[32:35], s27 offen offset:1024 lds
    buffer_load_dwordx4 v12, s[32:35], s27 offen offset:2048 lds
    buffer_load_dwordx4 v13, s[32:35], s27 offen offset:3072 lds
    s_mov_b32 m0, 53248
    s_nop 0
    buffer_load_dwordx4 v14, s[32:35], s27 offen offset:0 lds
    buffer_load_dwordx4 v15, s[32:35], s27 offen offset:1024 lds
    buffer_load_dwordx4 v16, s[32:35], s27 offen offset:2048 lds
    buffer_load_dwordx4 v17, s[32:35], s27 offen offset:3072 lds
    s_mov_b32 m0, 57344
    s_nop 0
    buffer_load_dwordx4 v18, s[32:35], s27 offen offset:0 lds
    buffer_load_dwordx4 v19, s[32:35], s27 offen offset:1024 lds
    buffer_load_dwordx4 v20, s[32:35], s27 offen offset:2048 lds
    buffer_load_dwordx4 v21, s[32:35], s27 offen offset:3072 lds
    s_mov_b32 m0, 73728
    s_mov_b32 s27, 0
    buffer_load_dwordx4 v22, s[36:39], s27 offen offset:0 nt lds
    buffer_load_dwordx4 v23, s[36:39], s27 offen offset:1024 nt lds
    buffer_load_dwordx4 v24, s[36:39], s27 offen offset:2048 nt lds
    buffer_load_dwordx4 v22, s[36:39], s27 offen offset:3072 nt lds
    s_mov_b32 m0, 77824
    s_mov_b32 s27, 4096
    buffer_load_dwordx4 v23, s[36:39], s27 offen offset:0 nt lds
    buffer_load_dwordx4 v24, s[36:39], s27 offen offset:1024 nt lds
    buffer_load_dwordx4 v22, s[36:39], s27 offen offset:2048 nt lds
    buffer_load_dwordx4 v23, s[36:39], s27 offen offset:3072 nt lds
    s_mov_b32 m0, 81920
    s_mov_b32 s27, 8192
    buffer_load_dwordx4 v24, s[36:39], s27 offen offset:0 nt lds
    buffer_load_dwordx4 v22, s[36:39], s27 offen offset:1024 nt lds
    buffer_load_dwordx4 v23, s[36:39], s27 offen offset:2048 nt lds
    buffer_load_dwordx4 v24, s[36:39], s27 offen offset:3072 nt lds
    s_waitcnt vmcnt(36)
    s_barrier
    s_add_u32 s27, s61, s96
    s_mov_b32 m0, 61440
    s_nop 0
    buffer_load_dwordx4 v10, s[32:35], s27 offen offset:0 lds
    buffer_load_dwordx4 v11, s[32:35], s27 offen offset:1024 lds
    buffer_load_dwordx4 v12, s[32:35], s27 offen offset:2048 lds
    buffer_load_dwordx4 v13, s[32:35], s27 offen offset:3072 lds
    s_mov_b32 m0, 65536
    s_nop 0
    buffer_load_dwordx4 v14, s[32:35], s27 offen offset:0 lds
    buffer_load_dwordx4 v15, s[32:35], s27 offen offset:1024 lds
    buffer_load_dwordx4 v16, s[32:35], s27 offen offset:2048 lds
    buffer_load_dwordx4 v17, s[32:35], s27 offen offset:3072 lds
    s_mov_b32 m0, 69632
    s_nop 0
    buffer_load_dwordx4 v18, s[32:35], s27 offen offset:0 lds
    buffer_load_dwordx4 v19, s[32:35], s27 offen offset:1024 lds
    buffer_load_dwordx4 v20, s[32:35], s27 offen offset:2048 lds
    buffer_load_dwordx4 v21, s[32:35], s27 offen offset:3072 lds
    s_waitcnt vmcnt(36)
    s_barrier
    s_add_u32 s27, s62, s65
    s_mov_b32 m0, 0
    s_nop 0
    buffer_load_dwordx4 v10, s[32:35], s27 offen offset:0 lds
    buffer_load_dwordx4 v11, s[32:35], s27 offen offset:1024 lds
    buffer_load_dwordx4 v12, s[32:35], s27 offen offset:2048 lds
    buffer_load_dwordx4 v13, s[32:35], s27 offen offset:3072 lds
    s_mov_b32 m0, 4096
    s_nop 0
    buffer_load_dwordx4 v14, s[32:35], s27 offen offset:0 lds
    buffer_load_dwordx4 v15, s[32:35], s27 offen offset:1024 lds
    buffer_load_dwordx4 v16, s[32:35], s27 offen offset:2048 lds
    buffer_load_dwordx4 v17, s[32:35], s27 offen offset:3072 lds
    s_mov_b32 m0, 8192
    s_nop 0
    buffer_load_dwordx4 v18, s[32:35], s27 offen offset:0 lds
    buffer_load_dwordx4 v19, s[32:35], s27 offen offset:1024 lds
    buffer_load_dwordx4 v20, s[32:35], s27 offen offset:2048 lds
    buffer_load_dwordx4 v21, s[32:35], s27 offen offset:3072 lds
    s_mov_b32 m0, 86016
    s_mov_b32 s27, 12288
    buffer_load_dwordx4 v22, s[36:39], s27 offen offset:0 nt lds
    buffer_load_dwordx4 v23, s[36:39], s27 offen offset:1024 nt lds
    buffer_load_dwordx4 v24, s[36:39], s27 offen offset:2048 nt lds
    buffer_load_dwordx4 v22, s[36:39], s27 offen offset:3072 nt lds
    s_mov_b32 m0, 90112
    s_mov_b32 s27, 16384
    buffer_load_dwordx4 v23, s[36:39], s27 offen offset:0 nt lds
    buffer_load_dwordx4 v24, s[36:39], s27 offen offset:1024 nt lds
    buffer_load_dwordx4 v22, s[36:39], s27 offen offset:2048 nt lds
    buffer_load_dwordx4 v23, s[36:39], s27 offen offset:3072 nt lds
    s_mov_b32 m0, 94208
    s_mov_b32 s27, 20480
    buffer_load_dwordx4 v24, s[36:39], s27 offen offset:0 nt lds
    buffer_load_dwordx4 v22, s[36:39], s27 offen offset:1024 nt lds
    buffer_load_dwordx4 v23, s[36:39], s27 offen offset:2048 nt lds
    buffer_load_dwordx4 v24, s[36:39], s27 offen offset:3072 nt lds
    s_waitcnt vmcnt(48)
    s_barrier
    s_add_u32 s27, s62, s66
    s_mov_b32 m0, 12288
    s_nop 0
    buffer_load_dwordx4 v10, s[32:35], s27 offen offset:0 lds
    buffer_load_dwordx4 v11, s[32:35], s27 offen offset:1024 lds
    buffer_load_dwordx4 v12, s[32:35], s27 offen offset:2048 lds
    buffer_load_dwordx4 v13, s[32:35], s27 offen offset:3072 lds
    s_mov_b32 m0, 16384
    s_nop 0
    buffer_load_dwordx4 v14, s[32:35], s27 offen offset:0 lds
    buffer_load_dwordx4 v15, s[32:35], s27 offen offset:1024 lds
    buffer_load_dwordx4 v16, s[32:35], s27 offen offset:2048 lds
    buffer_load_dwordx4 v17, s[32:35], s27 offen offset:3072 lds
    s_mov_b32 m0, 20480
    s_nop 0
    buffer_load_dwordx4 v18, s[32:35], s27 offen offset:0 lds
    buffer_load_dwordx4 v19, s[32:35], s27 offen offset:1024 lds
    buffer_load_dwordx4 v20, s[32:35], s27 offen offset:2048 lds
    buffer_load_dwordx4 v21, s[32:35], s27 offen offset:3072 lds
    s_waitcnt vmcnt(36)
    s_barrier
    s_add_u32 s27, s62, s67
    s_mov_b32 m0, 24576
    s_nop 0
    buffer_load_dwordx4 v10, s[32:35], s27 offen offset:0 lds
    buffer_load_dwordx4 v11, s[32:35], s27 offen offset:1024 lds
    buffer_load_dwordx4 v12, s[32:35], s27 offen offset:2048 lds
    buffer_load_dwordx4 v13, s[32:35], s27 offen offset:3072 lds
    s_mov_b32 m0, 28672
    s_nop 0
    buffer_load_dwordx4 v14, s[32:35], s27 offen offset:0 lds
    buffer_load_dwordx4 v15, s[32:35], s27 offen offset:1024 lds
    buffer_load_dwordx4 v16, s[32:35], s27 offen offset:2048 lds
    buffer_load_dwordx4 v17, s[32:35], s27 offen offset:3072 lds
    s_mov_b32 m0, 32768
    s_nop 0
    buffer_load_dwordx4 v18, s[32:35], s27 offen offset:0 lds
    buffer_load_dwordx4 v19, s[32:35], s27 offen offset:1024 lds
    buffer_load_dwordx4 v20, s[32:35], s27 offen offset:2048 lds
    buffer_load_dwordx4 v21, s[32:35], s27 offen offset:3072 lds
    s_mov_b32 m0, 98304
    s_mov_b32 s27, 24576
    buffer_load_dwordx4 v22, s[36:39], s27 offen offset:0 nt lds
    buffer_load_dwordx4 v23, s[36:39], s27 offen offset:1024 nt lds
    buffer_load_dwordx4 v24, s[36:39], s27 offen offset:2048 nt lds
    buffer_load_dwordx4 v22, s[36:39], s27 offen offset:3072 nt lds
    s_mov_b32 m0, 102400
    s_mov_b32 s27, 28672
    buffer_load_dwordx4 v23, s[36:39], s27 offen offset:0 nt lds
    buffer_load_dwordx4 v24, s[36:39], s27 offen offset:1024 nt lds
    buffer_load_dwordx4 v22, s[36:39], s27 offen offset:2048 nt lds
    buffer_load_dwordx4 v23, s[36:39], s27 offen offset:3072 nt lds
    s_mov_b32 m0, 106496
    s_mov_b32 s27, 32768
    buffer_load_dwordx4 v24, s[36:39], s27 offen offset:0 nt lds
    buffer_load_dwordx4 v22, s[36:39], s27 offen offset:1024 nt lds
    buffer_load_dwordx4 v23, s[36:39], s27 offen offset:2048 nt lds
    buffer_load_dwordx4 v24, s[36:39], s27 offen offset:3072 nt lds
    s_waitcnt vmcnt(48)
    s_barrier
    s_add_u32 s27, s62, s96
    s_mov_b32 m0, 36864
    s_nop 0
    buffer_load_dwordx4 v10, s[32:35], s27 offen offset:0 lds
    buffer_load_dwordx4 v11, s[32:35], s27 offen offset:1024 lds
    buffer_load_dwordx4 v12, s[32:35], s27 offen offset:2048 lds
    buffer_load_dwordx4 v13, s[32:35], s27 offen offset:3072 lds
    s_mov_b32 m0, 40960
    s_nop 0
    buffer_load_dwordx4 v14, s[32:35], s27 offen offset:0 lds
    buffer_load_dwordx4 v15, s[32:35], s27 offen offset:1024 lds
    buffer_load_dwordx4 v16, s[32:35], s27 offen offset:2048 lds
    buffer_load_dwordx4 v17, s[32:35], s27 offen offset:3072 lds
    s_mov_b32 m0, 45056
    s_nop 0
    buffer_load_dwordx4 v18, s[32:35], s27 offen offset:0 lds
    buffer_load_dwordx4 v19, s[32:35], s27 offen offset:1024 lds
    buffer_load_dwordx4 v20, s[32:35], s27 offen offset:2048 lds
    buffer_load_dwordx4 v21, s[32:35], s27 offen offset:3072 lds
    s_waitcnt vmcnt(36)
    s_barrier
    s_add_u32 s27, s63, s65
    s_mov_b32 m0, 49152
    s_nop 0
    buffer_load_dwordx4 v10, s[32:35], s27 offen offset:0 lds
    buffer_load_dwordx4 v11, s[32:35], s27 offen offset:1024 lds
    buffer_load_dwordx4 v12, s[32:35], s27 offen offset:2048 lds
    buffer_load_dwordx4 v13, s[32:35], s27 offen offset:3072 lds
    s_mov_b32 m0, 53248
    s_nop 0
    buffer_load_dwordx4 v14, s[32:35], s27 offen offset:0 lds
    buffer_load_dwordx4 v15, s[32:35], s27 offen offset:1024 lds
    buffer_load_dwordx4 v16, s[32:35], s27 offen offset:2048 lds
    buffer_load_dwordx4 v17, s[32:35], s27 offen offset:3072 lds
    s_mov_b32 m0, 57344
    s_nop 0
    buffer_load_dwordx4 v18, s[32:35], s27 offen offset:0 lds
    buffer_load_dwordx4 v19, s[32:35], s27 offen offset:1024 lds
    buffer_load_dwordx4 v20, s[32:35], s27 offen offset:2048 lds
    buffer_load_dwordx4 v21, s[32:35], s27 offen offset:3072 lds
    s_mov_b32 m0, 110592
    s_mov_b32 s27, 36864
    buffer_load_dwordx4 v22, s[36:39], s27 offen offset:0 nt lds
    buffer_load_dwordx4 v23, s[36:39], s27 offen offset:1024 nt lds
    buffer_load_dwordx4 v24, s[36:39], s27 offen offset:2048 nt lds
    buffer_load_dwordx4 v22, s[36:39], s27 offen offset:3072 nt lds
    s_mov_b32 m0, 114688
    s_mov_b32 s27, 40960
    buffer_load_dwordx4 v23, s[36:39], s27 offen offset:0 nt lds
    buffer_load_dwordx4 v24, s[36:39], s27 offen offset:1024 nt lds
    buffer_load_dwordx4 v22, s[36:39], s27 offen offset:2048 nt lds
    buffer_load_dwordx4 v23, s[36:39], s27 offen offset:3072 nt lds
    s_mov_b32 m0, 118784
    s_mov_b32 s27, 45056
    buffer_load_dwordx4 v24, s[36:39], s27 offen offset:0 nt lds
    buffer_load_dwordx4 v22, s[36:39], s27 offen offset:1024 nt lds
    buffer_load_dwordx4 v23, s[36:39], s27 offen offset:2048 nt lds
    buffer_load_dwordx4 v24, s[36:39], s27 offen offset:3072 nt lds
    s_waitcnt vmcnt(48)
    s_barrier
    s_add_u32 s27, s63, s66
    s_mov_b32 m0, 61440
    s_nop 0
    buffer_load_dwordx4 v10, s[32:35], s27 offen offset:0 lds
    buffer_load_dwordx4 v11, s[32:35], s27 offen offset:1024 lds
    buffer_load_dwordx4 v12, s[32:35], s27 offen offset:2048 lds
    buffer_load_dwordx4 v13, s[32:35], s27 offen offset:3072 lds
    s_mov_b32 m0, 65536
    s_nop 0
    buffer_load_dwordx4 v14, s[32:35], s27 offen offset:0 lds
    buffer_load_dwordx4 v15, s[32:35], s27 offen offset:1024 lds
    buffer_load_dwordx4 v16, s[32:35], s27 offen offset:2048 lds
    buffer_load_dwordx4 v17, s[32:35], s27 offen offset:3072 lds
    s_mov_b32 m0, 69632
    s_nop 0
    buffer_load_dwordx4 v18, s[32:35], s27 offen offset:0 lds
    buffer_load_dwordx4 v19, s[32:35], s27 offen offset:1024 lds
    buffer_load_dwordx4 v20, s[32:35], s27 offen offset:2048 lds
    buffer_load_dwordx4 v21, s[32:35], s27 offen offset:3072 lds
    s_waitcnt vmcnt(36)
    s_barrier
    s_add_u32 s27, s63, s67
    s_mov_b32 m0, 0
    s_nop 0
    buffer_load_dwordx4 v10, s[32:35], s27 offen offset:0 lds
    buffer_load_dwordx4 v11, s[32:35], s27 offen offset:1024 lds
    buffer_load_dwordx4 v12, s[32:35], s27 offen offset:2048 lds
    buffer_load_dwordx4 v13, s[32:35], s27 offen offset:3072 lds
    s_mov_b32 m0, 4096
    s_nop 0
    buffer_load_dwordx4 v14, s[32:35], s27 offen offset:0 lds
    buffer_load_dwordx4 v15, s[32:35], s27 offen offset:1024 lds
    buffer_load_dwordx4 v16, s[32:35], s27 offen offset:2048 lds
    buffer_load_dwordx4 v17, s[32:35], s27 offen offset:3072 lds
    s_mov_b32 m0, 8192
    s_nop 0
    buffer_load_dwordx4 v18, s[32:35], s27 offen offset:0 lds
    buffer_load_dwordx4 v19, s[32:35], s27 offen offset:1024 lds
    buffer_load_dwordx4 v20, s[32:35], s27 offen offset:2048 lds
    buffer_load_dwordx4 v21, s[32:35], s27 offen offset:3072 lds
    s_mov_b32 m0, 122880
    s_mov_b32 s27, 0
    buffer_load_dwordx4 v22, s[40:43], s27 offen offset:0 nt lds
    buffer_load_dwordx4 v23, s[40:43], s27 offen offset:1024 nt lds
    buffer_load_dwordx4 v24, s[40:43], s27 offen offset:2048 nt lds
    buffer_load_dwordx4 v22, s[40:43], s27 offen offset:3072 nt lds
    s_mov_b32 m0, 126976
    s_mov_b32 s27, 4096
    buffer_load_dwordx4 v23, s[40:43], s27 offen offset:0 nt lds
    buffer_load_dwordx4 v24, s[40:43], s27 offen offset:1024 nt lds
    buffer_load_dwordx4 v22, s[40:43], s27 offen offset:2048 nt lds
    buffer_load_dwordx4 v23, s[40:43], s27 offen offset:3072 nt lds
    s_mov_b32 m0, 131072
    s_mov_b32 s27, 8192
    buffer_load_dwordx4 v24, s[40:43], s27 offen offset:0 nt lds
    buffer_load_dwordx4 v22, s[40:43], s27 offen offset:1024 nt lds
    buffer_load_dwordx4 v23, s[40:43], s27 offen offset:2048 nt lds
    buffer_load_dwordx4 v24, s[40:43], s27 offen offset:3072 nt lds
    s_waitcnt vmcnt(48)
    s_barrier
    s_add_u32 s27, s63, s96
    s_mov_b32 m0, 12288
    s_nop 0
    buffer_load_dwordx4 v10, s[32:35], s27 offen offset:0 lds
    buffer_load_dwordx4 v11, s[32:35], s27 offen offset:1024 lds
    buffer_load_dwordx4 v12, s[32:35], s27 offen offset:2048 lds
    buffer_load_dwordx4 v13, s[32:35], s27 offen offset:3072 lds
    s_mov_b32 m0, 16384
    s_nop 0
    buffer_load_dwordx4 v14, s[32:35], s27 offen offset:0 lds
    buffer_load_dwordx4 v15, s[32:35], s27 offen offset:1024 lds
    buffer_load_dwordx4 v16, s[32:35], s27 offen offset:2048 lds
    buffer_load_dwordx4 v17, s[32:35], s27 offen offset:3072 lds
    s_mov_b32 m0, 20480
    s_nop 0
    buffer_load_dwordx4 v18, s[32:35], s27 offen offset:0 lds
    buffer_load_dwordx4 v19, s[32:35], s27 offen offset:1024 lds
    buffer_load_dwordx4 v20, s[32:35], s27 offen offset:2048 lds
    buffer_load_dwordx4 v21, s[32:35], s27 offen offset:3072 lds
    s_waitcnt vmcnt(36)
    s_barrier
    s_add_u32 s27, s64, s65
    s_mov_b32 m0, 24576
    s_nop 0
    buffer_load_dwordx4 v10, s[32:35], s27 offen offset:0 lds
    buffer_load_dwordx4 v11, s[32:35], s27 offen offset:1024 lds
    buffer_load_dwordx4 v12, s[32:35], s27 offen offset:2048 lds
    buffer_load_dwordx4 v13, s[32:35], s27 offen offset:3072 lds
    s_mov_b32 m0, 28672
    s_nop 0
    buffer_load_dwordx4 v14, s[32:35], s27 offen offset:0 lds
    buffer_load_dwordx4 v15, s[32:35], s27 offen offset:1024 lds
    buffer_load_dwordx4 v16, s[32:35], s27 offen offset:2048 lds
    buffer_load_dwordx4 v17, s[32:35], s27 offen offset:3072 lds
    s_mov_b32 m0, 32768
    s_nop 0
    buffer_load_dwordx4 v18, s[32:35], s27 offen offset:0 lds
    buffer_load_dwordx4 v19, s[32:35], s27 offen offset:1024 lds
    buffer_load_dwordx4 v20, s[32:35], s27 offen offset:2048 lds
    buffer_load_dwordx4 v21, s[32:35], s27 offen offset:3072 lds
    s_mov_b32 m0, 135168
    s_mov_b32 s27, 12288
    buffer_load_dwordx4 v22, s[40:43], s27 offen offset:0 nt lds
    buffer_load_dwordx4 v23, s[40:43], s27 offen offset:1024 nt lds
    buffer_load_dwordx4 v24, s[40:43], s27 offen offset:2048 nt lds
    buffer_load_dwordx4 v22, s[40:43], s27 offen offset:3072 nt lds
    s_mov_b32 m0, 139264
    s_mov_b32 s27, 16384
    buffer_load_dwordx4 v23, s[40:43], s27 offen offset:0 nt lds
    buffer_load_dwordx4 v24, s[40:43], s27 offen offset:1024 nt lds
    buffer_load_dwordx4 v22, s[40:43], s27 offen offset:2048 nt lds
    buffer_load_dwordx4 v23, s[40:43], s27 offen offset:3072 nt lds
    s_mov_b32 m0, 143360
    s_mov_b32 s27, 20480
    buffer_load_dwordx4 v24, s[40:43], s27 offen offset:0 nt lds
    buffer_load_dwordx4 v22, s[40:43], s27 offen offset:1024 nt lds
    buffer_load_dwordx4 v23, s[40:43], s27 offen offset:2048 nt lds
    buffer_load_dwordx4 v24, s[40:43], s27 offen offset:3072 nt lds
    s_waitcnt vmcnt(48)
    s_barrier
    s_add_u32 s27, s64, s66
    s_mov_b32 m0, 36864
    s_nop 0
    buffer_load_dwordx4 v10, s[32:35], s27 offen offset:0 lds
    buffer_load_dwordx4 v11, s[32:35], s27 offen offset:1024 lds
    buffer_load_dwordx4 v12, s[32:35], s27 offen offset:2048 lds
    buffer_load_dwordx4 v13, s[32:35], s27 offen offset:3072 lds
    s_mov_b32 m0, 40960
    s_nop 0
    buffer_load_dwordx4 v14, s[32:35], s27 offen offset:0 lds
    buffer_load_dwordx4 v15, s[32:35], s27 offen offset:1024 lds
    buffer_load_dwordx4 v16, s[32:35], s27 offen offset:2048 lds
    buffer_load_dwordx4 v17, s[32:35], s27 offen offset:3072 lds
    s_mov_b32 m0, 45056
    s_nop 0
    buffer_load_dwordx4 v18, s[32:35], s27 offen offset:0 lds
    buffer_load_dwordx4 v19, s[32:35], s27 offen offset:1024 lds
    buffer_load_dwordx4 v20, s[32:35], s27 offen offset:2048 lds
    buffer_load_dwordx4 v21, s[32:35], s27 offen offset:3072 lds
    s_waitcnt vmcnt(36)
    s_barrier
    s_add_u32 s27, s64, s67
    s_mov_b32 m0, 49152
    s_nop 0
    buffer_load_dwordx4 v10, s[32:35], s27 offen offset:0 lds
    buffer_load_dwordx4 v11, s[32:35], s27 offen offset:1024 lds
    buffer_load_dwordx4 v12, s[32:35], s27 offen offset:2048 lds
    buffer_load_dwordx4 v13, s[32:35], s27 offen offset:3072 lds
    s_mov_b32 m0, 53248
    s_nop 0
    buffer_load_dwordx4 v14, s[32:35], s27 offen offset:0 lds
    buffer_load_dwordx4 v15, s[32:35], s27 offen offset:1024 lds
    buffer_load_dwordx4 v16, s[32:35], s27 offen offset:2048 lds
    buffer_load_dwordx4 v17, s[32:35], s27 offen offset:3072 lds
    s_mov_b32 m0, 57344
    s_nop 0
    buffer_load_dwordx4 v18, s[32:35], s27 offen offset:0 lds
    buffer_load_dwordx4 v19, s[32:35], s27 offen offset:1024 lds
    buffer_load_dwordx4 v20, s[32:35], s27 offen offset:2048 lds
    buffer_load_dwordx4 v21, s[32:35], s27 offen offset:3072 lds
    s_mov_b32 m0, 147456
    s_mov_b32 s27, 49152
    buffer_load_dwordx4 v22, s[36:39], s27 offen offset:0 nt lds
    buffer_load_dwordx4 v23, s[36:39], s27 offen offset:1024 nt lds
    buffer_load_dwordx4 v24, s[36:39], s27 offen offset:2048 nt lds
    buffer_load_dwordx4 v22, s[36:39], s27 offen offset:3072 nt lds
    s_mov_b32 m0, 151552
    s_mov_b32 s27, 53248
    buffer_load_dwordx4 v23, s[36:39], s27 offen offset:0 nt lds
    buffer_load_dwordx4 v24, s[36:39], s27 offen offset:1024 nt lds
    buffer_load_dwordx4 v22, s[36:39], s27 offen offset:2048 nt lds
    buffer_load_dwordx4 v23, s[36:39], s27 offen offset:3072 nt lds
    s_mov_b32 m0, 155648
    s_mov_b32 s27, 57344
    buffer_load_dwordx4 v24, s[36:39], s27 offen offset:0 nt lds
    buffer_load_dwordx4 v22, s[36:39], s27 offen offset:1024 nt lds
    buffer_load_dwordx4 v23, s[36:39], s27 offen offset:2048 nt lds
    buffer_load_dwordx4 v24, s[36:39], s27 offen offset:3072 nt lds
    s_waitcnt vmcnt(48)
    s_barrier
    s_add_u32 s27, s64, s96
    s_mov_b32 m0, 61440
    s_nop 0
    buffer_load_dwordx4 v10, s[32:35], s27 offen offset:0 lds
    buffer_load_dwordx4 v11, s[32:35], s27 offen offset:1024 lds
    buffer_load_dwordx4 v12, s[32:35], s27 offen offset:2048 lds
    buffer_load_dwordx4 v13, s[32:35], s27 offen offset:3072 lds
    s_mov_b32 m0, 65536
    s_nop 0
    buffer_load_dwordx4 v14, s[32:35], s27 offen offset:0 lds
    buffer_load_dwordx4 v15, s[32:35], s27 offen offset:1024 lds
    buffer_load_dwordx4 v16, s[32:35], s27 offen offset:2048 lds
    buffer_load_dwordx4 v17, s[32:35], s27 offen offset:3072 lds
    s_mov_b32 m0, 69632
    s_nop 0
    buffer_load_dwordx4 v18, s[32:35], s27 offen offset:0 lds
    buffer_load_dwordx4 v19, s[32:35], s27 offen offset:1024 lds
    buffer_load_dwordx4 v20, s[32:35], s27 offen offset:2048 lds
    buffer_load_dwordx4 v21, s[32:35], s27 offen offset:3072 lds
    s_waitcnt vmcnt(36)
    s_barrier
    s_mov_b32 m0, 0
    s_mov_b32 s27, 61440
    buffer_load_dwordx4 v22, s[36:39], s27 offen offset:0 nt lds
    buffer_load_dwordx4 v23, s[36:39], s27 offen offset:1024 nt lds
    buffer_load_dwordx4 v24, s[36:39], s27 offen offset:2048 nt lds
    buffer_load_dwordx4 v22, s[36:39], s27 offen offset:3072 nt lds
    s_mov_b32 m0, 4096
    s_mov_b32 s27, 65536
    buffer_load_dwordx4 v23, s[36:39], s27 offen offset:0 nt lds
    buffer_load_dwordx4 v24, s[36:39], s27 offen offset:1024 nt lds
    buffer_load_dwordx4 v22, s[36:39], s27 offen offset:2048 nt lds
    buffer_load_dwordx4 v23, s[36:39], s27 offen offset:3072 nt lds
    s_mov_b32 m0, 8192
    s_mov_b32 s27, 69632
    buffer_load_dwordx4 v24, s[36:39], s27 offen offset:0 nt lds
    buffer_load_dwordx4 v22, s[36:39], s27 offen offset:1024 nt lds
    buffer_load_dwordx4 v23, s[36:39], s27 offen offset:2048 nt lds
    buffer_load_dwordx4 v24, s[36:39], s27 offen offset:3072 nt lds
    s_waitcnt vmcnt(36)
    s_barrier
    s_waitcnt vmcnt(12)
    s_barrier
    s_mov_b32 m0, 12288
    s_mov_b32 s27, 24576
    buffer_load_dwordx4 v22, s[40:43], s27 offen offset:0 nt lds
    buffer_load_dwordx4 v23, s[40:43], s27 offen offset:1024 nt lds
    buffer_load_dwordx4 v24, s[40:43], s27 offen offset:2048 nt lds
    buffer_load_dwordx4 v22, s[40:43], s27 offen offset:3072 nt lds
    s_mov_b32 m0, 16384
    s_mov_b32 s27, 28672
    buffer_load_dwordx4 v23, s[40:43], s27 offen offset:0 nt lds
    buffer_load_dwordx4 v24, s[40:43], s27 offen offset:1024 nt lds
    buffer_load_dwordx4 v22, s[40:43], s27 offen offset:2048 nt lds
    buffer_load_dwordx4 v23, s[40:43], s27 offen offset:3072 nt lds
    s_mov_b32 m0, 20480
    s_mov_b32 s27, 32768
    buffer_load_dwordx4 v24, s[40:43], s27 offen offset:0 nt lds
    buffer_load_dwordx4 v22, s[40:43], s27 offen offset:1024 nt lds
    buffer_load_dwordx4 v23, s[40:43], s27 offen offset:2048 nt lds
    buffer_load_dwordx4 v24, s[40:43], s27 offen offset:3072 nt lds
    s_waitcnt vmcnt(24)
    s_barrier
    s_waitcnt vmcnt(24)
    v_mov_b32 v200, 27
    ds_write_b32 v201, v200
    s_waitcnt lgkmcnt(0)
    s_barrier
    s_mov_b32 m0, 24576
    s_mov_b32 s27, 36864
    buffer_load_dwordx4 v22, s[40:43], s27 offen offset:0 nt lds
    buffer_load_dwordx4 v23, s[40:43], s27 offen offset:1024 nt lds
    buffer_load_dwordx4 v24, s[40:43], s27 offen offset:2048 nt lds
    buffer_load_dwordx4 v22, s[40:43], s27 offen offset:3072 nt lds
    s_mov_b32 m0, 28672
    s_mov_b32 s27, 40960
    buffer_load_dwordx4 v23, s[40:43], s27 offen offset:0 nt lds
    buffer_load_dwordx4 v24, s[40:43], s27 offen offset:1024 nt lds
    buffer_load_dwordx4 v22, s[40:43], s27 offen offset:2048 nt lds
    buffer_load_dwordx4 v23, s[40:43], s27 offen offset:3072 nt lds
    s_mov_b32 m0, 32768
    s_mov_b32 s27, 45056
    buffer_load_dwordx4 v24, s[40:43], s27 offen offset:0 nt lds
    buffer_load_dwordx4 v22, s[40:43], s27 offen offset:1024 nt lds
    buffer_load_dwordx4 v23, s[40:43], s27 offen offset:2048 nt lds
    buffer_load_dwordx4 v24, s[40:43], s27 offen offset:3072 nt lds
    s_mov_b32 m0, 36864
    s_mov_b32 s27, 73728
    buffer_load_dwordx4 v22, s[36:39], s27 offen offset:0 nt lds
    buffer_load_dwordx4 v23, s[36:39], s27 offen offset:1024 nt lds
    buffer_load_dwordx4 v24, s[36:39], s27 offen offset:2048 nt lds
    buffer_load_dwordx4 v22, s[36:39], s27 offen offset:3072 nt lds
    s_mov_b32 m0, 40960
    s_mov_b32 s27, 77824
    buffer_load_dwordx4 v23, s[36:39], s27 offen offset:0 nt lds
    buffer_load_dwordx4 v24, s[36:39], s27 offen offset:1024 nt lds
    buffer_load_dwordx4 v22, s[36:39], s27 offen offset:2048 nt lds
    buffer_load_dwordx4 v23, s[36:39], s27 offen offset:3072 nt lds
    s_mov_b32 m0, 45056
    s_mov_b32 s27, 81920
    buffer_load_dwordx4 v24, s[36:39], s27 offen offset:0 nt lds
    buffer_load_dwordx4 v22, s[36:39], s27 offen offset:1024 nt lds
    buffer_load_dwordx4 v23, s[36:39], s27 offen offset:2048 nt lds
    buffer_load_dwordx4 v24, s[36:39], s27 offen offset:3072 nt lds
    s_mov_b32 m0, 49152
    s_mov_b32 s27, 86016
    buffer_load_dwordx4 v22, s[36:39], s27 offen offset:0 nt lds
    buffer_load_dwordx4 v23, s[36:39], s27 offen offset:1024 nt lds
    buffer_load_dwordx4 v24, s[36:39], s27 offen offset:2048 nt lds
    buffer_load_dwordx4 v22, s[36:39], s27 offen offset:3072 nt lds
    s_mov_b32 m0, 53248
    s_mov_b32 s27, 90112
    buffer_load_dwordx4 v23, s[36:39], s27 offen offset:0 nt lds
    buffer_load_dwordx4 v24, s[36:39], s27 offen offset:1024 nt lds
    buffer_load_dwordx4 v22, s[36:39], s27 offen offset:2048 nt lds
    buffer_load_dwordx4 v23, s[36:39], s27 offen offset:3072 nt lds
    s_mov_b32 m0, 57344
    s_mov_b32 s27, 94208
    buffer_load_dwordx4 v24, s[36:39], s27 offen offset:0 nt lds
    buffer_load_dwordx4 v22, s[36:39], s27 offen offset:1024 nt lds
    buffer_load_dwordx4 v23, s[36:39], s27 offen offset:2048 nt lds
    buffer_load_dwordx4 v24, s[36:39], s27 offen offset:3072 nt lds
    s_mov_b32 m0, 61440
    s_mov_b32 s27, 49152
    buffer_load_dwordx4 v22, s[40:43], s27 offen offset:0 nt lds
    buffer_load_dwordx4 v23, s[40:43], s27 offen offset:1024 nt lds
    buffer_load_dwordx4 v24, s[40:43], s27 offen offset:2048 nt lds
    buffer_load_dwordx4 v22, s[40:43], s27 offen offset:3072 nt lds
    s_mov_b32 m0, 65536
    s_mov_b32 s27, 53248
    buffer_load_dwordx4 v23, s[40:43], s27 offen offset:0 nt lds
    buffer_load_dwordx4 v24, s[40:43], s27 offen offset:1024 nt lds
    buffer_load_dwordx4 v22, s[40:43], s27 offen offset:2048 nt lds
    buffer_load_dwordx4 v23, s[40:43], s27 offen offset:3072 nt lds
    s_mov_b32 m0, 69632
    s_mov_b32 s27, 57344
    buffer_load_dwordx4 v24, s[40:43], s27 offen offset:0 nt lds
    buffer_load_dwordx4 v22, s[40:43], s27 offen offset:1024 nt lds
    buffer_load_dwordx4 v23, s[40:43], s27 offen offset:2048 nt lds
    buffer_load_dwordx4 v24, s[40:43], s27 offen offset:3072 nt lds
    s_waitcnt vmcnt(36)
    v_mov_b32 v200, 30
    ds_write_b32 v201, v200
    s_cmp_ge_u32 s28, 22
    s_waitcnt lgkmcnt(0)
    s_cbranch_scc1 L_f1
    s_mov_b32 s29, 22
    s_call_b64 s[30:31], L_free
L_f1:
    s_mov_b32 m0, 73728
    s_mov_b32 s27, 61440
    buffer_load_dwordx4 v22, s[40:43], s27 offen offset:0 nt lds
    buffer_load_dwordx4 v23, s[40:43], s27 offen offset:1024 nt lds
    buffer_load_dwordx4 v24, s[40:43], s27 offen offset:2048 nt lds
    buffer_load_dwordx4 v22, s[40:43], s27 offen offset:3072 nt lds
    s_mov_b32 m0, 77824
    s_mov_b32 s27, 65536
    buffer_load_dwordx4 v23, s[40:43], s27 offen offset:0 nt lds
    buffer_load_dwordx4 v24, s[40:43], s27 offen offset:1024 nt lds
    buffer_load_dwordx4 v22, s[40:43], s27 offen offset:2048 nt lds
    buffer_load_dwordx4 v23, s[40:43], s27 offen offset:3072 nt lds
    s_mov_b32 m0, 81920
    s_mov_b32 s27, 69632
    buffer_load_dwordx4 v24, s[40:43], s27 offen offset:0 nt lds
    buffer_load_dwordx4 v22, s[40:43], s27 offen offset:1024 nt lds
    buffer_load_dwordx4 v23, s[40:43], s27 offen offset:2048 nt lds
    buffer_load_dwordx4 v24, s[40:43], s27 offen offset:3072 nt lds
    s_waitcnt vmcnt(36)
    v_mov_b32 v200, 31
    ds_write_b32 v201, v200
    s_mov_b32 m0, 86016
    s_mov_b32 s27, 98304
    buffer_load_dwordx4 v22, s[36:39], s27 offen offset:0 nt lds
    buffer_load_dwordx4 v23, s[36:39], s27 offen offset:1024 nt lds
    buffer_load_dwordx4 v24, s[36:39], s27 offen offset:2048 nt lds
    buffer_load_dwordx4 v22, s[36:39], s27 offen offset:3072 nt lds
    s_mov_b32 m0, 90112
    s_mov_b32 s27, 102400
    buffer_load_dwordx4 v23, s[36:39], s27 offen offset:0 nt lds
    buffer_load_dwordx4 v24, s[36:39], s27 offen offset:1024 nt lds
    buffer_load_dwordx4 v22, s[36:39], s27 offen offset:2048 nt lds
    buffer_load_dwordx4 v23, s[36:39], s27 offen offset:3072 nt lds
    s_mov_b32 m0, 94208
    s_mov_b32 s27, 106496
    buffer_load_dwordx4 v24, s[36:39], s27 offen offset:0 nt lds
    buffer_load_dwordx4 v22, s[36:39], s27 offen offset:1024 nt lds
    buffer_load_dwordx4 v23, s[36:39], s27 offen offset:2048 nt lds
    buffer_load_dwordx4 v24, s[36:39], s27 offen offset:3072 nt lds
    s_waitcnt vmcnt(36)
    v_mov_b32 v200, 32
    ds_write_b32 v201, v200
    s_cmp_ge_u32 s28, 24
    s_waitcnt lgkmcnt(0)
    s_cbranch_scc1 L_f2
    s_mov_b32 s29, 24
    s_call_b64 s[30:31], L_free
L_f2:
    s_mov_b32 m0, 98304
    s_mov_b32 s27, 110592
    buffer_load_dwordx4 v22, s[36:39], s27 offen offset:0 nt lds
    buffer_load_dwordx4 v23, s[36:39], s27 offen offset:1024 nt lds
    buffer_load_dwordx4 v24, s[36:39], s27 offen offset:2048 nt lds
    buffer_load_dwordx4 v22, s[36:39], s27 offen offset:3072 nt lds
    s_mov_b32 m0, 102400
    s_mov_b32 s27, 114688
    buffer_load_dwordx4 v23, s[36:39], s27 offen offset:0 nt lds
    buffer_load_dwordx4 v24, s[36:39], s27 offen offset:1024 nt lds
    buffer_load_dwordx4 v22, s[36:39], s27 offen offset:2048 nt lds
    buffer_load_dwordx4 v23, s[36:39], s27 offen offset:3072 nt lds
    s_mov_b32 m0, 106496
    s_mov_b32 s27, 118784
    buffer_load_dwordx4 v24, s[36:39], s27 offen offset:0 nt lds
    buffer_load_dwordx4 v22, s[36:39], s27 offen offset:1024 nt lds
    buffer_load_dwordx4 v23, s[36:39], s27 offen offset:2048 nt lds
    buffer_load_dwordx4 v24, s[36:39], s27 offen offset:3072 nt lds
    s_waitcnt vmcnt(36)
    v_mov_b32 v200, 33
    ds_write_b32 v201, v200
    v_mov_b32 v6, 0
    buffer_load_dwordx2 v[4:5], v6, s[56:59], 0 offen sc1
    s_mov_b32 m0, 110592
    s_mov_b32 s27, 73728
    buffer_load_dwordx4 v22, s[40:43], s27 offen offset:0 nt lds
    buffer_load_dwordx4 v23, s[40:43], s27 offen offset:1024 nt lds
    buffer_load_dwordx4 v24, s[40:43], s27 offen offset:2048 nt lds
    buffer_load_dwordx4 v22, s[40:43], s27 offen offset:3072 nt lds
    s_mov_b32 m0, 114688
    s_mov_b32 s27, 77824
    buffer_load_dwordx4 v23, s[40:43], s27 offen offset:0 nt lds
    buffer_load_dwordx4 v24, s[40:43], s27 offen offset:1024 nt lds
    buffer_load_dwordx4 v22, s[40:43], s27 offen offset:2048 nt lds
    buffer_load_dwordx4 v23, s[40:43], s27 offen offset:3072 nt lds
    s_mov_b32 m0, 118784
    s_mov_b32 s27, 81920
    buffer_load_dwordx4 v24, s[40:43], s27 offen offset:0 nt lds
    buffer_load_dwordx4 v22, s[40:43], s27 offen offset:1024 nt lds
    buffer_load_dwordx4 v23, s[40:43], s27 offen offset:2048 nt lds
    buffer_load_dwordx4 v24, s[40:43], s27 offen offset:3072 nt lds
    s_waitcnt vmcnt(36)
    v_mov_b32 v200, 34
    ds_write_b32 v201, v200
    s_cmp_ge_u32 s28, 26
    s_waitcnt lgkmcnt(0)
    s_cbranch_scc1 L_f3
    s_mov_b32 s29, 26
    s_call_b64 s[30:31], L_free
L_f3:
    s_mov_b32 m0, 122880
    s_mov_b32 s27, 86016
    buffer_load_dwordx4 v22, s[40:43], s27 offen offset:0 nt lds
    buffer_load_dwordx4 v23, s[40:43], s27 offen offset:1024 nt lds
    buffer_load_dwordx4 v24, s[40:43], s27 offen offset:2048 nt lds
    buffer_load_dwordx4 v22, s[40:43], s27 offen offset:3072 nt lds
    s_mov_b32 m0, 126976
    s_mov_b32 s27, 90112
    buffer_load_dwordx4 v23, s[40:43], s27 offen offset:0 nt lds
    buffer_load_dwordx4 v24, s[40:43], s27 offen offset:1024 nt lds
    buffer_load_dwordx4 v22, s[40:43], s27 offen offset:2048 nt lds
    buffer_load_dwordx4 v23, s[40:43], s27 offen offset:3072 nt lds
    s_mov_b32 m0, 131072
    s_mov_b32 s27, 94208
    buffer_load_dwordx4 v24, s[40:43], s27 offen offset:0 nt lds
    buffer_load_dwordx4 v22, s[40:43], s27 offen offset:1024 nt lds
    buffer_load_dwordx4 v23, s[40:43], s27 offen offset:2048 nt lds
    buffer_load_dwordx4 v24, s[40:43], s27 offen offset:3072 nt lds
    s_waitcnt vmcnt(36)
    v_mov_b32 v200, 35
    ds_write_b32 v201, v200
    s_mov_b32 m0, 135168
    s_mov_b32 s27, 122880
    buffer_load_dwordx4 v22, s[36:39], s27 offen offset:0 nt lds
    buffer_load_dwordx4 v23, s[36:39], s27 offen offset:1024 nt lds
    buffer_load_dwordx4 v24, s[36:39], s27 offen offset:2048 nt lds
    buffer_load_dwordx4 v22, s[36:39], s27 offen offset:3072 nt lds
    s_mov_b32 m0, 139264
    s_mov_b32 s27, 126976
    buffer_load_dwordx4 v23, s[36:39], s27 offen offset:0 nt lds
    buffer_load_dwordx4 v24, s[36:39], s27 offen offset:1024 nt lds
    buffer_load_dwordx4 v22, s[36:39], s27 offen offset:2048 nt lds
    buffer_load_dwordx4 v23, s[36:39], s27 offen offset:3072 nt lds
    s_mov_b32 m0, 143360
    s_mov_b32 s27, 131072
    buffer_load_dwordx4 v24, s[36:39], s27 offen offset:0 nt lds
    buffer_load_dwordx4 v22, s[36:39], s27 offen offset:1024 nt lds
    buffer_load_dwordx4 v23, s[36:39], s27 offen offset:2048 nt lds
    buffer_load_dwordx4 v24, s[36:39], s27 offen offset:3072 nt lds
    s_waitcnt vmcnt(36)
    v_mov_b32 v200, 36
    ds_write_b32 v201, v200
    s_cmp_ge_u32 s28, 28
    s_waitcnt lgkmcnt(0)
    s_cbranch_scc1 L_f4
    s_mov_b32 s29, 28
    s_call_b64 s[30:31], L_free
L_f4:
    s_mov_b32 m0, 147456
    s_mov_b32 s27, 135168
    buffer_load_dwordx4 v22, s[36:39], s27 offen offset:0 nt lds
    buffer_load_dwordx4 v23, s[36:39], s27 offen offset:1024 nt lds
    buffer_load_dwordx4 v24, s[36:39], s27 offen offset:2048 nt lds
    buffer_load_dwordx4 v22, s[36:39], s27 offen offset:3072 nt lds
    s_mov_b32 m0, 151552
    s_mov_b32 s27, 139264
    buffer_load_dwordx4 v23, s[36:39], s27 offen offset:0 nt lds
    buffer_load_dwordx4 v24, s[36:39], s27 offen offset:1024 nt lds
    buffer_load_dwordx4 v22, s[36:39], s27 offen offset:2048 nt lds
    buffer_load_dwordx4 v23, s[36:39], s27 offen offset:3072 nt lds
    s_mov_b32 m0, 155648
    s_mov_b32 s27, 143360
    buffer_load_dwordx4 v24, s[36:39], s27 offen offset:0 nt lds
    buffer_load_dwordx4 v22, s[36:39], s27 offen offset:1024 nt lds
    buffer_load_dwordx4 v23, s[36:39], s27 offen offset:2048 nt lds
    buffer_load_dwordx4 v24, s[36:39], s27 offen offset:3072 nt lds
    s_waitcnt vmcnt(36)
    v_mov_b32 v200, 37
    ds_write_b32 v201, v200
    s_mov_b32 m0, 0
    s_mov_b32 s27, 98304
    buffer_load_dwordx4 v22, s[40:43], s27 offen offset:0 nt lds
    buffer_load_dwordx4 v23, s[40:43], s27 offen offset:1024 nt lds
    buffer_load_dwordx4 v24, s[40:43], s27 offen offset:2048 nt lds
    buffer_load_dwordx4 v22, s[40:43], s27 offen offset:3072 nt lds
    s_mov_b32 m0, 4096
    s_mov_b32 s27, 102400
    buffer_load_dwordx4 v23, s[40:43], s27 offen offset:0 nt lds
    buffer_load_dwordx4 v24, s[40:43], s27 offen offset:1024 nt lds
    buffer_load_dwordx4 v22, s[40:43], s27 offen offset:2048 nt lds
    buffer_load_dwordx4 v23, s[40:43], s27 offen offset:3072 nt lds
    s_mov_b32 m0, 8192
    s_mov_b32 s27, 106496
    buffer_load_dwordx4 v24, s[40:43], s27 offen offset:0 nt lds
    buffer_load_dwordx4 v22, s[40:43], s27 offen offset:1024 nt lds
    buffer_load_dwordx4 v23, s[40:43], s27 offen offset:2048 nt lds
    buffer_load_dwordx4 v24, s[40:43], s27 offen offset:3072 nt lds
    s_waitcnt vmcnt(36)
    v_mov_b32 v200, 38
    ds_write_b32 v201, v200
    s_cmp_ge_u32 s28, 30
    s_waitcnt lgkmcnt(0)
    s_cbranch_scc1 L_f5
    s_mov_b32 s29, 30
    s_call_b64 s[30:31], L_free
L_f5:
    s_mov_b32 m0, 12288
    s_mov_b32 s27, 110592
    buffer_load_dwordx4 v22, s[40:43], s27 offen offset:0 nt lds
    buffer_load_dwordx4 v23, s[40:43], s27 offen offset:1024 nt lds
    buffer_load_dwordx4 v24, s[40:43], s27 offen offset:2048 nt lds
    buffer_load_dwordx4 v22, s[40:43], s27 offen offset:3072 nt lds
    s_mov_b32 m0, 16384
    s_mov_b32 s27, 114688
    buffer_load_dwordx4 v23, s[40:43], s27 offen offset:0 nt lds
    buffer_load_dwordx4 v24, s[40:43], s27 offen offset:1024 nt lds
    buffer_load_dwordx4 v22, s[40:43], s27 offen offset:2048 nt lds
    buffer_load_dwordx4 v23, s[40:43], s27 offen offset:3072 nt lds
    s_mov_b32 m0, 20480
    s_mov_b32 s27, 118784
    buffer_load_dwordx4 v24, s[40:43], s27 offen offset:0 nt lds
    buffer_load_dwordx4 v22, s[40:43], s27 offen offset:1024 nt lds
    buffer_load_dwordx4 v23, s[40:43], s27 offen offset:2048 nt lds
    buffer_load_dwordx4 v24, s[40:43], s27 offen offset:3072 nt lds
    s_waitcnt vmcnt(36)
    v_mov_b32 v200, 39
    ds_write_b32 v201, v200
    s_mov_b32 m0, 24576
    s_mov_b32 s27, 147456
    buffer_load_dwordx4 v22, s[36:39], s27 offen offset:0 nt lds
    buffer_load_dwordx4 v23, s[36:39], s27 offen offset:1024 nt lds
    buffer_load_dwordx4 v24, s[36:39], s27 offen offset:2048 nt lds
    buffer_load_dwordx4 v22, s[36:39], s27 offen offset:3072 nt lds
    s_mov_b32 m0, 28672
    s_mov_b32 s27, 151552
    buffer_load_dwordx4 v23, s[36:39], s27 offen offset:0 nt lds
    buffer_load_dwordx4 v24, s[36:39], s27 offen offset:1024 nt lds
    buffer_load_dwordx4 v22, s[36:39], s27 offen offset:2048 nt lds
    buffer_load_dwordx4 v23, s[36:39], s27 offen offset:3072 nt lds
    s_mov_b32 m0, 32768
    s_mov_b32 s27, 155648
    buffer_load_dwordx4 v24, s[36:39], s27 offen offset:0 nt lds
    buffer_load_dwordx4 v22, s[36:39], s27 offen offset:1024 nt lds
    buffer_load_dwordx4 v23, s[36:39], s27 offen offset:2048 nt lds
    buffer_load_dwordx4 v24, s[36:39], s27 offen offset:3072 nt lds
    s_waitcnt vmcnt(36)
    v_mov_b32 v200, 40
    ds_write_b32 v201, v200
    s_cmp_ge_u32 s28, 32
    s_waitcnt lgkmcnt(0)
    s_cbranch_scc1 L_f6
    s_mov_b32 s29, 32
    s_call_b64 s[30:31], L_free
L_f6:
    s_mov_b32 m0, 36864
    s_mov_b32 s27, 159744
    buffer_load_dwordx4 v22, s[36:39], s27 offen offset:0 nt lds
    buffer_load_dwordx4 v23, s[36:39], s27 offen offset:1024 nt lds
    buffer_load_dwordx4 v24, s[36:39], s27 offen offset:2048 nt lds
    buffer_load_dwordx4 v22, s[36:39], s27 offen offset:3072 nt lds
    s_mov_b32 m0, 40960
    s_mov_b32 s27, 163840
    buffer_load_dwordx4 v23, s[36:39], s27 offen offset:0 nt lds
    buffer_load_dwordx4 v24, s[36:39], s27 offen offset:1024 nt lds
    buffer_load_dwordx4 v22, s[36:39], s27 offen offset:2048 nt lds
    buffer_load_dwordx4 v23, s[36:39], s27 offen offset:3072 nt lds
    s_mov_b32 m0, 45056
    s_mov_b32 s27, 167936
    buffer_load_dwordx4 v24, s[36:39], s27 offen offset:0 nt lds
    buffer_load_dwordx4 v22, s[36:39], s27 offen offset:1024 nt lds
    buffer_load_dwordx4 v23, s[36:39], s27 offen offset:2048 nt lds
    buffer_load_dwordx4 v24, s[36:39], s27 offen offset:3072 nt lds
    s_waitcnt vmcnt(36)
    v_mov_b32 v200, 41
    ds_write_b32 v201, v200
    s_waitcnt vmcnt(63)
    s_mov_b32 s62, 0
    s_waitcnt lgkmcnt(0)
L_ns:
    v_cmp_ne_u32 vcc, 0, v4
    v_cmp_ne_u32 s[64:65], 0, v5
    s_and_b64 vcc, vcc, s[64:65]
    s_cbranch_vccnz L_ng
    s_nop 2
    buffer_load_dwordx2 v[4:5], v6, s[56:59], 0 offen sc1
    s_add_u32 s62, s62, 1
    s_waitcnt vmcnt(0)
    s_cmp_lt_u32 s62, 200000
    s_cbranch_scc1 L_ns
L_ng:
    v_readfirstlane_b32 s68, v4
    v_readfirstlane_b32 s69, v5
    v_mov_b32 v6, 159744
    ds_write_b64 v6, v[4:5]
    s_mov_b32 m0, 49152
    s_mov_b32 s27, 122880
    s_nop 0
    buffer_load_dwordx4 v22, s[40:43], s27 offen offset:0 nt lds
    buffer_load_dwordx4 v23, s[40:43], s27 offen offset:1024 nt lds
    buffer_load_dwordx4 v24, s[40:43], s27 offen offset:2048 nt lds
    buffer_load_dwordx4 v22, s[40:43], s27 offen offset:3072 nt lds
    s_mov_b32 m0, 53248
    s_mov_b32 s27, 126976
    buffer_load_dwordx4 v23, s[40:43], s27 offen offset:0 nt lds
    buffer_load_dwordx4 v24, s[40:43], s27 offen offset:1024 nt lds
    buffer_load_dwordx4 v22, s[40:43], s27 offen offset:2048 nt lds
    buffer_load_dwordx4 v23, s[40:43], s27 offen offset:3072 nt lds
    s_mov_b32 m0, 57344
    s_mov_b32 s27, 131072
    buffer_load_dwordx4 v24, s[40:43], s27 offen offset:0 nt lds
    buffer_load_dwordx4 v22, s[40:43], s27 offen offset:1024 nt lds
    buffer_load_dwordx4 v23, s[40:43], s27 offen offset:2048 nt lds
    buffer_load_dwordx4 v24, s[40:43], s27 offen offset:3072 nt lds
    s_waitcnt vmcnt(36)
    v_mov_b32 v200, 42
    ds_write_b32 v201, v200
    s_cmp_ge_u32 s28, 34
    s_waitcnt lgkmcnt(0)
    s_cbranch_scc1 L_f7
    s_mov_b32 s29, 34
    s_call_b64 s[30:31], L_free
L_f7:
    s_mov_b32 m0, 61440
    s_mov_b32 s27, 135168
    buffer_load_dwordx4 v22, s[40:43], s27 offen offset:0 nt lds
    buffer_load_dwordx4 v23, s[40:43], s27 offen offset:1024 nt lds
    buffer_load_dwordx4 v24, s[40:43], s27 offen offset:2048 nt lds
    buffer_load_dwordx4 v22, s[40:43], s27 offen offset:3072 nt lds
    s_mov_b32 m0, 65536
    s_mov_b32 s27, 139264
    buffer_load_dwordx4 v23, s[40:43], s27 offen offset:0 nt lds
    buffer_load_dwordx4 v24, s[40:43], s27 offen offset:1024 nt lds
    buffer_load_dwordx4 v22, s[40:43], s27 offen offset:2048 nt lds
    buffer_load_dwordx4 v23, s[40:43], s27 offen offset:3072 nt lds
    s_mov_b32 m0, 69632
    s_mov_b32 s27, 143360
    buffer_load_dwordx4 v24, s[40:43], s27 offen offset:0 nt lds
    buffer_load_dwordx4 v22, s[40:43], s27 offen offset:1024 nt lds
    buffer_load_dwordx4 v23, s[40:43], s27 offen offset:2048 nt lds
    buffer_load_dwordx4 v24, s[40:43], s27 offen offset:3072 nt lds
    s_waitcnt vmcnt(36)
    v_mov_b32 v200, 43
    ds_write_b32 v201, v200
    s_mov_b32 m0, 73728
    s_mov_b32 s27, 172032
    buffer_load_dwordx4 v22, s[36:39], s27 offen offset:0 nt lds
    buffer_load_dwordx4 v23, s[36:39], s27 offen offset:1024 nt lds
    buffer_load_dwordx4 v24, s[36:39], s27 offen offset:2048 nt lds
    buffer_load_dwordx4 v22, s[36:39], s27 offen offset:3072 nt lds
    s_mov_b32 m0, 77824
    s_mov_b32 s27, 176128
    buffer_load_dwordx4 v23, s[36:39], s27 offen offset:0 nt lds
    buffer_load_dwordx4 v24, s[36:39], s27 offen offset:1024 nt lds
    buffer_load_dwordx4 v22, s[36:39], s27 offen offset:2048 nt lds
    buffer_load_dwordx4 v23, s[36:39], s27 offen offset:3072 nt lds
    s_mov_b32 m0, 81920
    s_mov_b32 s27, 180224
    buffer_load_dwordx4 v24, s[36:39], s27 offen offset:0 nt lds
    buffer_load_dwordx4 v22, s[36:39], s27 offen offset:1024 nt lds
    buffer_load_dwordx4 v23, s[36:39], s27 offen offset:2048 nt lds
    buffer_load_dwordx4 v24, s[36:39], s27 offen offset:3072 nt lds
    s_waitcnt vmcnt(36)
    v_mov_b32 v200, 44
    ds_write_b32 v201, v200
    s_cmp_ge_u32 s28, 36
    s_waitcnt lgkmcnt(0)
    s_cbranch_scc1 L_f8
    s_mov_b32 s29, 36
    s_call_b64 s[30:31], L_free
L_f8:
    s_mov_b32 m0, 86016
    s_mov_b32 s27, 184320
    buffer_load_dwordx4 v22, s[36:39], s27 offen offset:0 nt lds
    buffer_load_dwordx4 v23, s[36:39], s27 offen offset:1024 nt lds
    buffer_load_dwordx4 v24, s[36:39], s27 offen offset:2048 nt lds
    buffer_load_dwordx4 v22, s[36:39], s27 offen offset:3072 nt lds
    s_mov_b32 m0, 90112
    s_mov_b32 s27, 188416
    buffer_load_dwordx4 v23, s[36:39], s27 offen offset:0 nt lds
    buffer_load_dwordx4 v24, s[36:39], s27 offen offset:1024 nt lds
    buffer_load_dwordx4 v22, s[36:39], s27 offen offset:2048 nt lds
    buffer_load_dwordx4 v23, s[36:39], s27 offen offset:3072 nt lds
    s_mov_b32 m0, 94208
    s_mov_b32 s27, 192512
    buffer_load_dwordx4 v24, s[36:39], s27 offen offset:0 nt lds
    buffer_load_dwordx4 v22, s[36:39], s27 offen offset:1024 nt lds
    buffer_load_dwordx4 v23, s[36:39], s27 offen offset:2048 nt lds
    buffer_load_dwordx4 v24, s[36:39], s27 offen offset:3072 nt lds
    s_waitcnt vmcnt(36)
    v_mov_b32 v200, 45
    ds_write_b32 v201, v200
    s_mov_b32 m0, 98304
    s_mov_b32 s27, 147456
    buffer_load_dwordx4 v22, s[40:43], s27 offen offset:0 nt lds
    buffer_load_dwordx4 v23, s[40:43], s27 offen offset:1024 nt lds
    buffer_load_dwordx4 v24, s[40:43], s27 offen offset:2048 nt lds
    buffer_load_dwordx4 v22, s[40:43], s27 offen offset:3072 nt lds
    s_mov_b32 m0, 102400
    s_mov_b32 s27, 151552
    buffer_load_dwordx4 v23, s[40:43], s27 offen offset:0 nt lds
    buffer_load_dwordx4 v24, s[40:43], s27 offen offset:1024 nt lds
    buffer_load_dwordx4 v22, s[40:43], s27 offen offset:2048 nt lds
    buffer_load_dwordx4 v23, s[40:43], s27 offen offset:3072 nt lds
    s_mov_b32 m0, 106496
    s_mov_b32 s27, 155648
    buffer_load_dwordx4 v24, s[40:43], s27 offen offset:0 nt lds
    buffer_load_dwordx4 v22, s[40:43], s27 offen offset:1024 nt lds
    buffer_load_dwordx4 v23, s[40:43], s27 offen offset:2048 nt lds
    buffer_load_dwordx4 v24, s[40:43], s27 offen offset:3072 nt lds
    s_waitcnt vmcnt(36)
    v_mov_b32 v200, 46
    ds_write_b32 v201, v200
    s_cmp_ge_u32 s28, 38
    s_waitcnt lgkmcnt(0)
    s_cbranch_scc1 L_f9
    s_mov_b32 s29, 38
    s_call_b64 s[30:31], L_free
L_f9:
    s_mov_b32 m0, 110592
    s_mov_b32 s27, 159744
    buffer_load_dwordx4 v22, s[40:43], s27 offen offset:0 nt lds
    buffer_load_dwordx4 v23, s[40:43], s27 offen offset:1024 nt lds
    buffer_load_dwordx4 v24, s[40:43], s27 offen offset:2048 nt lds
    buffer_load_dwordx4 v22, s[40:43], s27 offen offset:3072 nt lds
    s_mov_b32 m0, 114688
    s_mov_b32 s27, 163840
    buffer_load_dwordx4 v23, s[40:43], s27 offen offset:0 nt lds
    buffer_load_dwordx4 v24, s[40:43], s27 offen offset:1024 nt lds
    buffer_load_dwordx4 v22, s[40:43], s27 offen offset:2048 nt lds
    buffer_load_dwordx4 v23, s[40:43], s27 offen offset:3072 nt lds
    s_mov_b32 m0, 118784
    s_mov_b32 s27, 167936
    buffer_load_dwordx4 v24, s[40:43], s27 offen offset:0 nt lds
    buffer_load_dwordx4 v22, s[40:43], s27 offen offset:1024 nt lds
    buffer_load_dwordx4 v23, s[40:43], s27 offen offset:2048 nt lds
    buffer_load_dwordx4 v24, s[40:43], s27 offen offset:3072 nt lds
    s_waitcnt vmcnt(36)
    v_mov_b32 v200, 47
    ds_write_b32 v201, v200
    s_mov_b32 m0, 122880
    s_mov_b32 s27, 172032
    buffer_load_dwordx4 v22, s[40:43], s27 offen offset:0 nt lds
    buffer_load_dwordx4 v23, s[40:43], s27 offen offset:1024 nt lds
    buffer_load_dwordx4 v24, s[40:43], s27 offen offset:2048 nt lds
    buffer_load_dwordx4 v22, s[40:43], s27 offen offset:3072 nt lds
    s_mov_b32 m0, 126976
    s_mov_b32 s27, 176128
    buffer_load_dwordx4 v23, s[40:43], s27 offen offset:0 nt lds
    buffer_load_dwordx4 v24, s[40:43], s27 offen offset:1024 nt lds
    buffer_load_dwordx4 v22, s[40:43], s27 offen offset:2048 nt lds
    buffer_load_dwordx4 v23, s[40:43], s27 offen offset:3072 nt lds
    s_mov_b32 m0, 131072
    s_mov_b32 s27, 180224
    buffer_load_dwordx4 v24, s[40:43], s27 offen offset:0 nt lds
    buffer_load_dwordx4 v22, s[40:43], s27 offen offset:1024 nt lds
    buffer_load_dwordx4 v23, s[40:43], s27 offen offset:2048 nt lds
    buffer_load_dwordx4 v24, s[40:43], s27 offen offset:3072 nt lds
    s_waitcnt vmcnt(36)
    v_mov_b32 v200, 48
    ds_write_b32 v201, v200
    s_cmp_ge_u32 s28, 40
    s_waitcnt lgkmcnt(0)
    s_cbranch_scc1 L_f10
    s_mov_b32 s29, 40
    s_call_b64 s[30:31], L_free
L_f10:
    s_mov_b32 m0, 135168
    s_mov_b32 s27, 184320
    buffer_load_dwordx4 v22, s[40:43], s27 offen offset:0 nt lds
    buffer_load_dwordx4 v23, s[40:43], s27 offen offset:1024 nt lds
    buffer_load_dwordx4 v24, s[40:43], s27 offen offset:2048 nt lds
    buffer_load_dwordx4 v22, s[40:43], s27 offen offset:3072 nt lds
    s_mov_b32 m0, 139264
    s_mov_b32 s27, 188416
    buffer_load_dwordx4 v23, s[40:43], s27 offen offset:0 nt lds
    buffer_load_dwordx4 v24, s[40:43], s27 offen offset:1024 nt lds
    buffer_load_dwordx4 v22, s[40:43], s27 offen offset:2048 nt lds
    buffer_load_dwordx4 v23, s[40:43], s27 offen offset:3072 nt lds
    s_mov_b32 m0, 143360
    s_mov_b32 s27, 192512
    buffer_load_dwordx4 v24, s[40:43], s27 offen offset:0 nt lds
    buffer_load_dwordx4 v22, s[40:43], s27 offen offset:1024 nt lds
    buffer_load_dwordx4 v23, s[40:43], s27 offen offset:2048 nt lds
    buffer_load_dwordx4 v24, s[40:43], s27 offen offset:3072 nt lds
    s_waitcnt vmcnt(36)
    v_mov_b32 v200, 49
    ds_write_b32 v201, v200
    s_add_u32 s26, s52, s4
    s_mov_b32 m0, 147456
    s_add_u32 s27, s26, 0
    buffer_load_dwordx4 v26, s[44:47], s27 offen offset:0 lds
    buffer_load_dwordx4 v27, s[44:47], s27 offen offset:1024 lds
    buffer_load_dwordx4 v28, s[44:47], s27 offen offset:2048 lds
    buffer_load_dwordx4 v29, s[44:47], s27 offen offset:3072 lds
    s_mov_b32 m0, 151552
    s_add_u32 s27, s26, 40960
    buffer_load_dwordx4 v26, s[44:47], s27 offen offset:0 lds
    buffer_load_dwordx4 v27, s[44:47], s27 offen offset:1024 lds
    buffer_load_dwordx4 v28, s[44:47], s27 offen offset:2048 lds
    buffer_load_dwordx4 v29, s[44:47], s27 offen offset:3072 lds
    s_mov_b32 m0, 155648
    s_add_u32 s27, s26, 81920
    buffer_load_dwordx4 v26, s[44:47], s27 offen offset:0 lds
    buffer_load_dwordx4 v27, s[44:47], s27 offen offset:1024 lds
    buffer_load_dwordx4 v28, s[44:47], s27 offen offset:2048 lds
    buffer_load_dwordx4 v29, s[44:47], s27 offen offset:3072 lds
    s_waitcnt vmcnt(36)
    v_mov_b32 v200, 50
    ds_write_b32 v201, v200
    s_cmp_ge_u32 s28, 42
    s_waitcnt lgkmcnt(0)
    s_cbranch_scc1 L_f11
    s_mov_b32 s29, 42
    s_call_b64 s[30:31], L_free
L_f11:
    s_add_u32 s26, s52, s5
    s_mov_b32 m0, 0
    s_add_u32 s27, s26, 0
    buffer_load_dwordx4 v26, s[44:47], s27 offen offset:0 lds
    buffer_load_dwordx4 v27, s[44:47], s27 offen offset:1024 lds
    buffer_load_dwordx4 v28, s[44:47], s27 offen offset:2048 lds
    buffer_load_dwordx4 v29, s[44:47], s27 offen offset:3072 lds
    s_mov_b32 m0, 4096
    s_add_u32 s27, s26, 40960
    buffer_load_dwordx4 v26, s[44:47], s27 offen offset:0 lds
    buffer_load_dwordx4 v27, s[44:47], s27 offen offset:1024 lds
    buffer_load_dwordx4 v28, s[44:47], s27 offen offset:2048 lds
    buffer_load_dwordx4 v29, s[44:47], s27 offen offset:3072 lds
    s_mov_b32 m0, 8192
    s_add_u32 s27, s26, 81920
    buffer_load_dwordx4 v26, s[44:47], s27 offen offset:0 lds
    buffer_load_dwordx4 v27, s[44:47], s27 offen offset:1024 lds
    buffer_load_dwordx4 v28, s[44:47], s27 offen offset:2048 lds
    buffer_load_dwordx4 v29, s[44:47], s27 offen offset:3072 lds
    v_lshlrev_b32 v41, 7, v1
    v_min_u32 v42, 6016, v41
    s_lshl_b32 s60, s22, 2
    s_add_u32 s60, s60, s23
    s_mul_i32 s60, s60, 30720
    s_mul_i32 s61, s21, 983040
    s_add_u32 s60, s60, s61
    s_mov_b32 s64, s12
    s_mov_b32 s65, s13
    s_mov_b32 s66, 7864320
    s_mov_b32 s67, 0x20000
    s_add_u32 s27, s60, 0
    buffer_load_dword v40, v41, s[64:67], s27 offen
    s_add_u32 s27, s60, 8192
    buffer_load_dword v40, v41, s[64:67], s27 offen
    s_add_u32 s27, s60, 16384
    buffer_load_dword v40, v41, s[64:67], s27 offen
    s_add_u32 s27, s60, 24576
    buffer_load_dword v40, v42, s[64:67], s27 offen
    s_waitcnt vmcnt(36)
    v_mov_b32 v200, 51
    ds_write_b32 v201, v200
    s_add_u32 s26, s52, s6
    s_mov_b32 m0, 12288
    s_add_u32 s27, s26, 0
    buffer_load_dwordx4 v26, s[44:47], s27 offen offset:0 lds
    buffer_load_dwordx4 v27, s[44:47], s27 offen offset:1024 lds
    buffer_load_dwordx4 v28, s[44:47], s27 offen offset:2048 lds
    buffer_load_dwordx4 v29, s[44:47], s27 offen offset:3072 lds
    s_mov_b32 m0, 16384
    s_add_u32 s27, s26, 40960
    buffer_load_dwordx4 v26, s[44:47], s27 offen offset:0 lds
    buffer_load_dwordx4 v27, s[44:47], s27 offen offset:1024 lds
    buffer_load_dwordx4 v28, s[44:47], s27 offen offset:2048 lds
    buffer_load_dwordx4 v29, s[44:47], s27 offen offset:3072 lds
    s_mov_b32 m0, 20480
    s_add_u32 s27, s26, 81920
    buffer_load_dwordx4 v26, s[44:47], s27 offen offset:0 lds
    buffer_load_dwordx4 v27, s[44:47], s27 offen offset:1024 lds
    buffer_load_dwordx4 v28, s[44:47], s27 offen offset:2048 lds
    buffer_load_dwordx4 v29, s[44:47], s27 offen offset:3072 lds
    s_waitcnt vmcnt(36)
    v_mov_b32 v200, 52
    ds_write_b32 v201, v200
    s_cmp_ge_u32 s28, 44
    s_waitcnt lgkmcnt(0)
    s_cbranch_scc1 L_f12
    s_mov_b32 s29, 44
    s_call_b64 s[30:31], L_free
L_f12:
    s_add_u32 s26, s52, s4
    s_mov_b32 m0, 24576
    s_add_u32 s27, s26, 122880
    buffer_load_dwordx4 v26, s[44:47], s27 offen offset:0 lds
    buffer_load_dwordx4 v27, s[44:47], s27 offen offset:1024 lds
    buffer_load_dwordx4 v28, s[44:47], s27 offen offset:2048 lds
    buffer_load_dwordx4 v29, s[44:47], s27 offen offset:3072 lds
    s_mov_b32 m0, 28672
    s_add_u32 s27, s26, 163840
    buffer_load_dwordx4 v26, s[44:47], s27 offen offset:0 lds
    buffer_load_dwordx4 v27, s[44:47], s27 offen offset:1024 lds
    buffer_load_dwordx4 v28, s[44:47], s27 offen offset:2048 lds
    buffer_load_dwordx4 v29, s[44:47], s27 offen offset:3072 lds
    s_mov_b32 m0, 32768
    s_add_u32 s27, s26, 204800
    buffer_load_dwordx4 v26, s[44:47], s27 offen offset:0 lds
    buffer_load_dwordx4 v27, s[44:47], s27 offen offset:1024 lds
    buffer_load_dwordx4 v28, s[44:47], s27 offen offset:2048 lds
    buffer_load_dwordx4 v29, s[44:47], s27 offen offset:3072 lds
    s_waitcnt vmcnt(36)
    v_mov_b32 v200, 53
    ds_write_b32 v201, v200
    s_add_u32 s26, s52, s5
    s_mov_b32 m0, 36864
    s_add_u32 s27, s26, 122880
    buffer_load_dwordx4 v26, s[44:47], s27 offen offset:0 lds
    buffer_load_dwordx4 v27, s[44:47], s27 offen offset:1024 lds
    buffer_load_dwordx4 v28, s[44:47], s27 offen offset:2048 lds
    buffer_load_dwordx4 v29, s[44:47], s27 offen offset:3072 lds
    s_mov_b32 m0, 40960
    s_add_u32 s27, s26, 163840
    buffer_load_dwordx4 v26, s[44:47], s27 offen offset:0 lds
    buffer_load_dwordx4 v27, s[44:47], s27 offen offset:1024 lds
    buffer_load_dwordx4 v28, s[44:47], s27 offen offset:2048 lds
    buffer_load_dwordx4 v29, s[44:47], s27 offen offset:3072 lds
    s_mov_b32 m0, 45056
    s_add_u32 s27, s26, 204800
    buffer_load_dwordx4 v26, s[44:47], s27 offen offset:0 lds
    buffer_load_dwordx4 v27, s[44:47], s27 offen offset:1024 lds
    buffer_load_dwordx4 v28, s[44:47], s27 offen offset:2048 lds
    buffer_load_dwordx4 v29, s[44:47], s27 offen offset:3072 lds
    s_waitcnt vmcnt(36)
    v_mov_b32 v200, 54
    ds_write_b32 v201, v200
    s_cmp_ge_u32 s28, 46
    s_waitcnt lgkmcnt(0)
    s_cbranch_scc1 L_f13
    s_mov_b32 s29, 46
    s_call_b64 s[30:31], L_free
L_f13:
    s_add_u32 s26, s52, s6
    s_mov_b32 m0, 49152
    s_add_u32 s27, s26, 122880
    buffer_load_dwordx4 v26, s[44:47], s27 offen offset:0 lds
    buffer_load_dwordx4 v27, s[44:47], s27 offen offset:1024 lds
    buffer_load_dwordx4 v28, s[44:47], s27 offen offset:2048 lds
    buffer_load_dwordx4 v29, s[44:47], s27 offen offset:3072 lds
    s_mov_b32 m0, 53248
    s_add_u32 s27, s26, 163840
    buffer_load_dwordx4 v26, s[44:47], s27 offen offset:0 lds
    buffer_load_dwordx4 v27, s[44:47], s27 offen offset:1024 lds
    buffer_load_dwordx4 v28, s[44:47], s27 offen offset:2048 lds
    buffer_load_dwordx4 v29, s[44:47], s27 offen offset:3072 lds
    s_mov_b32 m0, 57344
    s_add_u32 s27, s26, 204800
    buffer_load_dwordx4 v26, s[44:47], s27 offen offset:0 lds
    buffer_load_dwordx4 v27, s[44:47], s27 offen offset:1024 lds
    buffer_load_dwordx4 v28, s[44:47], s27 offen offset:2048 lds
    buffer_load_dwordx4 v29, s[44:47], s27 offen offset:3072 lds
    s_waitcnt vmcnt(36)
    v_mov_b32 v200, 55
    ds_write_b32 v201, v200
    s_add_u32 s26, s53, s4
    s_mov_b32 m0, 61440
    s_add_u32 s27, s26, 0
    buffer_load_dwordx4 v26, s[44:47], s27 offen offset:0 lds
    buffer_load_dwordx4 v27, s[44:47], s27 offen offset:1024 lds
    buffer_load_dwordx4 v28, s[44:47], s27 offen offset:2048 lds
    buffer_load_dwordx4 v29, s[44:47], s27 offen offset:3072 lds
    s_mov_b32 m0, 65536
    s_add_u32 s27, s26, 40960
    buffer_load_dwordx4 v26, s[44:47], s27 offen offset:0 lds
    buffer_load_dwordx4 v27, s[44:47], s27 offen offset:1024 lds
    buffer_load_dwordx4 v28, s[44:47], s27 offen offset:2048 lds
    buffer_load_dwordx4 v29, s[44:47], s27 offen offset:3072 lds
    s_mov_b32 m0, 69632
    s_add_u32 s27, s26, 81920
    buffer_load_dwordx4 v26, s[44:47], s27 offen offset:0 lds
    buffer_load_dwordx4 v27, s[44:47], s27 offen offset:1024 lds
    buffer_load_dwordx4 v28, s[44:47], s27 offen offset:2048 lds
    buffer_load_dwordx4 v29, s[44:47], s27 offen offset:3072 lds
    s_waitcnt vmcnt(36)
    v_mov_b32 v200, 56
    ds_write_b32 v201, v200
    s_cmp_ge_u32 s28, 48
    s_waitcnt lgkmcnt(0)
    s_cbranch_scc1 L_f14
    s_mov_b32 s29, 48
    s_call_b64 s[30:31], L_free
L_f14:
    s_add_u32 s26, s53, s4
    s_mov_b32 m0, 73728
    s_add_u32 s27, s26, 122880
    buffer_load_dwordx4 v26, s[44:47], s27 offen offset:0 lds
    buffer_load_dwordx4 v27, s[44:47], s27 offen offset:1024 lds
    buffer_load_dwordx4 v28, s[44:47], s27 offen offset:2048 lds
    buffer_load_dwordx4 v29, s[44:47], s27 offen offset:3072 lds
    s_mov_b32 m0, 77824
    s_add_u32 s27, s26, 163840
    buffer_load_dwordx4 v26, s[44:47], s27 offen offset:0 lds
    buffer_load_dwordx4 v27, s[44:47], s27 offen offset:1024 lds
    buffer_load_dwordx4 v28, s[44:47], s27 offen offset:2048 lds
    buffer_load_dwordx4 v29, s[44:47], s27 offen offset:3072 lds
    s_mov_b32 m0, 81920
    s_add_u32 s27, s26, 204800
    buffer_load_dwordx4 v26, s[44:47], s27 offen offset:0 lds
    buffer_load_dwordx4 v27, s[44:47], s27 offen offset:1024 lds
    buffer_load_dwordx4 v28, s[44:47], s27 offen offset:2048 lds
    buffer_load_dwordx4 v29, s[44:47], s27 offen offset:3072 lds
    s_waitcnt vmcnt(36)
    v_mov_b32 v200, 57
    ds_write_b32 v201, v200
    s_add_u32 s26, s53, s5
    s_mov_b32 m0, 86016
    s_add_u32 s27, s26, 0
    buffer_load_dwordx4 v26, s[44:47], s27 offen offset:0 lds
    buffer_load_dwordx4 v27, s[44:47], s27 offen offset:1024 lds
    buffer_load_dwordx4 v28, s[44:47], s27 offen offset:2048 lds
    buffer_load_dwordx4 v29, s[44:47], s27 offen offset:3072 lds
    s_mov_b32 m0, 90112
    s_add_u32 s27, s26, 40960
    buffer_load_dwordx4 v26, s[44:47], s27 offen offset:0 lds
    buffer_load_dwordx4 v27, s[44:47], s27 offen offset:1024 lds
    buffer_load_dwordx4 v28, s[44:47], s27 offen offset:2048 lds
    buffer_load_dwordx4 v29, s[44:47], s27 offen offset:3072 lds
    s_mov_b32 m0, 94208
    s_add_u32 s27, s26, 81920
    buffer_load_dwordx4 v26, s[44:47], s27 offen offset:0 lds
    buffer_load_dwordx4 v27, s[44:47], s27 offen offset:1024 lds
    buffer_load_dwordx4 v28, s[44:47], s27 offen offset:2048 lds
    buffer_load_dwordx4 v29, s[44:47], s27 offen offset:3072 lds
    s_waitcnt vmcnt(36)
    v_mov_b32 v200, 58
    ds_write_b32 v201, v200
    s_cmp_ge_u32 s28, 50
    s_waitcnt lgkmcnt(0)
    s_cbranch_scc1 L_f15
    s_mov_b32 s29, 50
    s_call_b64 s[30:31], L_free
L_f15:
    s_add_u32 s26, s53, s5
    s_mov_b32 m0, 98304
    s_add_u32 s27, s26, 122880
    buffer_load_dwordx4 v26, s[44:47], s27 offen offset:0 lds
    buffer_load_dwordx4 v27, s[44:47], s27 offen offset:1024 lds
    buffer_load_dwordx4 v28, s[44:47], s27 offen offset:2048 lds
    buffer_load_dwordx4 v29, s[44:47], s27 offen offset:3072 lds
    s_mov_b32 m0, 102400
    s_add_u32 s27, s26, 163840
    buffer_load_dwordx4 v26, s[44:47], s27 offen offset:0 lds
    buffer_load_dwordx4 v27, s[44:47], s27 offen offset:1024 lds
    buffer_load_dwordx4 v28, s[44:47], s27 offen offset:2048 lds
    buffer_load_dwordx4 v29, s[44:47], s27 offen offset:3072 lds
    s_mov_b32 m0, 106496
    s_add_u32 s27, s26, 204800
    buffer_load_dwordx4 v26, s[44:47], s27 offen offset:0 lds
    buffer_load_dwordx4 v27, s[44:47], s27 offen offset:1024 lds
    buffer_load_dwordx4 v28, s[44:47], s27 offen offset:2048 lds
    buffer_load_dwordx4 v29, s[44:47], s27 offen offset:3072 lds
    s_waitcnt vmcnt(36)
    v_mov_b32 v200, 59
    ds_write_b32 v201, v200
    s_add_u32 s26, s53, s6
    s_mov_b32 m0, 110592
    s_add_u32 s27, s26, 0
    buffer_load_dwordx4 v26, s[44:47], s27 offen offset:0 lds
    buffer_load_dwordx4 v27, s[44:47], s27 offen offset:1024 lds
    buffer_load_dwordx4 v28, s[44:47], s27 offen offset:2048 lds
    buffer_load_dwordx4 v29, s[44:47], s27 offen offset:3072 lds
    s_mov_b32 m0, 114688
    s_add_u32 s27, s26, 40960
    buffer_load_dwordx4 v26, s[44:47], s27 offen offset:0 lds
    buffer_load_dwordx4 v27, s[44:47], s27 offen offset:1024 lds
    buffer_load_dwordx4 v28, s[44:47], s27 offen offset:2048 lds
    buffer_load_dwordx4 v29, s[44:47], s27 offen offset:3072 lds
    s_mov_b32 m0, 118784
    s_add_u32 s27, s26, 81920
    buffer_load_dwordx4 v26, s[44:47], s27 offen offset:0 lds
    buffer_load_dwordx4 v27, s[44:47], s27 offen offset:1024 lds
    buffer_load_dwordx4 v28, s[44:47], s27 offen offset:2048 lds
    buffer_load_dwordx4 v29, s[44:47], s27 offen offset:3072 lds
    s_waitcnt vmcnt(36)
    v_mov_b32 v200, 60
    ds_write_b32 v201, v200
    s_cmp_ge_u32 s28, 52
    s_waitcnt lgkmcnt(0)
    s_cbranch_scc1 L_f16
    s_mov_b32 s29, 52
    s_call_b64 s[30:31], L_free
L_f16:
    s_add_u32 s26, s53, s6
    s_mov_b32 m0, 122880
    s_add_u32 s27, s26, 122880
    buffer_load_dwordx4 v26, s[44:47], s27 offen offset:0 lds
    buffer_load_dwordx4 v27, s[44:47], s27 offen offset:1024 lds
    buffer_load_dwordx4 v28, s[44:47], s27 offen offset:2048 lds
    buffer_load_dwordx4 v29, s[44:47], s27 offen offset:3072 lds
    s_mov_b32 m0, 126976
    s_add_u32 s27, s26, 163840
    buffer_load_dwordx4 v26, s[44:47], s27 offen offset:0 lds
    buffer_load_dwordx4 v27, s[44:47], s27 offen offset:1024 lds
    buffer_load_dwordx4 v28, s[44:47], s27 offen offset:2048 lds
    buffer_load_dwordx4 v29, s[44:47], s27 offen offset:3072 lds
    s_mov_b32 m0, 131072
    s_add_u32 s27, s26, 204800
    buffer_load_dwordx4 v26, s[44:47], s27 offen offset:0 lds
    buffer_load_dwordx4 v27, s[44:47], s27 offen offset:1024 lds
    buffer_load_dwordx4 v28, s[44:47], s27 offen offset:2048 lds
    buffer_load_dwordx4 v29, s[44:47], s27 offen offset:3072 lds
    s_waitcnt vmcnt(36)
    v_mov_b32 v200, 61
    ds_write_b32 v201, v200
    s_add_u32 s26, s54, s5
    s_mov_b32 m0, 135168
    s_add_u32 s27, s26, 0
    buffer_load_dwordx4 v26, s[44:47], s27 offen offset:0 lds
    buffer_load_dwordx4 v27, s[44:47], s27 offen offset:1024 lds
    buffer_load_dwordx4 v28, s[44:47], s27 offen offset:2048 lds
    buffer_load_dwordx4 v29, s[44:47], s27 offen offset:3072 lds
    s_mov_b32 m0, 139264
    s_add_u32 s27, s26, 40960
    buffer_load_dwordx4 v26, s[44:47], s27 offen offset:0 lds
    buffer_load_dwordx4 v27, s[44:47], s27 offen offset:1024 lds
    buffer_load_dwordx4 v28, s[44:47], s27 offen offset:2048 lds
    buffer_load_dwordx4 v29, s[44:47], s27 offen offset:3072 lds
    s_mov_b32 m0, 143360
    s_add_u32 s27, s26, 81920
    buffer_load_dwordx4 v26, s[44:47], s27 offen offset:0 lds
    buffer_load_dwordx4 v27, s[44:47], s27 offen offset:1024 lds
    buffer_load_dwordx4 v28, s[44:47], s27 offen offset:2048 lds
    buffer_load_dwordx4 v29, s[44:47], s27 offen offset:3072 lds
    s_waitcnt vmcnt(36)
    v_mov_b32 v200, 62
    ds_write_b32 v201, v200
    s_cmp_ge_u32 s28, 54
    s_waitcnt lgkmcnt(0)
    s_cbranch_scc1 L_f17
    s_mov_b32 s29, 54
    s_call_b64 s[30:31], L_free
L_f17:
    s_add_u32 s26, s54, s5
    s_mov_b32 m0, 147456
    s_add_u32 s27, s26, 122880
    buffer_load_dwordx4 v26, s[44:47], s27 offen offset:0 lds
    buffer_load_dwordx4 v27, s[44:47], s27 offen offset:1024 lds
    buffer_load_dwordx4 v28, s[44:47], s27 offen offset:2048 lds
    buffer_load_dwordx4 v29, s[44:47], s27 offen offset:3072 lds
    s_mov_b32 m0, 151552
    s_add_u32 s27, s26, 163840
    buffer_load_dwordx4 v26, s[44:47], s27 offen offset:0 lds
    buffer_load_dwordx4 v27, s[44:47], s27 offen offset:1024 lds
    buffer_load_dwordx4 v28, s[44:47], s27 offen offset:2048 lds
    buffer_load_dwordx4 v29, s[44:47], s27 offen offset:3072 lds
    s_mov_b32 m0, 155648
    s_add_u32 s27, s26, 204800
    buffer_load_dwordx4 v26, s[44:47], s27 offen offset:0 lds
    buffer_load_dwordx4 v27, s[44:47], s27 offen offset:1024 lds
    buffer_load_dwordx4 v28, s[44:47], s27 offen offset:2048 lds
    buffer_load_dwordx4 v29, s[44:47], s27 offen offset:3072 lds
    s_waitcnt vmcnt(36)
    v_mov_b32 v200, 63
    ds_write_b32 v201, v200
    s_add_u32 s26, s55, s5
    s_mov_b32 m0, 0
    s_add_u32 s27, s26, 0
    buffer_load_dwordx4 v26, s[44:47], s27 offen offset:0 lds
    buffer_load_dwordx4 v27, s[44:47], s27 offen offset:1024 lds
    buffer_load_dwordx4 v28, s[44:47], s27 offen offset:2048 lds
    buffer_load_dwordx4 v29, s[44:47], s27 offen offset:3072 lds
    s_mov_b32 m0, 4096
    s_add_u32 s27, s26, 40960
    buffer_load_dwordx4 v26, s[44:47], s27 offen offset:0 lds
    buffer_load_dwordx4 v27, s[44:47], s27 offen offset:1024 lds
    buffer_load_dwordx4 v28, s[44:47], s27 offen offset:2048 lds
    buffer_load_dwordx4 v29, s[44:47], s27 offen offset:3072 lds
    s_mov_b32 m0, 8192
    s_add_u32 s27, s26, 81920
    buffer_load_dwordx4 v26, s[44:47], s27 offen offset:0 lds
    buffer_load_dwordx4 v27, s[44:47], s27 offen offset:1024 lds
    buffer_load_dwordx4 v28, s[44:47], s27 offen offset:2048 lds
    buffer_load_dwordx4 v29, s[44:47], s27 offen offset:3072 lds
    s_waitcnt vmcnt(36)
    v_mov_b32 v200, 64
    ds_write_b32 v201, v200
    s_cmp_ge_u32 s28, 56
    s_waitcnt lgkmcnt(0)
    s_cbranch_scc1 L_f18
    s_mov_b32 s29, 56
    s_call_b64 s[30:31], L_free
L_f18:
    s_add_u32 s26, s55, s5
    s_mov_b32 m0, 12288
    s_add_u32 s27, s26, 122880
    buffer_load_dwordx4 v26, s[44:47], s27 offen offset:0 lds
    buffer_load_dwordx4 v27, s[44:47], s27 offen offset:1024 lds
    buffer_load_dwordx4 v28, s[44:47], s27 offen offset:2048 lds
    buffer_load_dwordx4 v29, s[44:47], s27 offen offset:3072 lds
    s_mov_b32 m0, 16384
    s_add_u32 s27, s26, 163840
    buffer_load_dwordx4 v26, s[44:47], s27 offen offset:0 lds
    buffer_load_dwordx4 v27, s[44:47], s27 offen offset:1024 lds
    buffer_load_dwordx4 v28, s[44:47], s27 offen offset:2048 lds
    buffer_load_dwordx4 v29, s[44:47], s27 offen offset:3072 lds
    s_mov_b32 m0, 20480
    s_add_u32 s27, s26, 204800
    buffer_load_dwordx4 v26, s[44:47], s27 offen offset:0 lds
    buffer_load_dwordx4 v27, s[44:47], s27 offen offset:1024 lds
    buffer_load_dwordx4 v28, s[44:47], s27 offen offset:2048 lds
    buffer_load_dwordx4 v29, s[44:47], s27 offen offset:3072 lds
    s_waitcnt vmcnt(36)
    v_mov_b32 v200, 65
    ds_write_b32 v201, v200
    s_add_u32 s26, s54, s6
    s_mov_b32 m0, 24576
    s_add_u32 s27, s26, 0
    buffer_load_dwordx4 v26, s[44:47], s27 offen offset:0 lds
    buffer_load_dwordx4 v27, s[44:47], s27 offen offset:1024 lds
    buffer_load_dwordx4 v28, s[44:47], s27 offen offset:2048 lds
    buffer_load_dwordx4 v29, s[44:47], s27 offen offset:3072 lds
    s_mov_b32 m0, 28672
    s_add_u32 s27, s26, 40960
    buffer_load_dwordx4 v26, s[44:47], s27 offen offset:0 lds
    buffer_load_dwordx4 v27, s[44:47], s27 offen offset:1024 lds
    buffer_load_dwordx4 v28, s[44:47], s27 offen offset:2048 lds
    buffer_load_dwordx4 v29, s[44:47], s27 offen offset:3072 lds
    s_mov_b32 m0, 32768
    s_add_u32 s27, s26, 81920
    buffer_load_dwordx4 v26, s[44:47], s27 offen offset:0 lds
    buffer_load_dwordx4 v27, s[44:47], s27 offen offset:1024 lds
    buffer_load_dwordx4 v28, s[44:47], s27 offen offset:2048 lds
    buffer_load_dwordx4 v29, s[44:47], s27 offen offset:3072 lds
    s_waitcnt vmcnt(36)
    v_mov_b32 v200, 66
    ds_write_b32 v201, v200
    s_cmp_ge_u32 s28, 58
    s_waitcnt lgkmcnt(0)
    s_cbranch_scc1 L_f19
    s_mov_b32 s29, 58
    s_call_b64 s[30:31], L_free
L_f19:
    s_add_u32 s26, s54, s6
    s_mov_b32 m0, 36864
    s_add_u32 s27, s26, 122880
    buffer_load_dwordx4 v26, s[44:47], s27 offen offset:0 lds
    buffer_load_dwordx4 v27, s[44:47], s27 offen offset:1024 lds
    buffer_load_dwordx4 v28, s[44:47], s27 offen offset:2048 lds
    buffer_load_dwordx4 v29, s[44:47], s27 offen offset:3072 lds
    s_mov_b32 m0, 40960
    s_add_u32 s27, s26, 163840
    buffer_load_dwordx4 v26, s[44:47], s27 offen offset:0 lds
    buffer_load_dwordx4 v27, s[44:47], s27 offen offset:1024 lds
    buffer_load_dwordx4 v28, s[44:47], s27 offen offset:2048 lds
    buffer_load_dwordx4 v29, s[44:47], s27 offen offset:3072 lds
    s_mov_b32 m0, 45056
    s_add_u32 s27, s26, 204800
    buffer_load_dwordx4 v26, s[44:47], s27 offen offset:0 lds
    buffer_load_dwordx4 v27, s[44:47], s27 offen offset:1024 lds
    buffer_load_dwordx4 v28, s[44:47], s27 offen offset:2048 lds
    buffer_load_dwordx4 v29, s[44:47], s27 offen offset:3072 lds
    s_waitcnt vmcnt(36)
    v_mov_b32 v200, 67
    ds_write_b32 v201, v200
    s_add_u32 s26, s55, s6
    s_mov_b32 m0, 49152
    s_add_u32 s27, s26, 0
    buffer_load_dwordx4 v26, s[44:47], s27 offen offset:0 lds
    buffer_load_dwordx4 v27, s[44:47], s27 offen offset:1024 lds
    buffer_load_dwordx4 v28, s[44:47], s27 offen offset:2048 lds
    buffer_load_dwordx4 v29, s[44:47], s27 offen offset:3072 lds
    s_mov_b32 m0, 53248
    s_add_u32 s27, s26, 40960
    buffer_load_dwordx4 v26, s[44:47], s27 offen offset:0 lds
    buffer_load_dwordx4 v27, s[44:47], s27 offen offset:1024 lds
    buffer_load_dwordx4 v28, s[44:47], s27 offen offset:2048 lds
    buffer_load_dwordx4 v29, s[44:47], s27 offen offset:3072 lds
    s_mov_b32 m0, 57344
    s_add_u32 s27, s26, 81920
    buffer_load_dwordx4 v26, s[44:47], s27 offen offset:0 lds
    buffer_load_dwordx4 v27, s[44:47], s27 offen offset:1024 lds
    buffer_load_dwordx4 v28, s[44:47], s27 offen offset:2048 lds
    buffer_load_dwordx4 v29, s[44:47], s27 offen offset:3072 lds
    s_waitcnt vmcnt(36)
    v_mov_b32 v200, 68
    ds_write_b32 v201, v200
    s_cmp_ge_u32 s28, 60
    s_waitcnt lgkmcnt(0)
    s_cbranch_scc1 L_f20
    s_mov_b32 s29, 60
    s_call_b64 s[30:31], L_free
L_f20:
    s_add_u32 s26, s55, s6
    s_mov_b32 m0, 61440
    s_add_u32 s27, s26, 122880
    buffer_load_dwordx4 v26, s[44:47], s27 offen offset:0 lds
    buffer_load_dwordx4 v27, s[44:47], s27 offen offset:1024 lds
    buffer_load_dwordx4 v28, s[44:47], s27 offen offset:2048 lds
    buffer_load_dwordx4 v29, s[44:47], s27 offen offset:3072 lds
    s_mov_b32 m0, 65536
    s_add_u32 s27, s26, 163840
    buffer_load_dwordx4 v26, s[44:47], s27 offen offset:0 lds
    buffer_load_dwordx4 v27, s[44:47], s27 offen offset:1024 lds
    buffer_load_dwordx4 v28, s[44:47], s27 offen offset:2048 lds
    buffer_load_dwordx4 v29, s[44:47], s27 offen offset:3072 lds
    s_mov_b32 m0, 69632
    s_add_u32 s27, s26, 204800
    buffer_load_dwordx4 v26, s[44:47], s27 offen offset:0 lds
    buffer_load_dwordx4 v27, s[44:47], s27 offen offset:1024 lds
    buffer_load_dwordx4 v28, s[44:47], s27 offen offset:2048 lds
    buffer_load_dwordx4 v29, s[44:47], s27 offen offset:3072 lds
    s_waitcnt vmcnt(36)
    v_mov_b32 v200, 69
    ds_write_b32 v201, v200
    s_waitcnt vmcnt(24)
    v_mov_b32 v200, 70
    ds_write_b32 v201, v200
    s_waitcnt vmcnt(12)
    v_mov_b32 v200, 71
    ds_write_b32 v201, v200
    s_waitcnt vmcnt(0)
    v_mov_b32 v200, 72
    ds_write_b32 v201, v200
    s_mov_b32 s44, s14
    s_mov_b32 s45, s15
    s_mov_b32 s46, 1474560
    s_mov_b32 s47, 0x20000
    s_lshr_b32 s40, s23, 1
    s_mul_i32 s40, s40, 640
    s_and_b32 s41, s23, 1
    s_lshl_b32 s41, s41, 8
    s_add_u32 s41, s41, s40
    s_add_u32 s42, s41, 128
    s_add_u32 s40, s40, 512
    v_and_b32 v3, 15, v1
    v_mul_u32_u24 v3, 1280, v3
    v_lshrrev_b32 v6, 4, v1
    v_lshl_add_u32 v3, v6, 3, v3
    v_and_b32 v2, 7, v1
    v_lshlrev_b32 v2, 7, v2
    v_and_b32 v6, 8, v1
    v_mul_u32_u24 v6, 384, v6
    v_add_u32 v6, v6, v2
    s_mov_b32 s56, 0x00003f80
    s_mov_b32 s57, 0x3f800000
    s_lshl_b32 s54, s22, 5
    s_add_u32 s53, s54, s23
    s_mul_i32 s53, s53, 55424
    s_add_u32 s53, s53, 16777216
    s_and_b32 s55, s23, 2
    s_add_u32 s54, s54, s55
    s_mul_i32 s54, s54, 55424
    s_add_u32 s54, s54, 16777216
    s_lshl_b32 s52, s22, 2
    s_add_u32 s55, s55, s52
    s_mul_i32 s55, s55, 3072
    s_add_u32 s55, s55, 46235648
    s_add_u32 s39, s52, s23
    s_mul_i32 s39, s39, 3072
    s_add_u32 s39, s39, 46235648
    s_mul_i32 s52, s22, 184320
    s_cmp_ge_u32 s28, 62
    s_waitcnt lgkmcnt(0)
    s_cbranch_scc1 L_f21
    s_mov_b32 s29, 62
    s_call_b64 s[30:31], L_free
L_f21:
    s_and_b32 s37, s23, 1
    s_lshl_b32 s61, s21, 1
    s_add_u32 s61, s61, s37
    s_call_b64 s[66:67], L_unit16
    s_cmp_lg_u32 s21, 0
    s_cbranch_scc1 L_r1
    s_add_u32 s61, s37, 16
    s_call_b64 s[66:67], L_unit16
L_r1:
    s_cmp_ge_u32 s28, 70
    s_cbranch_scc1 L_f22
    s_mov_b32 s29, 70
    s_call_b64 s[30:31], L_free
L_f22:
    s_add_u32 s61, s21, 24
    s_call_b64 s[66:67], L_unit8
    s_cmp_lt_u32 s21, 4
    s_cbranch_scc1 L_r2
    s_add_u32 s61, s21, 28
    s_call_b64 s[66:67], L_unit8
L_r2:
    s_endpgm
L_free:
    s_mov_b32 s62, 0
L_free1:
    ds_read_b32 v200, v202
    s_add_u32 s62, s62, 1
    s_waitcnt lgkmcnt(0)
    v_readlane_b32 s28, v200, 0
    v_readlane_b32 s26, v200, 1
    v_readlane_b32 s27, v200, 2
    s_min_u32 s28, s28, s26
    s_min_u32 s28, s28, s27
    s_cmp_ge_u32 s28, s29
    s_cbranch_scc1 L_free2
    s_sleep 1
    s_cmp_lt_u32 s62, 3200000
    s_cbranch_scc1 L_free1
L_free2:
    s_setpc_b64 s[30:31]
L_end:
    s_endpgm
L_comp:
    v_add_u32 v2, s26, v1
    v_and_b32 v2, 3, v2
    s_lshl_b32 s30, s25, 8
    v_lshrrev_b32 v3, 4, v1
    v_lshl_add_u32 v2, v3, 2, v2
    v_lshlrev_b32 v2, 4, v2
    v_bfe_u32 v4, v1, 2, 2
    v_mul_u32_u24 v4, 5120, v4
    v_add_u32 v36, v2, v4
    s_mul_i32 s60, s20, 61440
    s_add_u32 s36, s23, 0
    s_sub_u32 s27, s36, 3
    s_min_u32 s36, s36, s27
    s_sub_u32 s27, s36, 3
    s_min_u32 s36, s36, s27
    s_add_u32 s37, s23, 1
    s_sub_u32 s27, s37, 3
    s_min_u32 s37, s37, s27
    s_sub_u32 s27, s37, 3
    s_min_u32 s37, s37, s27
    s_add_u32 s38, s23, 2
    s_sub_u32 s27, s38, 3
    s_min_u32 s38, s38, s27
    s_sub_u32 s27, s38, 3
    s_min_u32 s38, s38, s27
    s_mul_i32 s27, s38, 20480
    s_add_u32 s62, s60, s27
    s_mul_i32 s27, s37, 20480
    s_add_u32 s61, s60, s27
    s_mul_i32 s27, s36, 20480
    s_add_u32 s60, s60, s27
    s_waitcnt lgkmcnt(0)
    s_mul_i32 s27, s22, 184320
    s_add_u32 s32, s4, s27
    s_addc_u32 s33, s5, 0
    s_mov_b32 s34, 184320
    s_mov_b32 s35, 0x20000
    s_add_u32 s31, s60, s30
    buffer_load_dwordx4 v[136:139], v36, s[32:35], s31 offen offset:0
    buffer_load_dwordx4 v[140:143], v36, s[32:35], s31 offen offset:1280
    buffer_load_dwordx4 v[144:147], v36, s[32:35], s31 offen offset:2560
    buffer_load_dwordx4 v[148:151], v36, s[32:35], s31 offen offset:3840
    s_add_u32 s31, s61, s30
    buffer_load_dwordx4 v[152:155], v36, s[32:35], s31 offen offset:0
    buffer_load_dwordx4 v[156:159], v36, s[32:35], s31 offen offset:1280
    buffer_load_dwordx4 v[160:163], v36, s[32:35], s31 offen offset:2560
    buffer_load_dwordx4 v[164:167], v36, s[32:35], s31 offen offset:3840
    s_add_u32 s31, s62, s30
    buffer_load_dwordx4 v[168:171], v36, s[32:35], s31 offen offset:0
    buffer_load_dwordx4 v[172:175], v36, s[32:35], s31 offen offset:1280
    buffer_load_dwordx4 v[176:179], v36, s[32:35], s31 offen offset:2560
    buffer_load_dwordx4 v[180:183], v36, s[32:35], s31 offen offset:3840
    s_add_u32 s30, s30, 256
    s_sub_u32 s31, s30, 1280
    s_min_u32 s30, s30, s31
    s_lshr_b32 s27, s2, 3
    s_mul_i32 s27, s27, 3
    s_add_u32 s27, s27, s20
    s_mul_hi_u32 s26, s27, 138547333
    s_mul_i32 s26, s26, 31
    s_sub_u32 s27, s27, s26
    s_mul_i32 s27, s27, 2048
    v_min_u32 v2, 15, v1
    v_lshlrev_b32 v2, 7, v2
    v_add_u32 v2, s27, v2
    global_load_dword v188, v2, s[98:99]
    s_mov_b32 s48, s18
    s_mov_b32 s49, s19
    s_mov_b32 s50, 268435456
    s_mov_b32 s51, 0x20000
    s_mov_b32 s52, 0x55555555
    s_mov_b32 s53, 0x55555555
    s_mov_b32 s54, 0xaaaaaaaa
    s_mov_b32 s55, 0xaaaaaaaa
    s_mov_b32 s56, 0x33333333
    s_mov_b32 s57, 0x33333333
    s_mov_b32 s58, 0xcccccccc
    s_mov_b32 s59, 0xcccccccc
    v_lshrrev_b32 v3, 4, v1
    v_and_b32 v4, 15, v1
    v_lshlrev_b32 v9, 4, v1
    v_lshrrev_b32 v5, 2, v4
    v_lshl_add_u32 v5, v3, 3, v5
    v_mul_u32_u24 v5, 384, v5
    v_and_b32 v6, 3, v4
    v_lshl_add_u32 v5, v6, 4, v5
    v_lshrrev_b32 v6, 3, v4
    v_xor_b32 v7, 0, v6
    v_lshl_add_u32 v184, v7, 6, v5
    v_add_u32 v10, 49152, v184
    v_xor_b32 v7, 1, v6
    v_lshl_add_u32 v185, v7, 6, v5
    v_add_u32 v11, 49152, v185
    v_mul_u32_u24 v5, 384, v4
    v_and_b32 v6, 6, v4
    v_xor_b32 v6, v6, v3
    v_lshl_add_u32 v22, v6, 4, v5
    v_xor_b32 v6, 4, v6
    v_lshl_add_u32 v23, v6, 4, v5
    v_lshrrev_b32 v5, 2, v4
    v_lshl_add_u32 v5, v3, 2, v5
    v_bfe_u32 v6, v5, 1, 2
    v_mul_u32_u24 v5, 384, v5
    v_and_b32 v7, 3, v4
    v_lshl_add_u32 v5, v7, 3, v5
    v_xor_b32 v7, 0, v6
    v_lshl_add_u32 v32, v7, 5, v5
    v_xor_b32 v7, 1, v6
    v_lshl_add_u32 v33, v7, 5, v5
    v_xor_b32 v7, 2, v6
    v_lshl_add_u32 v34, v7, 5, v5
    v_xor_b32 v7, 3, v6
    v_lshl_add_u32 v35, v7, 5, v5
    v_mov_b32 v7, 0x3f803f80
    v_accvgpr_write_b32 a228, v7
    v_accvgpr_write_b32 a229, v7
    v_accvgpr_write_b32 a230, v7
    v_accvgpr_write_b32 a231, v7
    v_accvgpr_write_b32 a0, 0
    v_accvgpr_write_b32 a1, 0
    v_accvgpr_write_b32 a2, 0
    v_accvgpr_write_b32 a3, 0
    v_accvgpr_write_b32 a4, 0
    v_accvgpr_write_b32 a5, 0
    v_accvgpr_write_b32 a6, 0
    v_accvgpr_write_b32 a7, 0
    v_accvgpr_write_b32 a8, 0
    v_accvgpr_write_b32 a9, 0
    v_accvgpr_write_b32 a10, 0
    v_accvgpr_write_b32 a11, 0
    v_accvgpr_write_b32 a12, 0
    v_accvgpr_write_b32 a13, 0
    v_accvgpr_write_b32 a14, 0
    v_accvgpr_write_b32 a15, 0
    v_accvgpr_write_b32 a16, 0
    v_accvgpr_write_b32 a17, 0
    v_accvgpr_write_b32 a18, 0
    v_accvgpr_write_b32 a19, 0
    v_accvgpr_write_b32 a20, 0
    v_accvgpr_write_b32 a21, 0
    v_accvgpr_write_b32 a22, 0
    v_accvgpr_write_b32 a23, 0
    v_accvgpr_write_b32 a24, 0
    v_accvgpr_write_b32 a25, 0
    v_accvgpr_write_b32 a26, 0
    v_accvgpr_write_b32 a27, 0
    v_accvgpr_write_b32 a28, 0
    v_accvgpr_write_b32 a29, 0
    v_accvgpr_write_b32 a30, 0
    v_accvgpr_write_b32 a31, 0
    v_accvgpr_write_b32 a32, 0
    v_accvgpr_write_b32 a33, 0
    v_accvgpr_write_b32 a34, 0
    v_accvgpr_write_b32 a35, 0
    v_accvgpr_write_b32 a36, 0
    v_accvgpr_write_b32 a37, 0
    v_accvgpr_write_b32 a38, 0
    v_accvgpr_write_b32 a39, 0
    v_accvgpr_write_b32 a40, 0
    v_accvgpr_write_b32 a41, 0
    v_accvgpr_write_b32 a42, 0
    v_accvgpr_write_b32 a43, 0
    v_accvgpr_write_b32 a44, 0
    v_accvgpr_write_b32 a45, 0
    v_accvgpr_write_b32 a46, 0
    v_accvgpr_write_b32 a47, 0
    v_accvgpr_write_b32 a48, 0
    v_accvgpr_write_b32 a49, 0
    v_accvgpr_write_b32 a50, 0
    v_accvgpr_write_b32 a51, 0
    v_accvgpr_write_b32 a52, 0
    v_accvgpr_write_b32 a53, 0
    v_accvgpr_write_b32 a54, 0
    v_accvgpr_write_b32 a55, 0
    v_accvgpr_write_b32 a56, 0
    v_accvgpr_write_b32 a57, 0
    v_accvgpr_write_b32 a58, 0
    v_accvgpr_write_b32 a59, 0
    v_accvgpr_write_b32 a60, 0
    v_accvgpr_write_b32 a61, 0
    v_accvgpr_write_b32 a62, 0
    v_accvgpr_write_b32 a63, 0
    v_accvgpr_write_b32 a64, 0
    v_accvgpr_write_b32 a65, 0
    v_accvgpr_write_b32 a66, 0
    v_accvgpr_write_b32 a67, 0
    v_accvgpr_write_b32 a68, 0
    v_accvgpr_write_b32 a69, 0
    v_accvgpr_write_b32 a70, 0
    v_accvgpr_write_b32 a71, 0
    v_accvgpr_write_b32 a72, 0
    v_accvgpr_write_b32 a73, 0
    v_accvgpr_write_b32 a74, 0
    v_accvgpr_write_b32 a75, 0
    v_accvgpr_write_b32 a76, 0
    v_accvgpr_write_b32 a77, 0
    v_accvgpr_write_b32 a78, 0
    v_accvgpr_write_b32 a79, 0
    v_accvgpr_write_b32 a80, 0
    v_accvgpr_write_b32 a81, 0
    v_accvgpr_write_b32 a82, 0
    v_accvgpr_write_b32 a83, 0
    v_accvgpr_write_b32 a84, 0
    v_accvgpr_write_b32 a85, 0
    v_accvgpr_write_b32 a86, 0
    v_accvgpr_write_b32 a87, 0
    v_accvgpr_write_b32 a88, 0
    v_accvgpr_write_b32 a89, 0
    v_accvgpr_write_b32 a90, 0
    v_accvgpr_write_b32 a91, 0
    v_accvgpr_write_b32 a92, 0
    v_accvgpr_write_b32 a93, 0
    v_accvgpr_write_b32 a94, 0
    v_accvgpr_write_b32 a95, 0
    v_accvgpr_write_b32 a96, 0
    v_accvgpr_write_b32 a97, 0
    v_accvgpr_write_b32 a98, 0
    v_accvgpr_write_b32 a99, 0
    v_accvgpr_write_b32 a100, 0
    v_accvgpr_write_b32 a101, 0
    v_accvgpr_write_b32 a102, 0
    v_accvgpr_write_b32 a103, 0
    v_accvgpr_write_b32 a104, 0
    v_accvgpr_write_b32 a105, 0
    v_accvgpr_write_b32 a106, 0
    v_accvgpr_write_b32 a107, 0
    v_accvgpr_write_b32 a108, 0
    v_accvgpr_write_b32 a109, 0
    v_accvgpr_write_b32 a110, 0
    v_accvgpr_write_b32 a111, 0
    v_accvgpr_write_b32 a112, 0
    v_accvgpr_write_b32 a113, 0
    v_accvgpr_write_b32 a114, 0
    v_accvgpr_write_b32 a115, 0
    v_accvgpr_write_b32 a116, 0
    v_accvgpr_write_b32 a117, 0
    v_accvgpr_write_b32 a118, 0
    v_accvgpr_write_b32 a119, 0
    v_accvgpr_write_b32 a120, 0
    v_accvgpr_write_b32 a121, 0
    v_accvgpr_write_b32 a122, 0
    v_accvgpr_write_b32 a123, 0
    v_accvgpr_write_b32 a124, 0
    v_accvgpr_write_b32 a125, 0
    v_accvgpr_write_b32 a126, 0
    v_accvgpr_write_b32 a127, 0
    v_accvgpr_write_b32 a128, 0
    v_accvgpr_write_b32 a129, 0
    v_accvgpr_write_b32 a130, 0
    v_accvgpr_write_b32 a131, 0
    v_accvgpr_write_b32 a132, 0
    v_accvgpr_write_b32 a133, 0
    v_accvgpr_write_b32 a134, 0
    v_accvgpr_write_b32 a135, 0
    v_accvgpr_write_b32 a136, 0
    v_accvgpr_write_b32 a137, 0
    v_accvgpr_write_b32 a138, 0
    v_accvgpr_write_b32 a139, 0
    v_accvgpr_write_b32 a140, 0
    v_accvgpr_write_b32 a141, 0
    v_accvgpr_write_b32 a142, 0
    v_accvgpr_write_b32 a143, 0
    s_mov_b32 s25, 61440
    s_mov_b32 s63, 0
    s_lshl_b32 s27, s20, 8
    s_add_u32 s27, s27, 160256
    v_lshlrev_b32 v220, 2, v1
    v_add_u32 v220, s27, v220
    v_mov_b32 v221, 20
    ds_write_b32 v220, v221
    v_mov_b32 v222, 160000
    s_mov_b32 s28, 0
    s_waitcnt vmcnt(9)
    s_mov_b64 vcc, s[52:53]
    v_cndmask_b32_dpp v88, v140, v136, vcc quad_perm:[1,0,3,2] row_mask:0xf bank_mask:0xf
    v_cndmask_b32_dpp v89, v141, v137, vcc quad_perm:[1,0,3,2] row_mask:0xf bank_mask:0xf
    v_cndmask_b32_dpp v90, v142, v138, vcc quad_perm:[1,0,3,2] row_mask:0xf bank_mask:0xf
    v_cndmask_b32_dpp v91, v143, v139, vcc quad_perm:[1,0,3,2] row_mask:0xf bank_mask:0xf
    v_cndmask_b32_dpp v96, v148, v144, vcc quad_perm:[1,0,3,2] row_mask:0xf bank_mask:0xf
    v_cndmask_b32_dpp v97, v149, v145, vcc quad_perm:[1,0,3,2] row_mask:0xf bank_mask:0xf
    v_cndmask_b32_dpp v98, v150, v146, vcc quad_perm:[1,0,3,2] row_mask:0xf bank_mask:0xf
    v_cndmask_b32_dpp v99, v151, v147, vcc quad_perm:[1,0,3,2] row_mask:0xf bank_mask:0xf
    s_mov_b64 vcc, s[54:55]
    v_cndmask_b32_dpp v92, v136, v140, vcc quad_perm:[1,0,3,2] row_mask:0xf bank_mask:0xf
    v_cndmask_b32_dpp v93, v137, v141, vcc quad_perm:[1,0,3,2] row_mask:0xf bank_mask:0xf
    v_cndmask_b32_dpp v94, v138, v142, vcc quad_perm:[1,0,3,2] row_mask:0xf bank_mask:0xf
    v_cndmask_b32_dpp v95, v139, v143, vcc quad_perm:[1,0,3,2] row_mask:0xf bank_mask:0xf
    v_cndmask_b32_dpp v100, v144, v148, vcc quad_perm:[1,0,3,2] row_mask:0xf bank_mask:0xf
    v_cndmask_b32_dpp v101, v145, v149, vcc quad_perm:[1,0,3,2] row_mask:0xf bank_mask:0xf
    v_cndmask_b32_dpp v102, v146, v150, vcc quad_perm:[1,0,3,2] row_mask:0xf bank_mask:0xf
    v_cndmask_b32_dpp v103, v147, v151, vcc quad_perm:[1,0,3,2] row_mask:0xf bank_mask:0xf
    s_add_u32 s31, s60, s30
    buffer_load_dwordx4 v[136:139], v36, s[32:35], s31 offen offset:0
    buffer_load_dwordx4 v[140:143], v36, s[32:35], s31 offen offset:1280
    buffer_load_dwordx4 v[144:147], v36, s[32:35], s31 offen offset:2560
    buffer_load_dwordx4 v[148:151], v36, s[32:35], s31 offen offset:3840
    s_waitcnt vmcnt(9)
    s_mov_b64 vcc, s[52:53]
    v_cndmask_b32_dpp v104, v156, v152, vcc quad_perm:[1,0,3,2] row_mask:0xf bank_mask:0xf
    v_cndmask_b32_dpp v105, v157, v153, vcc quad_perm:[1,0,3,2] row_mask:0xf bank_mask:0xf
    v_cndmask_b32_dpp v106, v158, v154, vcc quad_perm:[1,0,3,2] row_mask:0xf bank_mask:0xf
    v_cndmask_b32_dpp v107, v159, v155, vcc quad_perm:[1,0,3,2] row_mask:0xf bank_mask:0xf
    v_cndmask_b32_dpp v112, v164, v160, vcc quad_perm:[1,0,3,2] row_mask:0xf bank_mask:0xf
    v_cndmask_b32_dpp v113, v165, v161, vcc quad_perm:[1,0,3,2] row_mask:0xf bank_mask:0xf
    v_cndmask_b32_dpp v114, v166, v162, vcc quad_perm:[1,0,3,2] row_mask:0xf bank_mask:0xf
    v_cndmask_b32_dpp v115, v167, v163, vcc quad_perm:[1,0,3,2] row_mask:0xf bank_mask:0xf
    s_mov_b64 vcc, s[54:55]
    v_cndmask_b32_dpp v108, v152, v156, vcc quad_perm:[1,0,3,2] row_mask:0xf bank_mask:0xf
    v_cndmask_b32_dpp v109, v153, v157, vcc quad_perm:[1,0,3,2] row_mask:0xf bank_mask:0xf
    v_cndmask_b32_dpp v110, v154, v158, vcc quad_perm:[1,0,3,2] row_mask:0xf bank_mask:0xf
    v_cndmask_b32_dpp v111, v155, v159, vcc quad_perm:[1,0,3,2] row_mask:0xf bank_mask:0xf
    v_cndmask_b32_dpp v116, v160, v164, vcc quad_perm:[1,0,3,2] row_mask:0xf bank_mask:0xf
    v_cndmask_b32_dpp v117, v161, v165, vcc quad_perm:[1,0,3,2] row_mask:0xf bank_mask:0xf
    v_cndmask_b32_dpp v118, v162, v166, vcc quad_perm:[1,0,3,2] row_mask:0xf bank_mask:0xf
    v_cndmask_b32_dpp v119, v163, v167, vcc quad_perm:[1,0,3,2] row_mask:0xf bank_mask:0xf
    s_add_u32 s31, s61, s30
    buffer_load_dwordx4 v[152:155], v36, s[32:35], s31 offen offset:0
    buffer_load_dwordx4 v[156:159], v36, s[32:35], s31 offen offset:1280
    buffer_load_dwordx4 v[160:163], v36, s[32:35], s31 offen offset:2560
    buffer_load_dwordx4 v[164:167], v36, s[32:35], s31 offen offset:3840
    s_waitcnt vmcnt(9)
    s_mov_b64 vcc, s[52:53]
    v_cndmask_b32_dpp v120, v172, v168, vcc quad_perm:[1,0,3,2] row_mask:0xf bank_mask:0xf
    v_cndmask_b32_dpp v121, v173, v169, vcc quad_perm:[1,0,3,2] row_mask:0xf bank_mask:0xf
    v_cndmask_b32_dpp v122, v174, v170, vcc quad_perm:[1,0,3,2] row_mask:0xf bank_mask:0xf
    v_cndmask_b32_dpp v123, v175, v171, vcc quad_perm:[1,0,3,2] row_mask:0xf bank_mask:0xf
    v_cndmask_b32_dpp v128, v180, v176, vcc quad_perm:[1,0,3,2] row_mask:0xf bank_mask:0xf
    v_cndmask_b32_dpp v129, v181, v177, vcc quad_perm:[1,0,3,2] row_mask:0xf bank_mask:0xf
    v_cndmask_b32_dpp v130, v182, v178, vcc quad_perm:[1,0,3,2] row_mask:0xf bank_mask:0xf
    v_cndmask_b32_dpp v131, v183, v179, vcc quad_perm:[1,0,3,2] row_mask:0xf bank_mask:0xf
    s_mov_b64 vcc, s[54:55]
    v_cndmask_b32_dpp v124, v168, v172, vcc quad_perm:[1,0,3,2] row_mask:0xf bank_mask:0xf
    v_cndmask_b32_dpp v125, v169, v173, vcc quad_perm:[1,0,3,2] row_mask:0xf bank_mask:0xf
    v_cndmask_b32_dpp v126, v170, v174, vcc quad_perm:[1,0,3,2] row_mask:0xf bank_mask:0xf
    v_cndmask_b32_dpp v127, v171, v175, vcc quad_perm:[1,0,3,2] row_mask:0xf bank_mask:0xf
    v_cndmask_b32_dpp v132, v176, v180, vcc quad_perm:[1,0,3,2] row_mask:0xf bank_mask:0xf
    v_cndmask_b32_dpp v133, v177, v181, vcc quad_perm:[1,0,3,2] row_mask:0xf bank_mask:0xf
    v_cndmask_b32_dpp v134, v178, v182, vcc quad_perm:[1,0,3,2] row_mask:0xf bank_mask:0xf
    v_cndmask_b32_dpp v135, v179, v183, vcc quad_perm:[1,0,3,2] row_mask:0xf bank_mask:0xf
    s_add_u32 s31, s62, s30
    buffer_load_dwordx4 v[168:171], v36, s[32:35], s31 offen offset:0
    buffer_load_dwordx4 v[172:175], v36, s[32:35], s31 offen offset:1280
    buffer_load_dwordx4 v[176:179], v36, s[32:35], s31 offen offset:2560
    buffer_load_dwordx4 v[180:183], v36, s[32:35], s31 offen offset:3840
    s_add_u32 s30, s30, 256
    s_sub_u32 s31, s30, 1280
    s_min_u32 s30, s30, s31
    s_mov_b64 vcc, s[56:57]
    v_cndmask_b32_dpp v40, v96, v88, vcc quad_perm:[2,3,0,1] row_mask:0xf bank_mask:0xf
    v_cndmask_b32_dpp v41, v97, v89, vcc quad_perm:[2,3,0,1] row_mask:0xf bank_mask:0xf
    v_cndmask_b32_dpp v42, v98, v90, vcc quad_perm:[2,3,0,1] row_mask:0xf bank_mask:0xf
    v_cndmask_b32_dpp v43, v99, v91, vcc quad_perm:[2,3,0,1] row_mask:0xf bank_mask:0xf
    v_cndmask_b32_dpp v44, v100, v92, vcc quad_perm:[2,3,0,1] row_mask:0xf bank_mask:0xf
    v_cndmask_b32_dpp v45, v101, v93, vcc quad_perm:[2,3,0,1] row_mask:0xf bank_mask:0xf
    v_cndmask_b32_dpp v46, v102, v94, vcc quad_perm:[2,3,0,1] row_mask:0xf bank_mask:0xf
    v_cndmask_b32_dpp v47, v103, v95, vcc quad_perm:[2,3,0,1] row_mask:0xf bank_mask:0xf
    v_cndmask_b32_dpp v56, v112, v104, vcc quad_perm:[2,3,0,1] row_mask:0xf bank_mask:0xf
    v_cndmask_b32_dpp v57, v113, v105, vcc quad_perm:[2,3,0,1] row_mask:0xf bank_mask:0xf
    v_cndmask_b32_dpp v58, v114, v106, vcc quad_perm:[2,3,0,1] row_mask:0xf bank_mask:0xf
    v_cndmask_b32_dpp v59, v115, v107, vcc quad_perm:[2,3,0,1] row_mask:0xf bank_mask:0xf
    v_cndmask_b32_dpp v60, v116, v108, vcc quad_perm:[2,3,0,1] row_mask:0xf bank_mask:0xf
    v_cndmask_b32_dpp v61, v117, v109, vcc quad_perm:[2,3,0,1] row_mask:0xf bank_mask:0xf
    v_cndmask_b32_dpp v62, v118, v110, vcc quad_perm:[2,3,0,1] row_mask:0xf bank_mask:0xf
    v_cndmask_b32_dpp v63, v119, v111, vcc quad_perm:[2,3,0,1] row_mask:0xf bank_mask:0xf
    v_cndmask_b32_dpp v72, v128, v120, vcc quad_perm:[2,3,0,1] row_mask:0xf bank_mask:0xf
    v_cndmask_b32_dpp v73, v129, v121, vcc quad_perm:[2,3,0,1] row_mask:0xf bank_mask:0xf
    v_cndmask_b32_dpp v74, v130, v122, vcc quad_perm:[2,3,0,1] row_mask:0xf bank_mask:0xf
    v_cndmask_b32_dpp v75, v131, v123, vcc quad_perm:[2,3,0,1] row_mask:0xf bank_mask:0xf
    v_cndmask_b32_dpp v76, v132, v124, vcc quad_perm:[2,3,0,1] row_mask:0xf bank_mask:0xf
    v_cndmask_b32_dpp v77, v133, v125, vcc quad_perm:[2,3,0,1] row_mask:0xf bank_mask:0xf
    v_cndmask_b32_dpp v78, v134, v126, vcc quad_perm:[2,3,0,1] row_mask:0xf bank_mask:0xf
    v_cndmask_b32_dpp v79, v135, v127, vcc quad_perm:[2,3,0,1] row_mask:0xf bank_mask:0xf
    s_waitcnt lgkmcnt(0)
    s_barrier
    ds_read_b64_tr_b16 v[224:225], v10 offset:0
    ds_read_b64_tr_b16 v[226:227], v10 offset:1536
    ds_read_b64_tr_b16 v[228:229], v10 offset:8
    ds_read_b64_tr_b16 v[230:231], v10 offset:1544
    ds_read_b64_tr_b16 v[232:233], v11 offset:0
    ds_read_b64_tr_b16 v[234:235], v11 offset:1536
    ds_read_b64_tr_b16 v[236:237], v11 offset:8
    ds_read_b64_tr_b16 v[238:239], v11 offset:1544
    ds_read_b64_tr_b16 v[240:241], v10 offset:128
    ds_read_b64_tr_b16 v[242:243], v10 offset:1664
    ds_read_b64_tr_b16 v[244:245], v10 offset:136
    ds_read_b64_tr_b16 v[246:247], v10 offset:1672
L_A:
    s_waitcnt lgkmcnt(8)
    v_mfma_f32_16x16x32_bf16 a[0:3], v[224:227], v[40:43], a[0:3]
    v_add_u32 v14, s25, v184
    v_add_u32 v15, s25, v185
    v_mfma_f32_16x16x32_bf16 a[4:7], v[224:227], v[56:59], a[4:7]
    ds_read_b64_tr_b16 v[248:249], v11 offset:128
    s_add_u32 s25, s25, 12288
    v_mfma_f32_16x16x32_bf16 a[8:11], v[224:227], v[72:75], a[8:11]
    ds_read_b64_tr_b16 v[250:251], v11 offset:1664
    s_sub_u32 s26, s25, 73728
    v_mfma_f32_16x16x32_bf16 a[12:15], v[228:231], v[40:43], a[12:15]
    s_min_u32 s25, s25, s26
    s_mov_b64 vcc, s[58:59]
    v_mfma_f32_16x16x32_bf16 a[16:19], v[228:231], v[56:59], a[16:19]
    ds_read_b64_tr_b16 v[252:253], v11 offset:136
    v_cndmask_b32_dpp v48, v88, v96, vcc quad_perm:[2,3,0,1] row_mask:0xf bank_mask:0xf
    v_mfma_f32_16x16x32_bf16 a[20:23], v[228:231], v[72:75], a[20:23]
    ds_read_b64_tr_b16 v[254:255], v11 offset:1672
    s_waitcnt lgkmcnt(8)
    v_mfma_f32_16x16x32_bf16 a[24:27], v[232:235], v[40:43], a[24:27]
    v_cndmask_b32_dpp v49, v89, v97, vcc quad_perm:[2,3,0,1] row_mask:0xf bank_mask:0xf
    v_cndmask_b32_dpp v50, v90, v98, vcc quad_perm:[2,3,0,1] row_mask:0xf bank_mask:0xf
    v_mfma_f32_16x16x32_bf16 a[28:31], v[232:235], v[56:59], a[28:31]
    ds_read_b64_tr_b16 v[224:225], v10 offset:256
    v_cndmask_b32_dpp v51, v91, v99, vcc quad_perm:[2,3,0,1] row_mask:0xf bank_mask:0xf
    v_mfma_f32_16x16x32_bf16 a[32:35], v[232:235], v[72:75], a[32:35]
    ds_read_b64_tr_b16 v[226:227], v10 offset:1792
    v_cndmask_b32_dpp v52, v92, v100, vcc quad_perm:[2,3,0,1] row_mask:0xf bank_mask:0xf
    v_mfma_f32_16x16x32_bf16 a[36:39], v[236:239], v[40:43], a[36:39]
    v_cndmask_b32_dpp v53, v93, v101, vcc quad_perm:[2,3,0,1] row_mask:0xf bank_mask:0xf
    v_cndmask_b32_dpp v54, v94, v102, vcc quad_perm:[2,3,0,1] row_mask:0xf bank_mask:0xf
    v_mfma_f32_16x16x32_bf16 a[40:43], v[236:239], v[56:59], a[40:43]
    ds_read_b64_tr_b16 v[228:229], v10 offset:264
    v_cndmask_b32_dpp v55, v95, v103, vcc quad_perm:[2,3,0,1] row_mask:0xf bank_mask:0xf
    v_mfma_f32_16x16x32_bf16 a[44:47], v[236:239], v[72:75], a[44:47]
    ds_read_b64_tr_b16 v[230:231], v10 offset:1800
    s_waitcnt lgkmcnt(8)
    v_mfma_f32_16x16x32_bf16 a[48:51], v[240:243], v[40:43], a[48:51]
    v_cndmask_b32_dpp v64, v104, v112, vcc quad_perm:[2,3,0,1] row_mask:0xf bank_mask:0xf
    v_cndmask_b32_dpp v65, v105, v113, vcc quad_perm:[2,3,0,1] row_mask:0xf bank_mask:0xf
    v_mfma_f32_16x16x32_bf16 a[52:55], v[240:243], v[56:59], a[52:55]
    ds_read_b64_tr_b16 v[232:233], v11 offset:256
    v_cndmask_b32_dpp v66, v106, v114, vcc quad_perm:[2,3,0,1] row_mask:0xf bank_mask:0xf
    v_mfma_f32_16x16x32_bf16 a[56:59], v[240:243], v[72:75], a[56:59]
    ds_read_b64_tr_b16 v[234:235], v11 offset:1792
    v_cndmask_b32_dpp v67, v107, v115, vcc quad_perm:[2,3,0,1] row_mask:0xf bank_mask:0xf
    v_mfma_f32_16x16x32_bf16 a[60:63], v[244:247], v[40:43], a[60:63]
    v_cndmask_b32_dpp v68, v108, v116, vcc quad_perm:[2,3,0,1] row_mask:0xf bank_mask:0xf
    v_mfma_f32_16x16x32_bf16 a[64:67], v[244:247], v[56:59], a[64:67]
    ds_read_b64_tr_b16 v[236:237], v11 offset:264
    v_mfma_f32_16x16x32_bf16 a[68:71], v[244:247], v[72:75], a[68:71]
    ds_read_b64_tr_b16 v[238:239], v11 offset:1800
    s_waitcnt lgkmcnt(8)
    v_mfma_f32_16x16x32_bf16 a[72:75], v[248:251], v[40:43], a[72:75]
    v_cndmask_b32_dpp v69, v109, v117, vcc quad_perm:[2,3,0,1] row_mask:0xf bank_mask:0xf
    v_cndmask_b32_dpp v70, v110, v118, vcc quad_perm:[2,3,0,1] row_mask:0xf bank_mask:0xf
    v_mfma_f32_16x16x32_bf16 a[76:79], v[248:251], v[56:59], a[76:79]
    ds_read_b64_tr_b16 v[240:241], v14 offset:0
    v_cndmask_b32_dpp v71, v111, v119, vcc quad_perm:[2,3,0,1] row_mask:0xf bank_mask:0xf
    v_mfma_f32_16x16x32_bf16 a[80:83], v[248:251], v[72:75], a[80:83]
    ds_read_b64_tr_b16 v[242:243], v14 offset:1536
    v_cndmask_b32_dpp v80, v120, v128, vcc quad_perm:[2,3,0,1] row_mask:0xf bank_mask:0xf
    v_mfma_f32_16x16x32_bf16 a[84:87], v[252:255], v[40:43], a[84:87]
    v_cndmask_b32_dpp v81, v121, v129, vcc quad_perm:[2,3,0,1] row_mask:0xf bank_mask:0xf
    v_mfma_f32_16x16x32_bf16 a[88:91], v[252:255], v[56:59], a[88:91]
    ds_read_b64_tr_b16 v[244:245], v14 offset:8
    v_mfma_f32_16x16x32_bf16 a[92:95], v[252:255], v[72:75], a[92:95]
    ds_read_b64_tr_b16 v[246:247], v14 offset:1544
    s_waitcnt lgkmcnt(8)
    v_mfma_f32_16x16x32_bf16 a[96:99], v[224:227], v[40:43], a[96:99]
    v_cndmask_b32_dpp v82, v122, v130, vcc quad_perm:[2,3,0,1] row_mask:0xf bank_mask:0xf
    v_cndmask_b32_dpp v83, v123, v131, vcc quad_perm:[2,3,0,1] row_mask:0xf bank_mask:0xf
    v_mfma_f32_16x16x32_bf16 a[100:103], v[224:227], v[56:59], a[100:103]
    ds_read_b64_tr_b16 v[248:249], v15 offset:0
    v_cndmask_b32_dpp v84, v124, v132, vcc quad_perm:[2,3,0,1] row_mask:0xf bank_mask:0xf
    v_mfma_f32_16x16x32_bf16 a[104:107], v[224:227], v[72:75], a[104:107]
    ds_read_b64_tr_b16 v[250:251], v15 offset:1536
    v_cndmask_b32_dpp v85, v125, v133, vcc quad_perm:[2,3,0,1] row_mask:0xf bank_mask:0xf
    v_mfma_f32_16x16x32_bf16 a[108:111], v[228:231], v[40:43], a[108:111]
    v_mfma_f32_16x16x32_bf16 a[112:115], v[228:231], v[56:59], a[112:115]
    ds_read_b64_tr_b16 v[252:253], v15 offset:8
    v_cndmask_b32_dpp v86, v126, v134, vcc quad_perm:[2,3,0,1] row_mask:0xf bank_mask:0xf
    v_mfma_f32_16x16x32_bf16 a[116:119], v[228:231], v[72:75], a[116:119]
    ds_read_b64_tr_b16 v[254:255], v15 offset:1544
    s_waitcnt lgkmcnt(8)
    v_mfma_f32_16x16x32_bf16 a[120:123], v[232:235], v[40:43], a[120:123]
    v_cndmask_b32_dpp v87, v127, v135, vcc quad_perm:[2,3,0,1] row_mask:0xf bank_mask:0xf
    v_mfma_f32_16x16x32_bf16 a[124:127], v[232:235], v[56:59], a[124:127]
    ds_read_b64_tr_b16 v[224:225], v14 offset:128
    v_mfma_f32_16x16x32_bf16 a[128:131], v[232:235], v[72:75], a[128:131]
    ds_read_b64_tr_b16 v[226:227], v14 offset:1664
    v_mfma_f32_16x16x32_bf16 a[132:135], v[236:239], v[40:43], a[132:135]
    s_barrier
    v_mfma_f32_16x16x32_bf16 a[136:139], v[236:239], v[56:59], a[136:139]
    ds_read_b64_tr_b16 v[228:229], v14 offset:136
    v_mfma_f32_16x16x32_bf16 a[140:143], v[236:239], v[72:75], a[140:143]
    ds_read_b64_tr_b16 v[230:231], v14 offset:1672
    s_waitcnt lgkmcnt(8)
    v_mfma_f32_16x16x32_bf16 a[0:3], v[240:243], v[44:47], a[0:3]
    v_add_u32 v10, s25, v184
    v_add_u32 v11, s25, v185
    v_mfma_f32_16x16x32_bf16 a[4:7], v[240:243], v[60:63], a[4:7]
    ds_read_b64_tr_b16 v[232:233], v15 offset:128
    s_add_u32 s25, s25, 12288
    v_mfma_f32_16x16x32_bf16 a[8:11], v[240:243], v[76:79], a[8:11]
    ds_read_b64_tr_b16 v[234:235], v15 offset:1664
    s_sub_u32 s26, s25, 73728
    v_mfma_f32_16x16x32_bf16 a[12:15], v[244:247], v[44:47], a[12:15]
    s_min_u32 s25, s25, s26
    v_mfma_f32_16x16x32_bf16 a[16:19], v[244:247], v[60:63], a[16:19]
    ds_read_b64_tr_b16 v[236:237], v15 offset:136
    v_mfma_f32_16x16x32_bf16 a[20:23], v[244:247], v[76:79], a[20:23]
    ds_read_b64_tr_b16 v[238:239], v15 offset:1672
    s_waitcnt lgkmcnt(8)
    v_mfma_f32_16x16x32_bf16 a[24:27], v[248:251], v[44:47], a[24:27]
    v_mfma_f32_16x16x32_bf16 a[28:31], v[248:251], v[60:63], a[28:31]
    ds_read_b64_tr_b16 v[240:241], v14 offset:256
    v_mfma_f32_16x16x32_bf16 a[32:35], v[248:251], v[76:79], a[32:35]
    ds_read_b64_tr_b16 v[242:243], v14 offset:1792
    v_mfma_f32_16x16x32_bf16 a[36:39], v[252:255], v[44:47], a[36:39]
    v_mfma_f32_16x16x32_bf16 a[40:43], v[252:255], v[60:63], a[40:43]
    ds_read_b64_tr_b16 v[244:245], v14 offset:264
    v_mfma_f32_16x16x32_bf16 a[44:47], v[252:255], v[76:79], a[44:47]
    ds_read_b64_tr_b16 v[246:247], v14 offset:1800
    s_waitcnt lgkmcnt(8)
    v_mfma_f32_16x16x32_bf16 a[48:51], v[224:227], v[44:47], a[48:51]
    v_mfma_f32_16x16x32_bf16 a[52:55], v[224:227], v[60:63], a[52:55]
    ds_read_b64_tr_b16 v[248:249], v15 offset:256
    v_mfma_f32_16x16x32_bf16 a[56:59], v[224:227], v[76:79], a[56:59]
    ds_read_b64_tr_b16 v[250:251], v15 offset:1792
    v_mfma_f32_16x16x32_bf16 a[60:63], v[228:231], v[44:47], a[60:63]
    v_mfma_f32_16x16x32_bf16 a[64:67], v[228:231], v[60:63], a[64:67]
    ds_read_b64_tr_b16 v[252:253], v15 offset:264
    v_mfma_f32_16x16x32_bf16 a[68:71], v[228:231], v[76:79], a[68:71]
    ds_read_b64_tr_b16 v[254:255], v15 offset:1800
    s_waitcnt lgkmcnt(8)
    v_mfma_f32_16x16x32_bf16 a[72:75], v[232:235], v[44:47], a[72:75]
    s_cmp_lt_u32 s63, 3
    s_cbranch_scc1 L_xw
    s_waitcnt vmcnt(0)
L_xw:
    s_waitcnt vmcnt(8)
    v_mfma_f32_16x16x32_bf16 a[76:79], v[232:235], v[60:63], a[76:79]
    ds_read_b64_tr_b16 v[224:225], v10 offset:0
    s_mov_b64 vcc, s[52:53]
    v_mfma_f32_16x16x32_bf16 a[80:83], v[232:235], v[76:79], a[80:83]
    ds_read_b64_tr_b16 v[226:227], v10 offset:1536
    v_cndmask_b32_dpp v88, v140, v136, vcc quad_perm:[1,0,3,2] row_mask:0xf bank_mask:0xf
    v_mfma_f32_16x16x32_bf16 a[84:87], v[236:239], v[44:47], a[84:87]
    v_cndmask_b32_dpp v89, v141, v137, vcc quad_perm:[1,0,3,2] row_mask:0xf bank_mask:0xf
    v_cndmask_b32_dpp v90, v142, v138, vcc quad_perm:[1,0,3,2] row_mask:0xf bank_mask:0xf
    v_mfma_f32_16x16x32_bf16 a[88:91], v[236:239], v[60:63], a[88:91]
    ds_read_b64_tr_b16 v[228:229], v10 offset:8
    v_cndmask_b32_dpp v91, v143, v139, vcc quad_perm:[1,0,3,2] row_mask:0xf bank_mask:0xf
    v_mfma_f32_16x16x32_bf16 a[92:95], v[236:239], v[76:79], a[92:95]
    ds_read_b64_tr_b16 v[230:231], v10 offset:1544
    s_waitcnt lgkmcnt(8)
    v_mfma_f32_16x16x32_bf16 a[96:99], v[240:243], v[44:47], a[96:99]
    v_cndmask_b32_dpp v96, v148, v144, vcc quad_perm:[1,0,3,2] row_mask:0xf bank_mask:0xf
    v_cndmask_b32_dpp v97, v149, v145, vcc quad_perm:[1,0,3,2] row_mask:0xf bank_mask:0xf
    v_mfma_f32_16x16x32_bf16 a[100:103], v[240:243], v[60:63], a[100:103]
    ds_read_b64_tr_b16 v[232:233], v11 offset:0
    v_cndmask_b32_dpp v98, v150, v146, vcc quad_perm:[1,0,3,2] row_mask:0xf bank_mask:0xf
    v_mfma_f32_16x16x32_bf16 a[104:107], v[240:243], v[76:79], a[104:107]
    ds_read_b64_tr_b16 v[234:235], v11 offset:1536
    v_cndmask_b32_dpp v99, v151, v147, vcc quad_perm:[1,0,3,2] row_mask:0xf bank_mask:0xf
    v_mfma_f32_16x16x32_bf16 a[108:111], v[244:247], v[44:47], a[108:111]
    s_mov_b64 vcc, s[54:55]
    v_cndmask_b32_dpp v92, v136, v140, vcc quad_perm:[1,0,3,2] row_mask:0xf bank_mask:0xf
    v_mfma_f32_16x16x32_bf16 a[112:115], v[244:247], v[60:63], a[112:115]
    ds_read_b64_tr_b16 v[236:237], v11 offset:8
    v_cndmask_b32_dpp v93, v137, v141, vcc quad_perm:[1,0,3,2] row_mask:0xf bank_mask:0xf
    v_mfma_f32_16x16x32_bf16 a[116:119], v[244:247], v[76:79], a[116:119]
    ds_read_b64_tr_b16 v[238:239], v11 offset:1544
    s_waitcnt lgkmcnt(8)
    v_mfma_f32_16x16x32_bf16 a[120:123], v[248:251], v[44:47], a[120:123]
    v_cndmask_b32_dpp v94, v138, v142, vcc quad_perm:[1,0,3,2] row_mask:0xf bank_mask:0xf
    v_cndmask_b32_dpp v95, v139, v143, vcc quad_perm:[1,0,3,2] row_mask:0xf bank_mask:0xf
    v_mfma_f32_16x16x32_bf16 a[124:127], v[248:251], v[60:63], a[124:127]
    ds_read_b64_tr_b16 v[240:241], v10 offset:128
    v_cndmask_b32_dpp v100, v144, v148, vcc quad_perm:[1,0,3,2] row_mask:0xf bank_mask:0xf
    v_mfma_f32_16x16x32_bf16 a[128:131], v[248:251], v[76:79], a[128:131]
    ds_read_b64_tr_b16 v[242:243], v10 offset:1664
    v_cndmask_b32_dpp v101, v145, v149, vcc quad_perm:[1,0,3,2] row_mask:0xf bank_mask:0xf
    v_mfma_f32_16x16x32_bf16 a[132:135], v[252:255], v[44:47], a[132:135]
    s_barrier
    v_cndmask_b32_dpp v102, v146, v150, vcc quad_perm:[1,0,3,2] row_mask:0xf bank_mask:0xf
    v_mfma_f32_16x16x32_bf16 a[136:139], v[252:255], v[60:63], a[136:139]
    ds_read_b64_tr_b16 v[244:245], v10 offset:136
    v_cndmask_b32_dpp v103, v147, v151, vcc quad_perm:[1,0,3,2] row_mask:0xf bank_mask:0xf
    v_mfma_f32_16x16x32_bf16 a[140:143], v[252:255], v[76:79], a[140:143]
    ds_read_b64_tr_b16 v[246:247], v10 offset:1672
    s_waitcnt lgkmcnt(8)
    v_mfma_f32_16x16x32_bf16 a[0:3], v[224:227], v[48:51], a[0:3]
    v_add_u32 v14, s25, v184
    v_add_u32 v15, s25, v185
    s_cmp_ge_u32 s63, 3
    s_cbranch_scc1 L_xs0
    s_add_u32 s31, s60, s30
    buffer_load_dwordx4 v[136:139], v36, s[32:35], s31 offen offset:0
    buffer_load_dwordx4 v[140:143], v36, s[32:35], s31 offen offset:1280
    buffer_load_dwordx4 v[144:147], v36, s[32:35], s31 offen offset:2560
    buffer_load_dwordx4 v[148:151], v36, s[32:35], s31 offen offset:3840
L_xs0:
    v_mfma_f32_16x16x32_bf16 a[4:7], v[224:227], v[64:67], a[4:7]
    ds_read_b64_tr_b16 v[248:249], v11 offset:128
    s_add_u32 s25, s25, 12288
    v_mfma_f32_16x16x32_bf16 a[8:11], v[224:227], v[80:83], a[8:11]
    ds_read_b64_tr_b16 v[250:251], v11 offset:1664
    s_sub_u32 s26, s25, 73728
    v_mfma_f32_16x16x32_bf16 a[12:15], v[228:231], v[48:51], a[12:15]
    s_min_u32 s25, s25, s26
    s_waitcnt vmcnt(8)
    v_mfma_f32_16x16x32_bf16 a[16:19], v[228:231], v[64:67], a[16:19]
    ds_read_b64_tr_b16 v[252:253], v11 offset:136
    s_mov_b64 vcc, s[52:53]
    v_mfma_f32_16x16x32_bf16 a[20:23], v[228:231], v[80:83], a[20:23]
    ds_read_b64_tr_b16 v[254:255], v11 offset:1672
    s_waitcnt lgkmcnt(8)
    v_mfma_f32_16x16x32_bf16 a[24:27], v[232:235], v[48:51], a[24:27]
    v_cndmask_b32_dpp v104, v156, v152, vcc quad_perm:[1,0,3,2] row_mask:0xf bank_mask:0xf
    v_cndmask_b32_dpp v105, v157, v153, vcc quad_perm:[1,0,3,2] row_mask:0xf bank_mask:0xf
    v_mfma_f32_16x16x32_bf16 a[28:31], v[232:235], v[64:67], a[28:31]
    ds_read_b64_tr_b16 v[224:225], v10 offset:256
    v_cndmask_b32_dpp v106, v158, v154, vcc quad_perm:[1,0,3,2] row_mask:0xf bank_mask:0xf
    v_mfma_f32_16x16x32_bf16 a[32:35], v[232:235], v[80:83], a[32:35]
    ds_read_b64_tr_b16 v[226:227], v10 offset:1792
    v_cndmask_b32_dpp v107, v159, v155, vcc quad_perm:[1,0,3,2] row_mask:0xf bank_mask:0xf
    v_mfma_f32_16x16x32_bf16 a[36:39], v[236:239], v[48:51], a[36:39]
    v_cndmask_b32_dpp v112, v164, v160, vcc quad_perm:[1,0,3,2] row_mask:0xf bank_mask:0xf
    v_cndmask_b32_dpp v113, v165, v161, vcc quad_perm:[1,0,3,2] row_mask:0xf bank_mask:0xf
    v_mfma_f32_16x16x32_bf16 a[40:43], v[236:239], v[64:67], a[40:43]
    ds_read_b64_tr_b16 v[228:229], v10 offset:264
    v_cndmask_b32_dpp v114, v166, v162, vcc quad_perm:[1,0,3,2] row_mask:0xf bank_mask:0xf
    v_mfma_f32_16x16x32_bf16 a[44:47], v[236:239], v[80:83], a[44:47]
    ds_read_b64_tr_b16 v[230:231], v10 offset:1800
    s_waitcnt lgkmcnt(8)
    v_mfma_f32_16x16x32_bf16 a[48:51], v[240:243], v[48:51], a[48:51]
    v_cndmask_b32_dpp v115, v167, v163, vcc quad_perm:[1,0,3,2] row_mask:0xf bank_mask:0xf
    s_mov_b64 vcc, s[54:55]
    v_mfma_f32_16x16x32_bf16 a[52:55], v[240:243], v[64:67], a[52:55]
    ds_read_b64_tr_b16 v[232:233], v11 offset:256
    v_cndmask_b32_dpp v108, v152, v156, vcc quad_perm:[1,0,3,2] row_mask:0xf bank_mask:0xf
    v_mfma_f32_16x16x32_bf16 a[56:59], v[240:243], v[80:83], a[56:59]
    ds_read_b64_tr_b16 v[234:235], v11 offset:1792
    v_cndmask_b32_dpp v109, v153, v157, vcc quad_perm:[1,0,3,2] row_mask:0xf bank_mask:0xf
    v_mfma_f32_16x16x32_bf16 a[60:63], v[244:247], v[48:51], a[60:63]
    v_cndmask_b32_dpp v110, v154, v158, vcc quad_perm:[1,0,3,2] row_mask:0xf bank_mask:0xf
    v_cndmask_b32_dpp v111, v155, v159, vcc quad_perm:[1,0,3,2] row_mask:0xf bank_mask:0xf
    v_mfma_f32_16x16x32_bf16 a[64:67], v[244:247], v[64:67], a[64:67]
    ds_read_b64_tr_b16 v[236:237], v11 offset:264
    v_cndmask_b32_dpp v116, v160, v164, vcc quad_perm:[1,0,3,2] row_mask:0xf bank_mask:0xf
    v_mfma_f32_16x16x32_bf16 a[68:71], v[244:247], v[80:83], a[68:71]
    ds_read_b64_tr_b16 v[238:239], v11 offset:1800
    s_waitcnt lgkmcnt(8)
    v_mfma_f32_16x16x32_bf16 a[72:75], v[248:251], v[48:51], a[72:75]
    v_cndmask_b32_dpp v117, v161, v165, vcc quad_perm:[1,0,3,2] row_mask:0xf bank_mask:0xf
    v_cndmask_b32_dpp v118, v162, v166, vcc quad_perm:[1,0,3,2] row_mask:0xf bank_mask:0xf
    v_mfma_f32_16x16x32_bf16 a[76:79], v[248:251], v[64:67], a[76:79]
    ds_read_b64_tr_b16 v[240:241], v14 offset:0
    v_cndmask_b32_dpp v119, v163, v167, vcc quad_perm:[1,0,3,2] row_mask:0xf bank_mask:0xf
    v_mfma_f32_16x16x32_bf16 a[80:83], v[248:251], v[80:83], a[80:83]
    ds_read_b64_tr_b16 v[242:243], v14 offset:1536
    s_cmp_ge_u32 s63, 3
    s_cbranch_scc1 L_xs1
    s_add_u32 s31, s61, s30
    buffer_load_dwordx4 v[152:155], v36, s[32:35], s31 offen offset:0
    buffer_load_dwordx4 v[156:159], v36, s[32:35], s31 offen offset:1280
    buffer_load_dwordx4 v[160:163], v36, s[32:35], s31 offen offset:2560
    buffer_load_dwordx4 v[164:167], v36, s[32:35], s31 offen offset:3840
L_xs1:
    v_mfma_f32_16x16x32_bf16 a[84:87], v[252:255], v[48:51], a[84:87]
    s_waitcnt vmcnt(8)
    s_mov_b64 vcc, s[52:53]
    v_mfma_f32_16x16x32_bf16 a[88:91], v[252:255], v[64:67], a[88:91]
    ds_read_b64_tr_b16 v[244:245], v14 offset:8
    v_cndmask_b32_dpp v120, v172, v168, vcc quad_perm:[1,0,3,2] row_mask:0xf bank_mask:0xf
    v_mfma_f32_16x16x32_bf16 a[92:95], v[252:255], v[80:83], a[92:95]
    ds_read_b64_tr_b16 v[246:247], v14 offset:1544
    s_waitcnt lgkmcnt(8)
    v_mfma_f32_16x16x32_bf16 a[96:99], v[224:227], v[48:51], a[96:99]
    v_cndmask_b32_dpp v121, v173, v169, vcc quad_perm:[1,0,3,2] row_mask:0xf bank_mask:0xf
    v_cndmask_b32_dpp v122, v174, v170, vcc quad_perm:[1,0,3,2] row_mask:0xf bank_mask:0xf
    v_mfma_f32_16x16x32_bf16 a[100:103], v[224:227], v[64:67], a[100:103]
    ds_read_b64_tr_b16 v[248:249], v15 offset:0
    v_cndmask_b32_dpp v123, v175, v171, vcc quad_perm:[1,0,3,2] row_mask:0xf bank_mask:0xf
    v_mfma_f32_16x16x32_bf16 a[104:107], v[224:227], v[80:83], a[104:107]
    ds_read_b64_tr_b16 v[250:251], v15 offset:1536
    v_cndmask_b32_dpp v128, v180, v176, vcc quad_perm:[1,0,3,2] row_mask:0xf bank_mask:0xf
    v_mfma_f32_16x16x32_bf16 a[108:111], v[228:231], v[48:51], a[108:111]
    v_cndmask_b32_dpp v129, v181, v177, vcc quad_perm:[1,0,3,2] row_mask:0xf bank_mask:0xf
    v_cndmask_b32_dpp v130, v182, v178, vcc quad_perm:[1,0,3,2] row_mask:0xf bank_mask:0xf
    v_mfma_f32_16x16x32_bf16 a[112:115], v[228:231], v[64:67], a[112:115]
    ds_read_b64_tr_b16 v[252:253], v15 offset:8
    v_cndmask_b32_dpp v131, v183, v179, vcc quad_perm:[1,0,3,2] row_mask:0xf bank_mask:0xf
    v_mfma_f32_16x16x32_bf16 a[116:119], v[228:231], v[80:83], a[116:119]
    ds_read_b64_tr_b16 v[254:255], v15 offset:1544
    s_waitcnt lgkmcnt(8)
    v_mfma_f32_16x16x32_bf16 a[120:123], v[232:235], v[48:51], a[120:123]
    s_mov_b64 vcc, s[54:55]
    v_cndmask_b32_dpp v124, v168, v172, vcc quad_perm:[1,0,3,2] row_mask:0xf bank_mask:0xf
    v_mfma_f32_16x16x32_bf16 a[124:127], v[232:235], v[64:67], a[124:127]
    ds_read_b64_tr_b16 v[224:225], v14 offset:128
    v_cndmask_b32_dpp v125, v169, v173, vcc quad_perm:[1,0,3,2] row_mask:0xf bank_mask:0xf
    v_mfma_f32_16x16x32_bf16 a[128:131], v[232:235], v[80:83], a[128:131]
    ds_read_b64_tr_b16 v[226:227], v14 offset:1664
    v_cndmask_b32_dpp v126, v170, v174, vcc quad_perm:[1,0,3,2] row_mask:0xf bank_mask:0xf
    v_mfma_f32_16x16x32_bf16 a[132:135], v[236:239], v[48:51], a[132:135]
    s_barrier
    v_cndmask_b32_dpp v127, v171, v175, vcc quad_perm:[1,0,3,2] row_mask:0xf bank_mask:0xf
    v_mfma_f32_16x16x32_bf16 a[136:139], v[236:239], v[64:67], a[136:139]
    ds_read_b64_tr_b16 v[228:229], v14 offset:136
    v_cndmask_b32_dpp v132, v176, v180, vcc quad_perm:[1,0,3,2] row_mask:0xf bank_mask:0xf
    v_mfma_f32_16x16x32_bf16 a[140:143], v[236:239], v[80:83], a[140:143]
    ds_read_b64_tr_b16 v[230:231], v14 offset:1672
    s_waitcnt lgkmcnt(8)
    v_mfma_f32_16x16x32_bf16 a[0:3], v[240:243], v[52:55], a[0:3]
    v_add_u32 v10, s25, v184
    v_add_u32 v11, s25, v185
    v_mfma_f32_16x16x32_bf16 a[4:7], v[240:243], v[68:71], a[4:7]
    ds_read_b64_tr_b16 v[232:233], v15 offset:128
    s_add_u32 s25, s25, 12288
    v_mfma_f32_16x16x32_bf16 a[8:11], v[240:243], v[84:87], a[8:11]
    ds_read_b64_tr_b16 v[234:235], v15 offset:1664
    s_sub_u32 s26, s25, 73728
    v_mfma_f32_16x16x32_bf16 a[12:15], v[244:247], v[52:55], a[12:15]
    s_min_u32 s25, s25, s26
    v_cndmask_b32_dpp v133, v177, v181, vcc quad_perm:[1,0,3,2] row_mask:0xf bank_mask:0xf
    v_cndmask_b32_dpp v134, v178, v182, vcc quad_perm:[1,0,3,2] row_mask:0xf bank_mask:0xf
    v_mfma_f32_16x16x32_bf16 a[16:19], v[244:247], v[68:71], a[16:19]
    ds_read_b64_tr_b16 v[236:237], v15 offset:136
    v_cndmask_b32_dpp v135, v179, v183, vcc quad_perm:[1,0,3,2] row_mask:0xf bank_mask:0xf
    v_mfma_f32_16x16x32_bf16 a[20:23], v[244:247], v[84:87], a[20:23]
    ds_read_b64_tr_b16 v[238:239], v15 offset:1672
    s_cmp_ge_u32 s63, 3
    s_cbranch_scc1 L_xs2
    s_add_u32 s31, s62, s30
    buffer_load_dwordx4 v[168:171], v36, s[32:35], s31 offen offset:0
    buffer_load_dwordx4 v[172:175], v36, s[32:35], s31 offen offset:1280
    buffer_load_dwordx4 v[176:179], v36, s[32:35], s31 offen offset:2560
    buffer_load_dwordx4 v[180:183], v36, s[32:35], s31 offen offset:3840
    s_add_u32 s30, s30, 256
    s_sub_u32 s31, s30, 1280
    s_min_u32 s30, s30, s31
L_xs2:
    s_waitcnt lgkmcnt(8)
    v_mfma_f32_16x16x32_bf16 a[24:27], v[248:251], v[52:55], a[24:27]
    s_mov_b64 vcc, s[56:57]
    v_cndmask_b32_dpp v40, v96, v88, vcc quad_perm:[2,3,0,1] row_mask:0xf bank_mask:0xf
    v_mfma_f32_16x16x32_bf16 a[28:31], v[248:251], v[68:71], a[28:31]
    ds_read_b64_tr_b16 v[240:241], v14 offset:256
    v_cndmask_b32_dpp v41, v97, v89, vcc quad_perm:[2,3,0,1] row_mask:0xf bank_mask:0xf
    v_mfma_f32_16x16x32_bf16 a[32:35], v[248:251], v[84:87], a[32:35]
    ds_read_b64_tr_b16 v[242:243], v14 offset:1792
    v_cndmask_b32_dpp v42, v98, v90, vcc quad_perm:[2,3,0,1] row_mask:0xf bank_mask:0xf
    v_mfma_f32_16x16x32_bf16 a[36:39], v[252:255], v[52:55], a[36:39]
    v_cndmask_b32_dpp v43, v99, v91, vcc quad_perm:[2,3,0,1] row_mask:0xf bank_mask:0xf
    v_cndmask_b32_dpp v44, v100, v92, vcc quad_perm:[2,3,0,1] row_mask:0xf bank_mask:0xf
    v_mfma_f32_16x16x32_bf16 a[40:43], v[252:255], v[68:71], a[40:43]
    ds_read_b64_tr_b16 v[244:245], v14 offset:264
    v_cndmask_b32_dpp v45, v101, v93, vcc quad_perm:[2,3,0,1] row_mask:0xf bank_mask:0xf
    v_mfma_f32_16x16x32_bf16 a[44:47], v[252:255], v[84:87], a[44:47]
    ds_read_b64_tr_b16 v[246:247], v14 offset:1800
    s_waitcnt lgkmcnt(8)
    v_mfma_f32_16x16x32_bf16 a[48:51], v[224:227], v[52:55], a[48:51]
    v_cndmask_b32_dpp v46, v102, v94, vcc quad_perm:[2,3,0,1] row_mask:0xf bank_mask:0xf
    v_cndmask_b32_dpp v47, v103, v95, vcc quad_perm:[2,3,0,1] row_mask:0xf bank_mask:0xf
    v_mfma_f32_16x16x32_bf16 a[52:55], v[224:227], v[68:71], a[52:55]
    ds_read_b64_tr_b16 v[248:249], v15 offset:256
    v_cndmask_b32_dpp v56, v112, v104, vcc quad_perm:[2,3,0,1] row_mask:0xf bank_mask:0xf
    v_mfma_f32_16x16x32_bf16 a[56:59], v[224:227], v[84:87], a[56:59]
    ds_read_b64_tr_b16 v[250:251], v15 offset:1792
    v_cndmask_b32_dpp v57, v113, v105, vcc quad_perm:[2,3,0,1] row_mask:0xf bank_mask:0xf
    v_mfma_f32_16x16x32_bf16 a[60:63], v[228:231], v[52:55], a[60:63]
    v_cndmask_b32_dpp v58, v114, v106, vcc quad_perm:[2,3,0,1] row_mask:0xf bank_mask:0xf
    v_cndmask_b32_dpp v59, v115, v107, vcc quad_perm:[2,3,0,1] row_mask:0xf bank_mask:0xf
    v_mfma_f32_16x16x32_bf16 a[64:67], v[228:231], v[68:71], a[64:67]
    ds_read_b64_tr_b16 v[252:253], v15 offset:264
    v_cndmask_b32_dpp v60, v116, v108, vcc quad_perm:[2,3,0,1] row_mask:0xf bank_mask:0xf
    v_mfma_f32_16x16x32_bf16 a[68:71], v[228:231], v[84:87], a[68:71]
    ds_read_b64_tr_b16 v[254:255], v15 offset:1800
    s_waitcnt lgkmcnt(8)
    v_mfma_f32_16x16x32_bf16 a[72:75], v[232:235], v[52:55], a[72:75]
    v_cndmask_b32_dpp v61, v117, v109, vcc quad_perm:[2,3,0,1] row_mask:0xf bank_mask:0xf
    v_cndmask_b32_dpp v62, v118, v110, vcc quad_perm:[2,3,0,1] row_mask:0xf bank_mask:0xf
    v_mfma_f32_16x16x32_bf16 a[76:79], v[232:235], v[68:71], a[76:79]
    ds_read_b64_tr_b16 v[224:225], v10 offset:0
    v_cndmask_b32_dpp v63, v119, v111, vcc quad_perm:[2,3,0,1] row_mask:0xf bank_mask:0xf
    v_mfma_f32_16x16x32_bf16 a[80:83], v[232:235], v[84:87], a[80:83]
    ds_read_b64_tr_b16 v[226:227], v10 offset:1536
    v_cndmask_b32_dpp v72, v128, v120, vcc quad_perm:[2,3,0,1] row_mask:0xf bank_mask:0xf
    v_mfma_f32_16x16x32_bf16 a[84:87], v[236:239], v[52:55], a[84:87]
    v_cndmask_b32_dpp v73, v129, v121, vcc quad_perm:[2,3,0,1] row_mask:0xf bank_mask:0xf
    v_cndmask_b32_dpp v74, v130, v122, vcc quad_perm:[2,3,0,1] row_mask:0xf bank_mask:0xf
    v_mfma_f32_16x16x32_bf16 a[88:91], v[236:239], v[68:71], a[88:91]
    ds_read_b64_tr_b16 v[228:229], v10 offset:8
    v_cndmask_b32_dpp v75, v131, v123, vcc quad_perm:[2,3,0,1] row_mask:0xf bank_mask:0xf
    v_mfma_f32_16x16x32_bf16 a[92:95], v[236:239], v[84:87], a[92:95]
    ds_read_b64_tr_b16 v[230:231], v10 offset:1544
    s_waitcnt lgkmcnt(8)
    v_mfma_f32_16x16x32_bf16 a[96:99], v[240:243], v[52:55], a[96:99]
    v_cndmask_b32_dpp v76, v132, v124, vcc quad_perm:[2,3,0,1] row_mask:0xf bank_mask:0xf
    v_cndmask_b32_dpp v77, v133, v125, vcc quad_perm:[2,3,0,1] row_mask:0xf bank_mask:0xf
    v_mfma_f32_16x16x32_bf16 a[100:103], v[240:243], v[68:71], a[100:103]
    ds_read_b64_tr_b16 v[232:233], v11 offset:0
    v_cndmask_b32_dpp v78, v134, v126, vcc quad_perm:[2,3,0,1] row_mask:0xf bank_mask:0xf
    v_mfma_f32_16x16x32_bf16 a[104:107], v[240:243], v[84:87], a[104:107]
    ds_read_b64_tr_b16 v[234:235], v11 offset:1536
    v_cndmask_b32_dpp v79, v135, v127, vcc quad_perm:[2,3,0,1] row_mask:0xf bank_mask:0xf
    v_mfma_f32_16x16x32_bf16 a[108:111], v[244:247], v[52:55], a[108:111]
    v_mfma_f32_16x16x32_bf16 a[112:115], v[244:247], v[68:71], a[112:115]
    ds_read_b64_tr_b16 v[236:237], v11 offset:8
    v_mfma_f32_16x16x32_bf16 a[116:119], v[244:247], v[84:87], a[116:119]
    ds_read_b64_tr_b16 v[238:239], v11 offset:1544
    s_waitcnt lgkmcnt(8)
    v_mfma_f32_16x16x32_bf16 a[120:123], v[248:251], v[52:55], a[120:123]
    v_mfma_f32_16x16x32_bf16 a[124:127], v[248:251], v[68:71], a[124:127]
    ds_read_b64_tr_b16 v[240:241], v10 offset:128
    v_mfma_f32_16x16x32_bf16 a[128:131], v[248:251], v[84:87], a[128:131]
    ds_read_b64_tr_b16 v[242:243], v10 offset:1664
    v_mfma_f32_16x16x32_bf16 a[132:135], v[252:255], v[52:55], a[132:135]
    s_barrier
    v_mfma_f32_16x16x32_bf16 a[136:139], v[252:255], v[68:71], a[136:139]
    ds_read_b64_tr_b16 v[244:245], v10 offset:136
    v_mfma_f32_16x16x32_bf16 a[140:143], v[252:255], v[84:87], a[140:143]
    ds_read_b64_tr_b16 v[246:247], v10 offset:1672
    s_add_u32 s63, s63, 1
    s_cmp_lt_u32 s63, 5
    s_cbranch_scc1 L_A
    s_mov_b32 s60, 1037384597
    s_mov_b32 s61, 1037384597
    s_mov_b32 s25, 73728
    v_add_u32 v18, 73728, v22
    v_add_u32 v19, 73728, v23
    v_add_u32 v20, 86016, v22
    v_add_u32 v21, 86016, v23
    s_mov_b32 s25, 98304
    s_cmp_ge_u32 s28, 22
    s_cbranch_scc0 L_sl1
L_bk1:
    s_waitcnt lgkmcnt(10)
    ds_read_b128 v[224:227], v18 offset:0
    s_waitcnt lgkmcnt(9)
    ds_read_b128 v[228:231], v18 offset:6144
    s_waitcnt lgkmcnt(8)
    ds_read_b128 v[232:235], v20 offset:0
    s_waitcnt lgkmcnt(7)
    ds_read_b128 v[236:239], v20 offset:6144
    s_waitcnt lgkmcnt(6)
    ds_read_b128 v[240:243], v19 offset:0
    s_waitcnt lgkmcnt(5)
    ds_read_b128 v[244:247], v19 offset:6144
    v_accvgpr_read_b32 v88, a0
    v_accvgpr_read_b32 v89, a1
    v_accvgpr_read_b32 v90, a2
    v_accvgpr_read_b32 v91, a3
    v_accvgpr_read_b32 v92, a12
    v_accvgpr_read_b32 v93, a13
    v_accvgpr_read_b32 v94, a14
    v_accvgpr_read_b32 v95, a15
    v_pk_mul_f32 v[88:89], v[88:89], s[60:61]
    v_pk_mul_f32 v[90:91], v[90:91], s[60:61]
    v_pk_mul_f32 v[92:93], v[92:93], s[60:61]
    v_pk_mul_f32 v[94:95], v[94:95], s[60:61]
    v_cvt_pk_bf16_f32 v96, v88, v89
    v_cvt_pk_bf16_f32 v97, v90, v91
    v_cvt_pk_bf16_f32 v98, v92, v93
    v_cvt_pk_bf16_f32 v99, v94, v95
    v_accvgpr_write_b32 a156, v96
    v_accvgpr_write_b32 a157, v97
    v_accvgpr_write_b32 a158, v98
    v_accvgpr_write_b32 a159, v99
    v_accvgpr_read_b32 v100, a4
    v_accvgpr_read_b32 v101, a5
    v_accvgpr_read_b32 v102, a6
    v_accvgpr_read_b32 v103, a7
    v_accvgpr_read_b32 v104, a16
    v_accvgpr_read_b32 v105, a17
    v_accvgpr_read_b32 v106, a18
    v_accvgpr_read_b32 v107, a19
    v_pk_mul_f32 v[100:101], v[100:101], s[60:61]
    v_pk_mul_f32 v[102:103], v[102:103], s[60:61]
    v_pk_mul_f32 v[104:105], v[104:105], s[60:61]
    v_pk_mul_f32 v[106:107], v[106:107], s[60:61]
    v_cvt_pk_bf16_f32 v108, v100, v101
    v_cvt_pk_bf16_f32 v109, v102, v103
    v_cvt_pk_bf16_f32 v110, v104, v105
    v_cvt_pk_bf16_f32 v111, v106, v107
    v_accvgpr_write_b32 a180, v108
    v_accvgpr_write_b32 a181, v109
    v_accvgpr_write_b32 a182, v110
    v_accvgpr_write_b32 a183, v111
    v_accvgpr_read_b32 v112, a8
    v_accvgpr_read_b32 v113, a9
    v_accvgpr_read_b32 v114, a10
    v_accvgpr_read_b32 v115, a11
    v_accvgpr_read_b32 v116, a20
    v_accvgpr_read_b32 v117, a21
    v_accvgpr_read_b32 v118, a22
    v_accvgpr_read_b32 v119, a23
    v_pk_mul_f32 v[112:113], v[112:113], s[60:61]
    v_pk_mul_f32 v[114:115], v[114:115], s[60:61]
    v_pk_mul_f32 v[116:117], v[116:117], s[60:61]
    v_pk_mul_f32 v[118:119], v[118:119], s[60:61]
    v_cvt_pk_bf16_f32 v120, v112, v113
    v_cvt_pk_bf16_f32 v121, v114, v115
    v_cvt_pk_bf16_f32 v122, v116, v117
    v_cvt_pk_bf16_f32 v123, v118, v119
    v_accvgpr_write_b32 a204, v120
    v_accvgpr_write_b32 a205, v121
    v_accvgpr_write_b32 a206, v122
    v_accvgpr_write_b32 a207, v123
    s_waitcnt lgkmcnt(4)
    v_mfma_f32_16x16x32_bf16 v[40:43], v[224:227], a[156:159], 0
    v_accvgpr_read_b32 v124, a24
    v_accvgpr_read_b32 v125, a25
    v_accvgpr_read_b32 v126, a26
    v_accvgpr_read_b32 v127, a27
    v_accvgpr_read_b32 v128, a36
    v_accvgpr_read_b32 v129, a37
    v_mfma_f32_16x16x32_bf16 v[44:47], v[224:227], a[180:183], 0
    v_accvgpr_read_b32 v130, a38
    v_accvgpr_read_b32 v131, a39
    v_pk_mul_f32 v[124:125], v[124:125], s[60:61]
    v_pk_mul_f32 v[126:127], v[126:127], s[60:61]
    v_pk_mul_f32 v[128:129], v[128:129], s[60:61]
    v_mfma_f32_16x16x32_bf16 v[48:51], v[224:227], a[204:207], 0
    ds_read_b128 v[248:251], v21 offset:0
    v_pk_mul_f32 v[130:131], v[130:131], s[60:61]
    v_cvt_pk_bf16_f32 v132, v124, v125
    v_cvt_pk_bf16_f32 v133, v126, v127
    v_cvt_pk_bf16_f32 v134, v128, v129
    v_cvt_pk_bf16_f32 v135, v130, v131
    v_accvgpr_write_b32 a160, v132
    v_mfma_f32_16x16x32_bf16 v[52:55], v[228:231], a[156:159], 0
    v_accvgpr_write_b32 a161, v133
    v_accvgpr_write_b32 a162, v134
    v_accvgpr_write_b32 a163, v135
    v_accvgpr_read_b32 v88, a28
    v_accvgpr_read_b32 v89, a29
    v_mfma_f32_16x16x32_bf16 v[56:59], v[228:231], a[180:183], 0
    v_accvgpr_read_b32 v90, a30
    v_accvgpr_read_b32 v91, a31
    v_accvgpr_read_b32 v92, a40
    v_accvgpr_read_b32 v93, a41
    v_accvgpr_read_b32 v94, a42
    v_accvgpr_read_b32 v95, a43
    v_mfma_f32_16x16x32_bf16 v[60:63], v[228:231], a[204:207], 0
    ds_read_b128 v[252:255], v21 offset:6144
    v_pk_mul_f32 v[88:89], v[88:89], s[60:61]
    v_pk_mul_f32 v[90:91], v[90:91], s[60:61]
    v_pk_mul_f32 v[92:93], v[92:93], s[60:61]
    v_pk_mul_f32 v[94:95], v[94:95], s[60:61]
    v_cvt_pk_bf16_f32 v96, v88, v89
    s_waitcnt lgkmcnt(4)
    v_mfma_f32_16x16x32_bf16 v[64:67], v[232:235], a[156:159], 0
    v_cvt_pk_bf16_f32 v97, v90, v91
    v_cvt_pk_bf16_f32 v98, v92, v93
    v_cvt_pk_bf16_f32 v99, v94, v95
    v_accvgpr_write_b32 a184, v96
    v_accvgpr_write_b32 a185, v97
    v_accvgpr_write_b32 a186, v98
    v_mfma_f32_16x16x32_bf16 v[68:71], v[232:235], a[180:183], 0
    v_accvgpr_write_b32 a187, v99
    v_accvgpr_read_b32 v100, a32
    v_accvgpr_read_b32 v101, a33
    v_accvgpr_read_b32 v102, a34
    v_accvgpr_read_b32 v103, a35
    v_mfma_f32_16x16x32_bf16 v[72:75], v[232:235], a[204:207], 0
    ds_read_b128 v[224:227], v18 offset:128
    v_accvgpr_read_b32 v104, a44
    v_accvgpr_read_b32 v105, a45
    v_accvgpr_read_b32 v106, a46
    v_accvgpr_read_b32 v107, a47
    v_pk_mul_f32 v[100:101], v[100:101], s[60:61]
    v_pk_mul_f32 v[102:103], v[102:103], s[60:61]
    v_mfma_f32_16x16x32_bf16 v[76:79], v[236:239], a[156:159], 0
    v_pk_mul_f32 v[104:105], v[104:105], s[60:61]
    v_pk_mul_f32 v[106:107], v[106:107], s[60:61]
    v_cvt_pk_bf16_f32 v108, v100, v101
    v_cvt_pk_bf16_f32 v109, v102, v103
    v_cvt_pk_bf16_f32 v110, v104, v105
    v_mfma_f32_16x16x32_bf16 v[80:83], v[236:239], a[180:183], 0
    v_cvt_pk_bf16_f32 v111, v106, v107
    v_accvgpr_write_b32 a208, v108
    v_accvgpr_write_b32 a209, v109
    v_accvgpr_write_b32 a210, v110
    v_accvgpr_write_b32 a211, v111
    v_mfma_f32_16x16x32_bf16 v[84:87], v[236:239], a[204:207], 0
    ds_read_b128 v[228:231], v18 offset:6272
    s_waitcnt lgkmcnt(4)
    v_mfma_f32_16x16x32_bf16 v[40:43], v[240:243], a[160:163], v[40:43]
    v_accvgpr_read_b32 v112, a48
    v_accvgpr_read_b32 v113, a49
    v_accvgpr_read_b32 v114, a50
    v_accvgpr_read_b32 v115, a51
    v_accvgpr_read_b32 v116, a60
    v_accvgpr_read_b32 v117, a61
    v_mfma_f32_16x16x32_bf16 v[44:47], v[240:243], a[184:187], v[44:47]
    v_accvgpr_read_b32 v118, a62
    v_accvgpr_read_b32 v119, a63
    v_pk_mul_f32 v[112:113], v[112:113], s[60:61]
    v_pk_mul_f32 v[114:115], v[114:115], s[60:61]
    v_pk_mul_f32 v[116:117], v[116:117], s[60:61]
    v_mfma_f32_16x16x32_bf16 v[48:51], v[240:243], a[208:211], v[48:51]
    ds_read_b128 v[232:235], v20 offset:128
    v_pk_mul_f32 v[118:119], v[118:119], s[60:61]
    v_cvt_pk_bf16_f32 v120, v112, v113
    v_cvt_pk_bf16_f32 v121, v114, v115
    v_cvt_pk_bf16_f32 v122, v116, v117
    v_cvt_pk_bf16_f32 v123, v118, v119
    v_accvgpr_write_b32 a164, v120
    v_mfma_f32_16x16x32_bf16 v[52:55], v[244:247], a[160:163], v[52:55]
    v_accvgpr_write_b32 a165, v121
    v_accvgpr_write_b32 a166, v122
    v_accvgpr_write_b32 a167, v123
    v_accvgpr_read_b32 v124, a52
    v_accvgpr_read_b32 v125, a53
    v_mfma_f32_16x16x32_bf16 v[56:59], v[244:247], a[184:187], v[56:59]
    v_accvgpr_read_b32 v126, a54
    v_accvgpr_read_b32 v127, a55
    v_accvgpr_read_b32 v128, a64
    v_accvgpr_read_b32 v129, a65
    v_accvgpr_read_b32 v130, a66
    v_accvgpr_read_b32 v131, a67
    v_mfma_f32_16x16x32_bf16 v[60:63], v[244:247], a[208:211], v[60:63]
    ds_read_b128 v[236:239], v20 offset:6272
    v_pk_mul_f32 v[124:125], v[124:125], s[60:61]
    v_pk_mul_f32 v[126:127], v[126:127], s[60:61]
    v_pk_mul_f32 v[128:129], v[128:129], s[60:61]
    v_pk_mul_f32 v[130:131], v[130:131], s[60:61]
    v_cvt_pk_bf16_f32 v132, v124, v125
    s_waitcnt lgkmcnt(4)
    v_mfma_f32_16x16x32_bf16 v[64:67], v[248:251], a[160:163], v[64:67]
    v_cvt_pk_bf16_f32 v133, v126, v127
    v_cvt_pk_bf16_f32 v134, v128, v129
    v_cvt_pk_bf16_f32 v135, v130, v131
    v_accvgpr_write_b32 a188, v132
    v_accvgpr_write_b32 a189, v133
    v_accvgpr_write_b32 a190, v134
    v_mfma_f32_16x16x32_bf16 v[68:71], v[248:251], a[184:187], v[68:71]
    v_accvgpr_write_b32 a191, v135
    v_accvgpr_read_b32 v88, a56
    v_accvgpr_read_b32 v89, a57
    v_accvgpr_read_b32 v90, a58
    v_accvgpr_read_b32 v91, a59
    v_mfma_f32_16x16x32_bf16 v[72:75], v[248:251], a[208:211], v[72:75]
    ds_read_b128 v[240:243], v19 offset:128
    v_accvgpr_read_b32 v92, a68
    v_accvgpr_read_b32 v93, a69
    v_accvgpr_read_b32 v94, a70
    v_accvgpr_read_b32 v95, a71
    v_pk_mul_f32 v[88:89], v[88:89], s[60:61]
    v_pk_mul_f32 v[90:91], v[90:91], s[60:61]
    v_mfma_f32_16x16x32_bf16 v[76:79], v[252:255], a[160:163], v[76:79]
    v_pk_mul_f32 v[92:93], v[92:93], s[60:61]
    v_pk_mul_f32 v[94:95], v[94:95], s[60:61]
    v_cvt_pk_bf16_f32 v96, v88, v89
    v_cvt_pk_bf16_f32 v97, v90, v91
    v_cvt_pk_bf16_f32 v98, v92, v93
    v_mfma_f32_16x16x32_bf16 v[80:83], v[252:255], a[184:187], v[80:83]
    v_cvt_pk_bf16_f32 v99, v94, v95
    v_accvgpr_write_b32 a212, v96
    v_accvgpr_write_b32 a213, v97
    v_accvgpr_write_b32 a214, v98
    v_accvgpr_write_b32 a215, v99
    v_mfma_f32_16x16x32_bf16 v[84:87], v[252:255], a[208:211], v[84:87]
    ds_read_b128 v[244:247], v19 offset:6272
    s_waitcnt lgkmcnt(4)
    v_mfma_f32_16x16x32_bf16 v[40:43], v[224:227], a[164:167], v[40:43]
    v_accvgpr_read_b32 v100, a72
    v_accvgpr_read_b32 v101, a73
    v_accvgpr_read_b32 v102, a74
    v_accvgpr_read_b32 v103, a75
    v_accvgpr_read_b32 v104, a84
    v_accvgpr_read_b32 v105, a85
    v_mfma_f32_16x16x32_bf16 v[44:47], v[224:227], a[188:191], v[44:47]
    v_accvgpr_read_b32 v106, a86
    v_accvgpr_read_b32 v107, a87
    v_pk_mul_f32 v[100:101], v[100:101], s[60:61]
    v_pk_mul_f32 v[102:103], v[102:103], s[60:61]
    v_pk_mul_f32 v[104:105], v[104:105], s[60:61]
    v_mfma_f32_16x16x32_bf16 v[48:51], v[224:227], a[212:215], v[48:51]
    ds_read_b128 v[248:251], v21 offset:128
    v_pk_mul_f32 v[106:107], v[106:107], s[60:61]
    v_cvt_pk_bf16_f32 v108, v100, v101
    v_cvt_pk_bf16_f32 v109, v102, v103
    v_cvt_pk_bf16_f32 v110, v104, v105
    v_cvt_pk_bf16_f32 v111, v106, v107
    v_accvgpr_write_b32 a168, v108
    v_mfma_f32_16x16x32_bf16 v[52:55], v[228:231], a[164:167], v[52:55]
    v_accvgpr_write_b32 a169, v109
    v_accvgpr_write_b32 a170, v110
    v_accvgpr_write_b32 a171, v111
    v_accvgpr_read_b32 v112, a76
    v_accvgpr_read_b32 v113, a77
    v_mfma_f32_16x16x32_bf16 v[56:59], v[228:231], a[188:191], v[56:59]
    v_accvgpr_read_b32 v114, a78
    v_accvgpr_read_b32 v115, a79
    v_accvgpr_read_b32 v116, a88
    v_accvgpr_read_b32 v117, a89
    v_accvgpr_read_b32 v118, a90
    v_accvgpr_read_b32 v119, a91
    v_mfma_f32_16x16x32_bf16 v[60:63], v[228:231], a[212:215], v[60:63]
    ds_read_b128 v[252:255], v21 offset:6272
    v_pk_mul_f32 v[112:113], v[112:113], s[60:61]
    v_pk_mul_f32 v[114:115], v[114:115], s[60:61]
    v_pk_mul_f32 v[116:117], v[116:117], s[60:61]
    v_pk_mul_f32 v[118:119], v[118:119], s[60:61]
    v_cvt_pk_bf16_f32 v120, v112, v113
    s_waitcnt lgkmcnt(4)
    v_mfma_f32_16x16x32_bf16 v[64:67], v[232:235], a[164:167], v[64:67]
    v_cvt_pk_bf16_f32 v121, v114, v115
    v_cvt_pk_bf16_f32 v122, v116, v117
    v_cvt_pk_bf16_f32 v123, v118, v119
    v_accvgpr_write_b32 a192, v120
    v_accvgpr_write_b32 a193, v121
    v_accvgpr_write_b32 a194, v122
    v_mfma_f32_16x16x32_bf16 v[68:71], v[232:235], a[188:191], v[68:71]
    v_accvgpr_write_b32 a195, v123
    v_accvgpr_read_b32 v124, a80
    v_accvgpr_read_b32 v125, a81
    v_accvgpr_read_b32 v126, a82
    v_accvgpr_read_b32 v127, a83
    v_mfma_f32_16x16x32_bf16 v[72:75], v[232:235], a[212:215], v[72:75]
    ds_read_b128 v[224:227], v18 offset:256
    v_accvgpr_read_b32 v128, a92
    v_accvgpr_read_b32 v129, a93
    v_accvgpr_read_b32 v130, a94
    v_accvgpr_read_b32 v131, a95
    v_pk_mul_f32 v[124:125], v[124:125], s[60:61]
    v_pk_mul_f32 v[126:127], v[126:127], s[60:61]
    v_mfma_f32_16x16x32_bf16 v[76:79], v[236:239], a[164:167], v[76:79]
    v_pk_mul_f32 v[128:129], v[128:129], s[60:61]
    v_pk_mul_f32 v[130:131], v[130:131], s[60:61]
    v_cvt_pk_bf16_f32 v132, v124, v125
    v_cvt_pk_bf16_f32 v133, v126, v127
    v_cvt_pk_bf16_f32 v134, v128, v129
    v_mfma_f32_16x16x32_bf16 v[80:83], v[236:239], a[188:191], v[80:83]
    v_cvt_pk_bf16_f32 v135, v130, v131
    v_accvgpr_write_b32 a216, v132
    v_accvgpr_write_b32 a217, v133
    v_accvgpr_write_b32 a218, v134
    v_accvgpr_write_b32 a219, v135
    v_mfma_f32_16x16x32_bf16 v[84:87], v[236:239], a[212:215], v[84:87]
    ds_read_b128 v[228:231], v18 offset:6400
    s_waitcnt lgkmcnt(4)
    v_mfma_f32_16x16x32_bf16 v[40:43], v[240:243], a[168:171], v[40:43]
    v_accvgpr_read_b32 v88, a96
    v_accvgpr_read_b32 v89, a97
    v_accvgpr_read_b32 v90, a98
    v_accvgpr_read_b32 v91, a99
    v_accvgpr_read_b32 v92, a108
    v_accvgpr_read_b32 v93, a109
    v_mfma_f32_16x16x32_bf16 v[44:47], v[240:243], a[192:195], v[44:47]
    v_accvgpr_read_b32 v94, a110
    v_accvgpr_read_b32 v95, a111
    v_pk_mul_f32 v[88:89], v[88:89], s[60:61]
    v_pk_mul_f32 v[90:91], v[90:91], s[60:61]
    v_pk_mul_f32 v[92:93], v[92:93], s[60:61]
    v_mfma_f32_16x16x32_bf16 v[48:51], v[240:243], a[216:219], v[48:51]
    ds_read_b128 v[232:235], v20 offset:256
    v_pk_mul_f32 v[94:95], v[94:95], s[60:61]
    v_cvt_pk_bf16_f32 v96, v88, v89
    v_cvt_pk_bf16_f32 v97, v90, v91
    v_cvt_pk_bf16_f32 v98, v92, v93
    v_cvt_pk_bf16_f32 v99, v94, v95
    v_accvgpr_write_b32 a172, v96
    v_mfma_f32_16x16x32_bf16 v[52:55], v[244:247], a[168:171], v[52:55]
    v_accvgpr_write_b32 a173, v97
    v_accvgpr_write_b32 a174, v98
    v_accvgpr_write_b32 a175, v99
    v_accvgpr_read_b32 v100, a100
    v_accvgpr_read_b32 v101, a101
    v_mfma_f32_16x16x32_bf16 v[56:59], v[244:247], a[192:195], v[56:59]
    v_accvgpr_read_b32 v102, a102
    v_accvgpr_read_b32 v103, a103
    v_accvgpr_read_b32 v104, a112
    v_accvgpr_read_b32 v105, a113
    v_accvgpr_read_b32 v106, a114
    v_accvgpr_read_b32 v107, a115
    v_mfma_f32_16x16x32_bf16 v[60:63], v[244:247], a[216:219], v[60:63]
    ds_read_b128 v[236:239], v20 offset:6400
    v_pk_mul_f32 v[100:101], v[100:101], s[60:61]
    v_pk_mul_f32 v[102:103], v[102:103], s[60:61]
    v_pk_mul_f32 v[104:105], v[104:105], s[60:61]
    v_pk_mul_f32 v[106:107], v[106:107], s[60:61]
    v_cvt_pk_bf16_f32 v108, v100, v101
    s_waitcnt lgkmcnt(4)
    v_mfma_f32_16x16x32_bf16 v[64:67], v[248:251], a[168:171], v[64:67]
    v_cvt_pk_bf16_f32 v109, v102, v103
    v_cvt_pk_bf16_f32 v110, v104, v105
    v_cvt_pk_bf16_f32 v111, v106, v107
    v_accvgpr_write_b32 a196, v108
    v_accvgpr_write_b32 a197, v109
    v_accvgpr_write_b32 a198, v110
    v_mfma_f32_16x16x32_bf16 v[68:71], v[248:251], a[192:195], v[68:71]
    v_accvgpr_write_b32 a199, v111
    v_accvgpr_read_b32 v112, a104
    v_accvgpr_read_b32 v113, a105
    v_accvgpr_read_b32 v114, a106
    v_accvgpr_read_b32 v115, a107
    v_mfma_f32_16x16x32_bf16 v[72:75], v[248:251], a[216:219], v[72:75]
    ds_read_b128 v[240:243], v19 offset:256
    v_accvgpr_read_b32 v116, a116
    v_accvgpr_read_b32 v117, a117
    v_accvgpr_read_b32 v118, a118
    v_accvgpr_read_b32 v119, a119
    v_pk_mul_f32 v[112:113], v[112:113], s[60:61]
    v_pk_mul_f32 v[114:115], v[114:115], s[60:61]
    v_mfma_f32_16x16x32_bf16 v[76:79], v[252:255], a[168:171], v[76:79]
    v_pk_mul_f32 v[116:117], v[116:117], s[60:61]
    v_pk_mul_f32 v[118:119], v[118:119], s[60:61]
    v_cvt_pk_bf16_f32 v120, v112, v113
    v_cvt_pk_bf16_f32 v121, v114, v115
    v_cvt_pk_bf16_f32 v122, v116, v117
    v_mfma_f32_16x16x32_bf16 v[80:83], v[252:255], a[192:195], v[80:83]
    v_cvt_pk_bf16_f32 v123, v118, v119
    v_accvgpr_write_b32 a220, v120
    v_accvgpr_write_b32 a221, v121
    v_accvgpr_write_b32 a222, v122
    v_accvgpr_write_b32 a223, v123
    v_mfma_f32_16x16x32_bf16 v[84:87], v[252:255], a[216:219], v[84:87]
    ds_read_b128 v[244:247], v19 offset:6400
    v_add_u32 v18, s25, v22
    s_waitcnt lgkmcnt(4)
    v_mfma_f32_16x16x32_bf16 v[40:43], v[224:227], a[172:175], v[40:43]
    v_accvgpr_read_b32 v124, a120
    v_accvgpr_read_b32 v125, a121
    v_accvgpr_read_b32 v126, a122
    v_accvgpr_read_b32 v127, a123
    v_accvgpr_read_b32 v128, a132
    v_accvgpr_read_b32 v129, a133
    v_mfma_f32_16x16x32_bf16 v[44:47], v[224:227], a[196:199], v[44:47]
    v_add_u32 v19, s25, v23
    s_add_u32 s25, s25, 12288
    v_accvgpr_read_b32 v130, a134
    v_accvgpr_read_b32 v131, a135
    v_pk_mul_f32 v[124:125], v[124:125], s[60:61]
    v_pk_mul_f32 v[126:127], v[126:127], s[60:61]
    v_pk_mul_f32 v[128:129], v[128:129], s[60:61]
    v_mfma_f32_16x16x32_bf16 v[48:51], v[224:227], a[220:223], v[48:51]
    ds_read_b128 v[248:251], v21 offset:256
    s_sub_u32 s26, s25, 159744
    v_pk_mul_f32 v[130:131], v[130:131], s[60:61]
    v_cvt_pk_bf16_f32 v132, v124, v125
    v_cvt_pk_bf16_f32 v133, v126, v127
    v_cvt_pk_bf16_f32 v134, v128, v129
    v_cvt_pk_bf16_f32 v135, v130, v131
    v_accvgpr_write_b32 a176, v132
    v_mfma_f32_16x16x32_bf16 v[52:55], v[228:231], a[172:175], v[52:55]
    s_min_u32 s25, s25, s26
    v_accvgpr_write_b32 a177, v133
    v_accvgpr_write_b32 a178, v134
    v_accvgpr_write_b32 a179, v135
    v_accvgpr_read_b32 v88, a124
    v_accvgpr_read_b32 v89, a125
    v_mfma_f32_16x16x32_bf16 v[56:59], v[228:231], a[196:199], v[56:59]
    v_accvgpr_read_b32 v90, a126
    v_accvgpr_read_b32 v91, a127
    v_accvgpr_read_b32 v92, a136
    v_accvgpr_read_b32 v93, a137
    v_accvgpr_read_b32 v94, a138
    v_accvgpr_read_b32 v95, a139
    v_mfma_f32_16x16x32_bf16 v[60:63], v[228:231], a[220:223], v[60:63]
    ds_read_b128 v[252:255], v21 offset:6400
    v_pk_mul_f32 v[88:89], v[88:89], s[60:61]
    v_pk_mul_f32 v[90:91], v[90:91], s[60:61]
    v_pk_mul_f32 v[92:93], v[92:93], s[60:61]
    v_pk_mul_f32 v[94:95], v[94:95], s[60:61]
    v_cvt_pk_bf16_f32 v96, v88, v89
    s_waitcnt lgkmcnt(4)
    v_mfma_f32_16x16x32_bf16 v[64:67], v[232:235], a[172:175], v[64:67]
    s_cmp_ge_u32 s28, 24
    s_cbranch_scc0 L_sl2
L_bk2:
    v_cvt_pk_bf16_f32 v97, v90, v91
    v_cvt_pk_bf16_f32 v98, v92, v93
    v_cvt_pk_bf16_f32 v99, v94, v95
    v_accvgpr_write_b32 a200, v96
    v_accvgpr_write_b32 a201, v97
    v_accvgpr_write_b32 a202, v98
    v_mfma_f32_16x16x32_bf16 v[68:71], v[232:235], a[196:199], v[68:71]
    v_accvgpr_write_b32 a203, v99
    v_accvgpr_read_b32 v100, a128
    v_accvgpr_read_b32 v101, a129
    v_accvgpr_read_b32 v102, a130
    v_accvgpr_read_b32 v103, a131
    v_mfma_f32_16x16x32_bf16 v[72:75], v[232:235], a[220:223], v[72:75]
    ds_read_b128 v[224:227], v18 offset:0
    v_accvgpr_read_b32 v104, a140
    v_accvgpr_read_b32 v105, a141
    v_accvgpr_read_b32 v106, a142
    v_accvgpr_read_b32 v107, a143
    v_pk_mul_f32 v[100:101], v[100:101], s[60:61]
    v_pk_mul_f32 v[102:103], v[102:103], s[60:61]
    v_mfma_f32_16x16x32_bf16 v[76:79], v[236:239], a[172:175], v[76:79]
    v_pk_mul_f32 v[104:105], v[104:105], s[60:61]
    v_pk_mul_f32 v[106:107], v[106:107], s[60:61]
    v_cvt_pk_bf16_f32 v108, v100, v101
    v_cvt_pk_bf16_f32 v109, v102, v103
    v_cvt_pk_bf16_f32 v110, v104, v105
    v_mfma_f32_16x16x32_bf16 v[80:83], v[236:239], a[196:199], v[80:83]
    v_cvt_pk_bf16_f32 v111, v106, v107
    v_accvgpr_write_b32 a224, v108
    v_accvgpr_write_b32 a225, v109
    v_accvgpr_write_b32 a226, v110
    v_accvgpr_write_b32 a227, v111
    v_mfma_f32_16x16x32_bf16 v[84:87], v[236:239], a[220:223], v[84:87]
    ds_read_b128 v[228:231], v19 offset:0
    s_waitcnt lgkmcnt(4)
    v_mfma_f32_16x16x32_bf16 v[40:43], v[240:243], a[176:179], v[40:43]
    v_lshrrev_b32 v3, 4, v1
    v_and_b32 v4, 15, v1
    v_mfma_f32_16x16x32_bf16 v[44:47], v[240:243], a[200:203], v[44:47]
    v_lshrrev_b32 v5, 2, v4
    v_lshl_add_u32 v5, v3, 2, v5
    v_mfma_f32_16x16x32_bf16 v[48:51], v[240:243], a[224:227], v[48:51]
    ds_read_b128 v[232:235], v18 offset:128
    v_bfe_u32 v6, v5, 1, 2
    v_mfma_f32_16x16x32_bf16 v[52:55], v[244:247], a[176:179], v[52:55]
    v_lshlrev_b32 v5, 7, v5
    v_and_b32 v7, 3, v4
    v_mfma_f32_16x16x32_bf16 v[56:59], v[244:247], a[200:203], v[56:59]
    v_lshl_add_u32 v5, v7, 3, v5
    v_xor_b32 v7, 0, v6
    v_mfma_f32_16x16x32_bf16 v[60:63], v[244:247], a[224:227], v[60:63]
    ds_read_b128 v[236:239], v19 offset:128
    s_waitcnt lgkmcnt(4)
    v_mfma_f32_16x16x32_bf16 v[64:67], v[248:251], a[176:179], v[64:67]
    v_lshl_add_u32 v10, v7, 5, v5
    v_xor_b32 v7, 1, v6
    v_mfma_f32_16x16x32_bf16 v[68:71], v[248:251], a[200:203], v[68:71]
    v_lshl_add_u32 v11, v7, 5, v5
    v_xor_b32 v7, 2, v6
    v_mfma_f32_16x16x32_bf16 v[72:75], v[248:251], a[224:227], v[72:75]
    ds_read_b128 v[240:243], v18 offset:256
    v_lshl_add_u32 v12, v7, 5, v5
    v_mfma_f32_16x16x32_bf16 v[76:79], v[252:255], a[176:179], v[76:79]
    v_add_u32 v221, 2, v221
    ds_write_b32 v220, v221
    v_mfma_f32_16x16x32_bf16 v[80:83], v[252:255], a[200:203], v[80:83]
    v_xor_b32 v7, 3, v6
    v_lshl_add_u32 v13, v7, 5, v5
    v_mfma_f32_16x16x32_bf16 v[84:87], v[252:255], a[224:227], v[84:87]
    ds_read_b128 v[244:247], v19 offset:256
    v_max3_f32 v172, v40, v41, v42
    v_max3_f32 v173, v44, v45, v46
    v_max3_f32 v174, v48, v49, v50
    v_max3_f32 v172, v172, v43, v52
    v_max3_f32 v173, v173, v47, v56
    v_max3_f32 v174, v174, v51, v60
    v_max3_f32 v172, v172, v53, v54
    v_max3_f32 v173, v173, v57, v58
    v_max3_f32 v174, v174, v61, v62
    v_max3_f32 v172, v172, v55, v64
    v_max3_f32 v173, v173, v59, v68
    v_max3_f32 v174, v174, v63, v72
    v_max3_f32 v172, v172, v65, v66
    v_max3_f32 v173, v173, v69, v70
    v_max3_f32 v174, v174, v73, v74
    v_max3_f32 v172, v172, v67, v76
    v_max3_f32 v173, v173, v71, v80
    v_max3_f32 v174, v174, v75, v84
    v_max3_f32 v172, v172, v77, v78
    v_max3_f32 v173, v173, v81, v82
    v_max3_f32 v174, v174, v85, v86
    v_max_f32 v172, v172, v79
    v_max_f32 v173, v173, v83
    v_max_f32 v174, v174, v87
    v_mov_b32 v176, v172
    v_mov_b32 v177, v173
    v_mov_b32 v178, v174
    v_permlane32_swap_b32 v172, v176
    v_permlane32_swap_b32 v173, v177
    v_permlane32_swap_b32 v174, v178
    v_max_f32 v172, v172, v176
    v_max_f32 v173, v173, v177
    v_max_f32 v174, v174, v178
    v_mov_b32 v176, v172
    v_mov_b32 v177, v173
    v_mov_b32 v178, v174
    v_permlane16_swap_b32 v172, v176
    v_permlane16_swap_b32 v173, v177
    v_permlane16_swap_b32 v174, v178
    v_max_f32 v172, v172, v176
    v_max_f32 v173, v173, v177
    v_max_f32 v174, v174, v178
    v_sub_f32 v160, 0, v172
    v_sub_f32 v161, 0, v172
    v_sub_f32 v162, 0, v172
    v_sub_f32 v163, 0, v172
    v_sub_f32 v164, 0, v173
    v_sub_f32 v165, 0, v173
    v_sub_f32 v166, 0, v173
    v_sub_f32 v167, 0, v173
    v_sub_f32 v168, 0, v174
    v_sub_f32 v169, 0, v174
    v_sub_f32 v170, 0, v174
    v_sub_f32 v171, 0, v174
    s_mov_b32 s63, 0x41000000
    s_mov_b32 s61, 0
    s_waitcnt lgkmcnt(5)
    v_mfma_f32_16x16x32_bf16 v[88:91], v[224:227], a[156:159], v[160:163]
    v_add_u32 v20, s25, v22
    v_add_u32 v21, s25, v23
    v_add_f32 v40, v40, v160
    v_add_f32 v41, v41, v160
    v_mfma_f32_16x16x32_bf16 v[92:95], v[224:227], a[180:183], v[164:167]
    s_add_u32 s25, s25, 12288
    s_sub_u32 s26, s25, 159744
    v_add_f32 v42, v42, v160
    v_add_f32 v43, v43, v160
    v_mfma_f32_16x16x32_bf16 v[96:99], v[224:227], a[204:207], v[168:171]
    ds_read_b128 v[248:251], v18 offset:6144
    s_min_u32 s25, s25, s26
    v_exp_f32 v40, v40
    v_mfma_f32_16x16x32_bf16 v[88:91], v[228:231], a[160:163], v[88:91]
    v_exp_f32 v41, v41
    v_exp_f32 v42, v42
    v_mfma_f32_16x16x32_bf16 v[92:95], v[228:231], a[184:187], v[92:95]
    v_exp_f32 v43, v43
    v_mfma_f32_16x16x32_bf16 v[96:99], v[228:231], a[208:211], v[96:99]
    ds_read_b128 v[252:255], v19 offset:6144
    v_cvt_pk_bf16_f32 v136, v40, v41
    s_waitcnt lgkmcnt(5)
    v_mfma_f32_16x16x32_bf16 v[88:91], v[232:235], a[164:167], v[88:91]
    v_cvt_pk_bf16_f32 v137, v42, v43
    v_add_f32 v52, v52, v160
    v_mfma_f32_16x16x32_bf16 v[92:95], v[232:235], a[188:191], v[92:95]
    v_add_f32 v53, v53, v160
    v_add_f32 v54, v54, v160
    v_mfma_f32_16x16x32_bf16 v[96:99], v[232:235], a[212:215], v[96:99]
    ds_read_b128 v[224:227], v18 offset:6272
    v_add_f32 v55, v55, v160
    v_mfma_f32_16x16x32_bf16 v[88:91], v[236:239], a[168:171], v[88:91]
    v_exp_f32 v52, v52
    v_mfma_f32_16x16x32_bf16 v[92:95], v[236:239], a[192:195], v[92:95]
    v_exp_f32 v53, v53
    v_mfma_f32_16x16x32_bf16 v[96:99], v[236:239], a[216:219], v[96:99]
    ds_read_b128 v[228:231], v19 offset:6272
    v_exp_f32 v54, v54
    s_waitcnt lgkmcnt(4)
    v_mfma_f32_16x16x32_bf16 v[88:91], v[240:243], a[172:175], v[88:91]
    v_exp_f32 v55, v55
    v_mfma_f32_16x16x32_bf16 v[92:95], v[240:243], a[196:199], v[92:95]
    v_cvt_pk_bf16_f32 v138, v52, v53
    v_mfma_f32_16x16x32_bf16 v[96:99], v[240:243], a[220:223], v[96:99]
    ds_read_b128 v[232:235], v18 offset:6400
    v_cvt_pk_bf16_f32 v139, v54, v55
    v_mfma_f32_16x16x32_bf16 v[88:91], v[244:247], a[176:179], v[88:91]
    v_add_f32 v44, v44, v164
    v_add_f32 v45, v45, v164
    v_mfma_f32_16x16x32_bf16 v[92:95], v[244:247], a[200:203], v[92:95]
    v_add_f32 v46, v46, v164
    v_add_f32 v47, v47, v164
    v_mfma_f32_16x16x32_bf16 v[96:99], v[244:247], a[224:227], v[96:99]
    ds_read_b128 v[236:239], v19 offset:6400
    v_exp_f32 v44, v44
    s_waitcnt lgkmcnt(4)
    v_mfma_f32_16x16x32_bf16 v[100:103], v[248:251], a[156:159], v[160:163]
    v_exp_f32 v45, v45
    v_mfma_f32_16x16x32_bf16 v[104:107], v[248:251], a[180:183], v[164:167]
    v_exp_f32 v46, v46
    v_mfma_f32_16x16x32_bf16 v[108:111], v[248:251], a[204:207], v[168:171]
    ds_read_b128 v[240:243], v20 offset:0
    v_mfma_f32_16x16x32_bf16 v[100:103], v[252:255], a[160:163], v[100:103]
    v_exp_f32 v47, v47
    v_cvt_pk_bf16_f32 v140, v44, v45
    v_mfma_f32_16x16x32_bf16 v[104:107], v[252:255], a[184:187], v[104:107]
    v_cvt_pk_bf16_f32 v141, v46, v47
    v_add_f32 v56, v56, v164
    v_mfma_f32_16x16x32_bf16 v[108:111], v[252:255], a[208:211], v[108:111]
    ds_read_b128 v[244:247], v21 offset:0
    s_waitcnt lgkmcnt(4)
    v_mfma_f32_16x16x32_bf16 v[100:103], v[224:227], a[164:167], v[100:103]
    v_add_f32 v57, v57, v164
    v_add_f32 v58, v58, v164
    v_mfma_f32_16x16x32_bf16 v[104:107], v[224:227], a[188:191], v[104:107]
    v_add_f32 v59, v59, v164
    v_exp_f32 v56, v56
    v_mfma_f32_16x16x32_bf16 v[108:111], v[224:227], a[212:215], v[108:111]
    ds_read_b128 v[248:251], v20 offset:128
    v_mfma_f32_16x16x32_bf16 v[100:103], v[228:231], a[168:171], v[100:103]
    v_exp_f32 v57, v57
    v_exp_f32 v58, v58
    v_mfma_f32_16x16x32_bf16 v[104:107], v[228:231], a[192:195], v[104:107]
    v_exp_f32 v59, v59
    v_mfma_f32_16x16x32_bf16 v[108:111], v[228:231], a[216:219], v[108:111]
    ds_read_b128 v[252:255], v21 offset:128
    s_waitcnt lgkmcnt(4)
    v_mfma_f32_16x16x32_bf16 v[100:103], v[232:235], a[172:175], v[100:103]
    v_cvt_pk_bf16_f32 v142, v56, v57
    v_mfma_f32_16x16x32_bf16 v[104:107], v[232:235], a[196:199], v[104:107]
    v_cvt_pk_bf16_f32 v143, v58, v59
    v_add_f32 v48, v48, v168
    v_mfma_f32_16x16x32_bf16 v[108:111], v[232:235], a[220:223], v[108:111]
    ds_read_b128 v[224:227], v20 offset:256
    v_add_f32 v49, v49, v168
    v_mfma_f32_16x16x32_bf16 v[100:103], v[236:239], a[176:179], v[100:103]
    v_add_f32 v50, v50, v168
    v_add_f32 v51, v51, v168
    v_exp_f32 v48, v48
    v_mfma_f32_16x16x32_bf16 v[104:107], v[236:239], a[200:203], v[104:107]
    v_exp_f32 v49, v49
    v_mfma_f32_16x16x32_bf16 v[108:111], v[236:239], a[224:227], v[108:111]
    ds_read_b128 v[228:231], v21 offset:256
    s_waitcnt lgkmcnt(4)
    v_mfma_f32_16x16x32_bf16 v[112:115], v[240:243], a[156:159], v[160:163]
    v_add_u32 v24, s25, v32
    v_add_u32 v25, s25, v33
    v_exp_f32 v50, v50
    v_mfma_f32_16x16x32_bf16 v[116:119], v[240:243], a[180:183], v[164:167]
    v_add_u32 v26, s25, v34
    v_add_u32 v27, s25, v35
    v_exp_f32 v51, v51
    v_mfma_f32_16x16x32_bf16 v[120:123], v[240:243], a[204:207], v[168:171]
    ds_read_b128 v[232:235], v20 offset:6144
    s_add_u32 s25, s25, 12288
    v_cvt_pk_bf16_f32 v144, v48, v49
    v_mfma_f32_16x16x32_bf16 v[112:115], v[244:247], a[160:163], v[112:115]
    s_sub_u32 s26, s25, 159744
    s_min_u32 s25, s25, s26
    v_cvt_pk_bf16_f32 v145, v50, v51
    v_mfma_f32_16x16x32_bf16 v[116:119], v[244:247], a[184:187], v[116:119]
    v_add_f32 v60, v60, v168
    v_add_f32 v61, v61, v168
    v_add_f32 v62, v62, v168
    v_mfma_f32_16x16x32_bf16 v[120:123], v[244:247], a[208:211], v[120:123]
    ds_read_b128 v[236:239], v21 offset:6144
    s_waitcnt lgkmcnt(4)
    v_mfma_f32_16x16x32_bf16 v[112:115], v[248:251], a[164:167], v[112:115]
    v_add_f32 v63, v63, v168
    v_exp_f32 v60, v60
    v_mfma_f32_16x16x32_bf16 v[116:119], v[248:251], a[188:191], v[116:119]
    v_exp_f32 v61, v61
    v_mfma_f32_16x16x32_bf16 v[120:123], v[248:251], a[212:215], v[120:123]
    ds_read_b128 v[240:243], v20 offset:6272
    v_exp_f32 v62, v62
    v_mfma_f32_16x16x32_bf16 v[112:115], v[252:255], a[168:171], v[112:115]
    v_exp_f32 v63, v63
    v_mfma_f32_16x16x32_bf16 v[116:119], v[252:255], a[192:195], v[116:119]
    v_cvt_pk_bf16_f32 v146, v60, v61
    v_mfma_f32_16x16x32_bf16 v[120:123], v[252:255], a[216:219], v[120:123]
    ds_read_b128 v[244:247], v21 offset:6272
    s_waitcnt lgkmcnt(4)
    v_mfma_f32_16x16x32_bf16 v[112:115], v[224:227], a[172:175], v[112:115]
    v_cvt_pk_bf16_f32 v147, v62, v63
    v_add_f32 v64, v64, v160
    v_mfma_f32_16x16x32_bf16 v[116:119], v[224:227], a[196:199], v[116:119]
    v_add_f32 v65, v65, v160
    v_add_f32 v66, v66, v160
    v_add_f32 v67, v67, v160
    v_mfma_f32_16x16x32_bf16 v[120:123], v[224:227], a[220:223], v[120:123]
    ds_read_b128 v[248:251], v20 offset:6400
    v_exp_f32 v64, v64
    v_mfma_f32_16x16x32_bf16 v[112:115], v[228:231], a[176:179], v[112:115]
    v_exp_f32 v65, v65
    v_mfma_f32_16x16x32_bf16 v[116:119], v[228:231], a[200:203], v[116:119]
    v_exp_f32 v66, v66
    v_mfma_f32_16x16x32_bf16 v[120:123], v[228:231], a[224:227], v[120:123]
    ds_read_b128 v[252:255], v21 offset:6400
    s_waitcnt lgkmcnt(4)
    v_mfma_f32_16x16x32_bf16 v[124:127], v[232:235], a[156:159], v[160:163]
    s_cmp_ge_u32 s28, 26
    s_cbranch_scc0 L_sl3
L_bk3:
    v_mfma_f32_16x16x32_bf16 v[128:131], v[232:235], a[180:183], v[164:167]
    ds_read_b64_tr_b16 v[224:225], v24 offset:0
    v_exp_f32 v67, v67
    v_mfma_f32_16x16x32_bf16 v[132:135], v[232:235], a[204:207], v[168:171]
    ds_read_b64_tr_b16 v[226:227], v24 offset:6144
    v_cvt_pk_bf16_f32 v148, v64, v65
    v_mfma_f32_16x16x32_bf16 v[124:127], v[236:239], a[160:163], v[124:127]
    v_cvt_pk_bf16_f32 v149, v66, v67
    v_add_f32 v76, v76, v160
    v_mfma_f32_16x16x32_bf16 v[128:131], v[236:239], a[184:187], v[128:131]
    ds_read_b64_tr_b16 v[228:229], v25 offset:0
    v_add_f32 v77, v77, v160
    v_mfma_f32_16x16x32_bf16 v[132:135], v[236:239], a[208:211], v[132:135]
    ds_read_b64_tr_b16 v[230:231], v25 offset:6144
    s_waitcnt lgkmcnt(6)
    v_mfma_f32_16x16x32_bf16 v[124:127], v[240:243], a[164:167], v[124:127]
    v_add_f32 v78, v78, v160
    v_add_f32 v79, v79, v160
    v_mfma_f32_16x16x32_bf16 v[128:131], v[240:243], a[188:191], v[128:131]
    ds_read_b64_tr_b16 v[232:233], v26 offset:0
    v_exp_f32 v76, v76
    v_mfma_f32_16x16x32_bf16 v[132:135], v[240:243], a[212:215], v[132:135]
    ds_read_b64_tr_b16 v[234:235], v26 offset:6144
    v_mfma_f32_16x16x32_bf16 v[124:127], v[244:247], a[168:171], v[124:127]
    v_exp_f32 v77, v77
    v_exp_f32 v78, v78
    v_mfma_f32_16x16x32_bf16 v[128:131], v[244:247], a[192:195], v[128:131]
    ds_read_b64_tr_b16 v[236:237], v27 offset:0
    v_mfma_f32_16x16x32_bf16 v[132:135], v[244:247], a[216:219], v[132:135]
    ds_read_b64_tr_b16 v[238:239], v27 offset:6144
    s_waitcnt lgkmcnt(8)
    v_mfma_f32_16x16x32_bf16 v[124:127], v[248:251], a[172:175], v[124:127]
    v_exp_f32 v79, v79
    v_mfma_f32_16x16x32_bf16 v[128:131], v[248:251], a[196:199], v[128:131]
    ds_read_b64_tr_b16 v[240:241], v24 offset:128
    v_cvt_pk_bf16_f32 v150, v76, v77
    v_mfma_f32_16x16x32_bf16 v[132:135], v[248:251], a[220:223], v[132:135]
    ds_read_b64_tr_b16 v[242:243], v24 offset:6272
    v_cvt_pk_bf16_f32 v151, v78, v79
    v_mfma_f32_16x16x32_bf16 v[124:127], v[252:255], a[176:179], v[124:127]
    v_add_u32 v221, 2, v221
    ds_write_b32 v220, v221
    v_add_f32 v68, v68, v164
    v_mfma_f32_16x16x32_bf16 v[128:131], v[252:255], a[200:203], v[128:131]
    ds_read_b64_tr_b16 v[244:245], v25 offset:128
    v_add_f32 v69, v69, v164
    v_mfma_f32_16x16x32_bf16 v[132:135], v[252:255], a[224:227], v[132:135]
    ds_read_b64_tr_b16 v[246:247], v25 offset:6272
    v_add_f32 v70, v70, v164
    v_mfma_f32_16x16x32_bf16 a[144:147], a[228:231], v[136:139], 0
    v_add_u32 v28, s25, v32
    v_add_u32 v29, s25, v33
    v_add_f32 v71, v71, v164
    v_exp_f32 v68, v68
    v_mfma_f32_16x16x32_bf16 a[148:151], a[228:231], v[140:143], 0
    v_add_u32 v30, s25, v34
    v_add_u32 v31, s25, v35
    v_exp_f32 v69, v69
    v_mfma_f32_16x16x32_bf16 a[152:155], a[228:231], v[144:147], 0
    s_add_u32 s25, s25, 12288
    v_exp_f32 v70, v70
    s_waitcnt lgkmcnt(9)
    v_mfma_f32_16x16x32_bf16 a[0:3], v[224:227], v[136:139], 0
    s_sub_u32 s26, s25, 159744
    s_min_u32 s25, s25, s26
    v_exp_f32 v71, v71
    v_mfma_f32_16x16x32_bf16 a[4:7], v[224:227], v[140:143], 0
    ds_read_b64_tr_b16 v[248:249], v26 offset:128
    v_cvt_pk_bf16_f32 v152, v68, v69
    v_mfma_f32_16x16x32_bf16 a[8:11], v[224:227], v[144:147], 0
    ds_read_b64_tr_b16 v[250:251], v26 offset:6272
    v_cvt_pk_bf16_f32 v153, v70, v71
    v_mfma_f32_16x16x32_bf16 a[12:15], v[228:231], v[136:139], 0
    v_add_f32 v80, v80, v164
    v_add_f32 v81, v81, v164
    v_mfma_f32_16x16x32_bf16 a[16:19], v[228:231], v[140:143], 0
    ds_read_b64_tr_b16 v[252:253], v27 offset:128
    v_add_f32 v82, v82, v164
    v_mfma_f32_16x16x32_bf16 a[20:23], v[228:231], v[144:147], 0
    ds_read_b64_tr_b16 v[254:255], v27 offset:6272
    s_waitcnt lgkmcnt(9)
    v_mfma_f32_16x16x32_bf16 a[24:27], v[232:235], v[136:139], 0
    v_add_f32 v83, v83, v164
    v_exp_f32 v80, v80
    v_mfma_f32_16x16x32_bf16 a[28:31], v[232:235], v[140:143], 0
    ds_read_b64_tr_b16 v[224:225], v24 offset:256
    v_max3_f32 v172, v88, v89, v90
    v_mfma_f32_16x16x32_bf16 a[32:35], v[232:235], v[144:147], 0
    ds_read_b64_tr_b16 v[226:227], v24 offset:6400
    v_exp_f32 v81, v81
    v_mfma_f32_16x16x32_bf16 a[36:39], v[236:239], v[136:139], 0
    v_exp_f32 v82, v82
    v_mfma_f32_16x16x32_bf16 a[40:43], v[236:239], v[140:143], 0
    ds_read_b64_tr_b16 v[228:229], v25 offset:256
    v_exp_f32 v83, v83
    v_mfma_f32_16x16x32_bf16 a[44:47], v[236:239], v[144:147], 0
    ds_read_b64_tr_b16 v[230:231], v25 offset:6400
    s_waitcnt lgkmcnt(8)
    v_mfma_f32_16x16x32_bf16 a[48:51], v[240:243], v[136:139], 0
    v_cvt_pk_bf16_f32 v154, v80, v81
    v_max3_f32 v173, v92, v93, v94
    v_mfma_f32_16x16x32_bf16 a[52:55], v[240:243], v[140:143], 0
    ds_read_b64_tr_b16 v[232:233], v26 offset:256
    v_cvt_pk_bf16_f32 v155, v82, v83
    v_mfma_f32_16x16x32_bf16 a[56:59], v[240:243], v[144:147], 0
    ds_read_b64_tr_b16 v[234:235], v26 offset:6400
    v_add_f32 v72, v72, v168
    v_add_f32 v73, v73, v168
    v_mfma_f32_16x16x32_bf16 a[60:63], v[244:247], v[136:139], 0
    v_add_f32 v74, v74, v168
    v_add_f32 v75, v75, v168
    v_mfma_f32_16x16x32_bf16 a[64:67], v[244:247], v[140:143], 0
    ds_read_b64_tr_b16 v[236:237], v27 offset:256
    v_exp_f32 v72, v72
    v_mfma_f32_16x16x32_bf16 a[68:71], v[244:247], v[144:147], 0
    ds_read_b64_tr_b16 v[238:239], v27 offset:6400
    s_waitcnt lgkmcnt(8)
    v_mfma_f32_16x16x32_bf16 a[72:75], v[248:251], v[136:139], 0
    v_exp_f32 v73, v73
    v_mfma_f32_16x16x32_bf16 a[76:79], v[248:251], v[140:143], 0
    ds_read_b64_tr_b16 v[240:241], v28 offset:0
    v_exp_f32 v74, v74
    v_mfma_f32_16x16x32_bf16 a[80:83], v[248:251], v[144:147], 0
    ds_read_b64_tr_b16 v[242:243], v28 offset:6144
    v_max3_f32 v174, v96, v97, v98
    v_mfma_f32_16x16x32_bf16 a[84:87], v[252:255], v[136:139], 0
    v_exp_f32 v75, v75
    v_mfma_f32_16x16x32_bf16 a[88:91], v[252:255], v[140:143], 0
    ds_read_b64_tr_b16 v[244:245], v29 offset:0
    v_cvt_pk_bf16_f32 v156, v72, v73
    v_mfma_f32_16x16x32_bf16 a[92:95], v[252:255], v[144:147], 0
    ds_read_b64_tr_b16 v[246:247], v29 offset:6144
    v_cvt_pk_bf16_f32 v157, v74, v75
    s_waitcnt lgkmcnt(8)
    v_mfma_f32_16x16x32_bf16 a[96:99], v[224:227], v[136:139], 0
    v_add_f32 v84, v84, v168
    v_add_f32 v85, v85, v168
    v_mfma_f32_16x16x32_bf16 a[100:103], v[224:227], v[140:143], 0
    ds_read_b64_tr_b16 v[248:249], v30 offset:0
    v_add_f32 v86, v86, v168
    v_mfma_f32_16x16x32_bf16 a[104:107], v[224:227], v[144:147], 0
    ds_read_b64_tr_b16 v[250:251], v30 offset:6144
    v_add_f32 v87, v87, v168
    v_mfma_f32_16x16x32_bf16 a[108:111], v[228:231], v[136:139], 0
    v_exp_f32 v84, v84
    v_mfma_f32_16x16x32_bf16 a[112:115], v[228:231], v[140:143], 0
    ds_read_b64_tr_b16 v[252:253], v31 offset:0
    v_exp_f32 v85, v85
    v_mfma_f32_16x16x32_bf16 a[116:119], v[228:231], v[144:147], 0
    ds_read_b64_tr_b16 v[254:255], v31 offset:6144
    s_waitcnt lgkmcnt(8)
    v_mfma_f32_16x16x32_bf16 a[120:123], v[232:235], v[136:139], 0
    v_exp_f32 v86, v86
    v_mfma_f32_16x16x32_bf16 a[124:127], v[232:235], v[140:143], 0
    ds_read_b64_tr_b16 v[224:225], v28 offset:128
    v_exp_f32 v87, v87
    v_mfma_f32_16x16x32_bf16 a[128:131], v[232:235], v[144:147], 0
    ds_read_b64_tr_b16 v[226:227], v28 offset:6272
    v_cvt_pk_bf16_f32 v158, v84, v85
    v_mfma_f32_16x16x32_bf16 a[132:135], v[236:239], v[136:139], 0
    v_cvt_pk_bf16_f32 v159, v86, v87
    v_max3_f32 v172, v172, v91, v100
    v_mfma_f32_16x16x32_bf16 a[136:139], v[236:239], v[140:143], 0
    ds_read_b64_tr_b16 v[228:229], v29 offset:128
    v_max3_f32 v173, v173, v95, v104
    v_mfma_f32_16x16x32_bf16 a[140:143], v[236:239], v[144:147], 0
    ds_read_b64_tr_b16 v[230:231], v29 offset:6272
    v_max3_f32 v174, v174, v99, v108
    v_mfma_f32_16x16x32_bf16 a[144:147], a[228:231], v[148:151], a[144:147]
    v_add_u32 v18, s25, v22
    v_add_u32 v19, s25, v23
    v_mfma_f32_16x16x32_bf16 a[148:151], a[228:231], v[152:155], a[148:151]
    s_add_u32 s25, s25, 12288
    s_sub_u32 s26, s25, 159744
    v_mfma_f32_16x16x32_bf16 a[152:155], a[228:231], v[156:159], a[152:155]
    s_min_u32 s25, s25, s26
    s_waitcnt lgkmcnt(8)
    v_mfma_f32_16x16x32_bf16 a[0:3], v[240:243], v[148:151], a[0:3]
    v_max3_f32 v172, v172, v101, v102
    v_max3_f32 v173, v173, v105, v106
    v_mfma_f32_16x16x32_bf16 a[4:7], v[240:243], v[152:155], a[4:7]
    ds_read_b64_tr_b16 v[232:233], v30 offset:128
    v_max3_f32 v174, v174, v109, v110
    v_mfma_f32_16x16x32_bf16 a[8:11], v[240:243], v[156:159], a[8:11]
    ds_read_b64_tr_b16 v[234:235], v30 offset:6272
    v_max3_f32 v172, v172, v103, v112
    v_mfma_f32_16x16x32_bf16 a[12:15], v[244:247], v[148:151], a[12:15]
    v_max3_f32 v173, v173, v107, v116
    v_max3_f32 v174, v174, v111, v120
    v_mfma_f32_16x16x32_bf16 a[16:19], v[244:247], v[152:155], a[16:19]
    ds_read_b64_tr_b16 v[236:237], v31 offset:128
    v_max3_f32 v172, v172, v113, v114
    v_mfma_f32_16x16x32_bf16 a[20:23], v[244:247], v[156:159], a[20:23]
    ds_read_b64_tr_b16 v[238:239], v31 offset:6272
    s_waitcnt lgkmcnt(8)
    v_mfma_f32_16x16x32_bf16 a[24:27], v[248:251], v[148:151], a[24:27]
    v_max3_f32 v173, v173, v117, v118
    v_max3_f32 v174, v174, v121, v122
    v_mfma_f32_16x16x32_bf16 a[28:31], v[248:251], v[152:155], a[28:31]
    ds_read_b64_tr_b16 v[240:241], v28 offset:256
    v_max3_f32 v172, v172, v115, v124
    v_mfma_f32_16x16x32_bf16 a[32:35], v[248:251], v[156:159], a[32:35]
    ds_read_b64_tr_b16 v[242:243], v28 offset:6400
    v_max3_f32 v173, v173, v119, v128
    v_mfma_f32_16x16x32_bf16 a[36:39], v[252:255], v[148:151], a[36:39]
    v_max3_f32 v174, v174, v123, v132
    v_max3_f32 v172, v172, v125, v126
    v_mfma_f32_16x16x32_bf16 a[40:43], v[252:255], v[152:155], a[40:43]
    ds_read_b64_tr_b16 v[244:245], v29 offset:256
    v_max3_f32 v173, v173, v129, v130
    v_mfma_f32_16x16x32_bf16 a[44:47], v[252:255], v[156:159], a[44:47]
    ds_read_b64_tr_b16 v[246:247], v29 offset:6400
    s_waitcnt lgkmcnt(8)
    v_mfma_f32_16x16x32_bf16 a[48:51], v[224:227], v[148:151], a[48:51]
    v_max3_f32 v174, v174, v133, v134
    v_max_f32 v172, v172, v127
    v_mfma_f32_16x16x32_bf16 a[52:55], v[224:227], v[152:155], a[52:55]
    ds_read_b64_tr_b16 v[248:249], v30 offset:256
    v_max_f32 v173, v173, v131
    v_mfma_f32_16x16x32_bf16 a[56:59], v[224:227], v[156:159], a[56:59]
    ds_read_b64_tr_b16 v[250:251], v30 offset:6400
    v_max_f32 v174, v174, v135
    v_mfma_f32_16x16x32_bf16 a[60:63], v[228:231], v[148:151], a[60:63]
    v_max3_f32 v175, v172, v173, v174
    v_mfma_f32_16x16x32_bf16 a[64:67], v[228:231], v[152:155], a[64:67]
    ds_read_b64_tr_b16 v[252:253], v31 offset:256
    v_mfma_f32_16x16x32_bf16 a[68:71], v[228:231], v[156:159], a[68:71]
    ds_read_b64_tr_b16 v[254:255], v31 offset:6400
    s_waitcnt lgkmcnt(8)
    v_mfma_f32_16x16x32_bf16 a[72:75], v[232:235], v[148:151], a[72:75]
    s_cmp_ge_u32 s28, 28
    s_cbranch_scc0 L_sl4
L_bk4:
    v_mfma_f32_16x16x32_bf16 a[76:79], v[232:235], v[152:155], a[76:79]
    v_mfma_f32_16x16x32_bf16 a[80:83], v[232:235], v[156:159], a[80:83]
    ds_read_b128 v[224:227], v18 offset:0
    v_mfma_f32_16x16x32_bf16 a[84:87], v[236:239], v[148:151], a[84:87]
    v_mfma_f32_16x16x32_bf16 a[88:91], v[236:239], v[152:155], a[88:91]
    v_mfma_f32_16x16x32_bf16 a[92:95], v[236:239], v[156:159], a[92:95]
    ds_read_b128 v[228:231], v19 offset:0
    s_waitcnt lgkmcnt(6)
    v_mfma_f32_16x16x32_bf16 a[96:99], v[240:243], v[148:151], a[96:99]
    v_mfma_f32_16x16x32_bf16 a[100:103], v[240:243], v[152:155], a[100:103]
    v_mfma_f32_16x16x32_bf16 a[104:107], v[240:243], v[156:159], a[104:107]
    ds_read_b128 v[232:235], v18 offset:128
    v_mfma_f32_16x16x32_bf16 a[108:111], v[244:247], v[148:151], a[108:111]
    v_mfma_f32_16x16x32_bf16 a[112:115], v[244:247], v[152:155], a[112:115]
    v_mfma_f32_16x16x32_bf16 a[116:119], v[244:247], v[156:159], a[116:119]
    ds_read_b128 v[236:239], v19 offset:128
    s_waitcnt lgkmcnt(4)
    v_mfma_f32_16x16x32_bf16 a[120:123], v[248:251], v[148:151], a[120:123]
    v_mfma_f32_16x16x32_bf16 a[124:127], v[248:251], v[152:155], a[124:127]
    v_mfma_f32_16x16x32_bf16 a[128:131], v[248:251], v[156:159], a[128:131]
    ds_read_b128 v[240:243], v18 offset:256
    v_mfma_f32_16x16x32_bf16 a[132:135], v[252:255], v[148:151], a[132:135]
    v_add_u32 v221, 2, v221
    ds_write_b32 v220, v221
    v_mfma_f32_16x16x32_bf16 a[136:139], v[252:255], v[152:155], a[136:139]
    v_mfma_f32_16x16x32_bf16 a[140:143], v[252:255], v[156:159], a[140:143]
    ds_read_b128 v[244:247], v19 offset:256
    v_cmp_lt_f32 vcc, s63, v175
    s_cbranch_vccz L_norarea
    s_call_b64 s[66:67], L_rare1
L_norarea:
    s_mov_b32 s29, 28
L_B:
    s_waitcnt lgkmcnt(5)
    v_mfma_f32_16x16x32_bf16 v[40:43], v[224:227], a[156:159], v[160:163]
    v_add_u32 v20, s25, v22
    v_add_u32 v21, s25, v23
    v_mfma_f32_16x16x32_bf16 v[44:47], v[224:227], a[180:183], v[164:167]
    s_add_u32 s25, s25, 12288
    s_sub_u32 s26, s25, 159744
    v_mfma_f32_16x16x32_bf16 v[48:51], v[224:227], a[204:207], v[168:171]
    ds_read_b128 v[248:251], v18 offset:6144
    s_min_u32 s25, s25, s26
    v_mfma_f32_16x16x32_bf16 v[40:43], v[228:231], a[160:163], v[40:43]
    v_exp_f32 v88, v88
    v_mfma_f32_16x16x32_bf16 v[44:47], v[228:231], a[184:187], v[44:47]
    v_exp_f32 v89, v89
    v_mfma_f32_16x16x32_bf16 v[48:51], v[228:231], a[208:211], v[48:51]
    ds_read_b128 v[252:255], v19 offset:6144
    s_waitcnt lgkmcnt(5)
    v_mfma_f32_16x16x32_bf16 v[40:43], v[232:235], a[164:167], v[40:43]
    v_exp_f32 v90, v90
    v_mfma_f32_16x16x32_bf16 v[44:47], v[232:235], a[188:191], v[44:47]
    v_exp_f32 v91, v91
    v_mfma_f32_16x16x32_bf16 v[48:51], v[232:235], a[212:215], v[48:51]
    ds_read_b128 v[224:227], v18 offset:6272
    v_cvt_pk_bf16_f32 v136, v88, v89
    v_mfma_f32_16x16x32_bf16 v[40:43], v[236:239], a[168:171], v[40:43]
    v_cvt_pk_bf16_f32 v137, v90, v91
    v_mfma_f32_16x16x32_bf16 v[44:47], v[236:239], a[192:195], v[44:47]
    v_exp_f32 v100, v100
    v_mfma_f32_16x16x32_bf16 v[48:51], v[236:239], a[216:219], v[48:51]
    ds_read_b128 v[228:231], v19 offset:6272
    s_waitcnt lgkmcnt(4)
    v_mfma_f32_16x16x32_bf16 v[40:43], v[240:243], a[172:175], v[40:43]
    v_exp_f32 v101, v101
    v_mfma_f32_16x16x32_bf16 v[44:47], v[240:243], a[196:199], v[44:47]
    v_exp_f32 v102, v102
    v_mfma_f32_16x16x32_bf16 v[48:51], v[240:243], a[220:223], v[48:51]
    ds_read_b128 v[232:235], v18 offset:6400
    v_mfma_f32_16x16x32_bf16 v[40:43], v[244:247], a[176:179], v[40:43]
    v_exp_f32 v103, v103
    v_mfma_f32_16x16x32_bf16 v[44:47], v[244:247], a[200:203], v[44:47]
    v_cvt_pk_bf16_f32 v138, v100, v101
    v_mfma_f32_16x16x32_bf16 v[48:51], v[244:247], a[224:227], v[48:51]
    ds_read_b128 v[236:239], v19 offset:6400
    s_waitcnt lgkmcnt(4)
    v_mfma_f32_16x16x32_bf16 v[52:55], v[248:251], a[156:159], v[160:163]
    v_cvt_pk_bf16_f32 v139, v102, v103
    v_mfma_f32_16x16x32_bf16 v[56:59], v[248:251], a[180:183], v[164:167]
    v_exp_f32 v92, v92
    v_mfma_f32_16x16x32_bf16 v[60:63], v[248:251], a[204:207], v[168:171]
    ds_read_b128 v[240:243], v20 offset:0
    v_mfma_f32_16x16x32_bf16 v[52:55], v[252:255], a[160:163], v[52:55]
    v_exp_f32 v93, v93
    v_mfma_f32_16x16x32_bf16 v[56:59], v[252:255], a[184:187], v[56:59]
    v_exp_f32 v94, v94
    v_mfma_f32_16x16x32_bf16 v[60:63], v[252:255], a[208:211], v[60:63]
    ds_read_b128 v[244:247], v21 offset:0
    s_waitcnt lgkmcnt(4)
    v_mfma_f32_16x16x32_bf16 v[52:55], v[224:227], a[164:167], v[52:55]
    v_exp_f32 v95, v95
    v_mfma_f32_16x16x32_bf16 v[56:59], v[224:227], a[188:191], v[56:59]
    v_cvt_pk_bf16_f32 v140, v92, v93
    v_mfma_f32_16x16x32_bf16 v[60:63], v[224:227], a[212:215], v[60:63]
    ds_read_b128 v[248:251], v20 offset:128
    v_cvt_pk_bf16_f32 v141, v94, v95
    v_mfma_f32_16x16x32_bf16 v[52:55], v[228:231], a[168:171], v[52:55]
    v_exp_f32 v104, v104
    v_mfma_f32_16x16x32_bf16 v[56:59], v[228:231], a[192:195], v[56:59]
    v_exp_f32 v105, v105
    v_mfma_f32_16x16x32_bf16 v[60:63], v[228:231], a[216:219], v[60:63]
    ds_read_b128 v[252:255], v21 offset:128
    s_waitcnt lgkmcnt(4)
    v_mfma_f32_16x16x32_bf16 v[52:55], v[232:235], a[172:175], v[52:55]
    v_exp_f32 v106, v106
    v_mfma_f32_16x16x32_bf16 v[56:59], v[232:235], a[196:199], v[56:59]
    v_exp_f32 v107, v107
    v_mfma_f32_16x16x32_bf16 v[60:63], v[232:235], a[220:223], v[60:63]
    ds_read_b128 v[224:227], v20 offset:256
    v_cvt_pk_bf16_f32 v142, v104, v105
    v_mfma_f32_16x16x32_bf16 v[52:55], v[236:239], a[176:179], v[52:55]
    v_cvt_pk_bf16_f32 v143, v106, v107
    v_mfma_f32_16x16x32_bf16 v[56:59], v[236:239], a[200:203], v[56:59]
    v_exp_f32 v96, v96
    v_mfma_f32_16x16x32_bf16 v[60:63], v[236:239], a[224:227], v[60:63]
    ds_read_b128 v[228:231], v21 offset:256
    s_waitcnt lgkmcnt(4)
    v_mfma_f32_16x16x32_bf16 v[64:67], v[240:243], a[156:159], v[160:163]
    v_add_u32 v24, s25, v32
    v_add_u32 v25, s25, v33
    v_mfma_f32_16x16x32_bf16 v[68:71], v[240:243], a[180:183], v[164:167]
    v_add_u32 v26, s25, v34
    v_add_u32 v27, s25, v35
    v_mfma_f32_16x16x32_bf16 v[72:75], v[240:243], a[204:207], v[168:171]
    ds_read_b128 v[232:235], v20 offset:6144
    s_add_u32 s25, s25, 12288
    v_mfma_f32_16x16x32_bf16 v[64:67], v[244:247], a[160:163], v[64:67]
    s_sub_u32 s26, s25, 159744
    s_min_u32 s25, s25, s26
    v_mfma_f32_16x16x32_bf16 v[68:71], v[244:247], a[184:187], v[68:71]
    v_exp_f32 v97, v97
    v_mfma_f32_16x16x32_bf16 v[72:75], v[244:247], a[208:211], v[72:75]
    ds_read_b128 v[236:239], v21 offset:6144
    s_waitcnt lgkmcnt(4)
    v_mfma_f32_16x16x32_bf16 v[64:67], v[248:251], a[164:167], v[64:67]
    v_exp_f32 v98, v98
    v_mfma_f32_16x16x32_bf16 v[68:71], v[248:251], a[188:191], v[68:71]
    v_exp_f32 v99, v99
    v_mfma_f32_16x16x32_bf16 v[72:75], v[248:251], a[212:215], v[72:75]
    ds_read_b128 v[240:243], v20 offset:6272
    v_cvt_pk_bf16_f32 v144, v96, v97
    v_mfma_f32_16x16x32_bf16 v[64:67], v[252:255], a[168:171], v[64:67]
    v_cvt_pk_bf16_f32 v145, v98, v99
    v_mfma_f32_16x16x32_bf16 v[68:71], v[252:255], a[192:195], v[68:71]
    v_exp_f32 v108, v108
    v_mfma_f32_16x16x32_bf16 v[72:75], v[252:255], a[216:219], v[72:75]
    ds_read_b128 v[244:247], v21 offset:6272
    s_waitcnt lgkmcnt(4)
    v_mfma_f32_16x16x32_bf16 v[64:67], v[224:227], a[172:175], v[64:67]
    v_exp_f32 v109, v109
    v_mfma_f32_16x16x32_bf16 v[68:71], v[224:227], a[196:199], v[68:71]
    v_exp_f32 v110, v110
    v_mfma_f32_16x16x32_bf16 v[72:75], v[224:227], a[220:223], v[72:75]
    ds_read_b128 v[248:251], v20 offset:6400
    v_mfma_f32_16x16x32_bf16 v[64:67], v[228:231], a[176:179], v[64:67]
    v_exp_f32 v111, v111
    v_mfma_f32_16x16x32_bf16 v[68:71], v[228:231], a[200:203], v[68:71]
    v_cvt_pk_bf16_f32 v146, v108, v109
    v_mfma_f32_16x16x32_bf16 v[72:75], v[228:231], a[224:227], v[72:75]
    ds_read_b128 v[252:255], v21 offset:6400
    s_waitcnt lgkmcnt(4)
    v_mfma_f32_16x16x32_bf16 v[76:79], v[232:235], a[156:159], v[160:163]
    s_add_u32 s29, s29, 2
    s_cmp_ge_u32 s28, s29
    s_cbranch_scc0 L_sl5
L_bk5:
    v_mfma_f32_16x16x32_bf16 v[80:83], v[232:235], a[180:183], v[164:167]
    ds_read_b64_tr_b16 v[224:225], v24 offset:0
    v_cvt_pk_bf16_f32 v147, v110, v111
    v_mfma_f32_16x16x32_bf16 v[84:87], v[232:235], a[204:207], v[168:171]
    ds_read_b64_tr_b16 v[226:227], v24 offset:6144
    v_mfma_f32_16x16x32_bf16 v[76:79], v[236:239], a[160:163], v[76:79]
    v_exp_f32 v112, v112
    v_mfma_f32_16x16x32_bf16 v[80:83], v[236:239], a[184:187], v[80:83]
    ds_read_b64_tr_b16 v[228:229], v25 offset:0
    v_mfma_f32_16x16x32_bf16 v[84:87], v[236:239], a[208:211], v[84:87]
    ds_read_b64_tr_b16 v[230:231], v25 offset:6144
    s_waitcnt lgkmcnt(6)
    v_mfma_f32_16x16x32_bf16 v[76:79], v[240:243], a[164:167], v[76:79]
    v_exp_f32 v113, v113
    v_mfma_f32_16x16x32_bf16 v[80:83], v[240:243], a[188:191], v[80:83]
    ds_read_b64_tr_b16 v[232:233], v26 offset:0
    v_mfma_f32_16x16x32_bf16 v[84:87], v[240:243], a[212:215], v[84:87]
    ds_read_b64_tr_b16 v[234:235], v26 offset:6144
    v_mfma_f32_16x16x32_bf16 v[76:79], v[244:247], a[168:171], v[76:79]
    v_exp_f32 v114, v114
    v_mfma_f32_16x16x32_bf16 v[80:83], v[244:247], a[192:195], v[80:83]
    ds_read_b64_tr_b16 v[236:237], v27 offset:0
    v_mfma_f32_16x16x32_bf16 v[84:87], v[244:247], a[216:219], v[84:87]
    ds_read_b64_tr_b16 v[238:239], v27 offset:6144
    s_waitcnt lgkmcnt(8)
    v_mfma_f32_16x16x32_bf16 v[76:79], v[248:251], a[172:175], v[76:79]
    v_exp_f32 v115, v115
    v_mfma_f32_16x16x32_bf16 v[80:83], v[248:251], a[196:199], v[80:83]
    ds_read_b64_tr_b16 v[240:241], v24 offset:128
    v_cvt_pk_bf16_f32 v148, v112, v113
    v_mfma_f32_16x16x32_bf16 v[84:87], v[248:251], a[220:223], v[84:87]
    ds_read_b64_tr_b16 v[242:243], v24 offset:6272
    v_cvt_pk_bf16_f32 v149, v114, v115
    v_mfma_f32_16x16x32_bf16 v[76:79], v[252:255], a[176:179], v[76:79]
    v_add_u32 v221, 2, v221
    ds_write_b32 v220, v221
    v_mfma_f32_16x16x32_bf16 v[80:83], v[252:255], a[200:203], v[80:83]
    ds_read_b64_tr_b16 v[244:245], v25 offset:128
    v_mfma_f32_16x16x32_bf16 v[84:87], v[252:255], a[224:227], v[84:87]
    ds_read_b64_tr_b16 v[246:247], v25 offset:6272
    v_mfma_f32_16x16x32_bf16 a[144:147], a[228:231], v[136:139], a[144:147]
    v_add_u32 v28, s25, v32
    v_add_u32 v29, s25, v33
    v_mfma_f32_16x16x32_bf16 a[148:151], a[228:231], v[140:143], a[148:151]
    v_add_u32 v30, s25, v34
    v_add_u32 v31, s25, v35
    v_mfma_f32_16x16x32_bf16 a[152:155], a[228:231], v[144:147], a[152:155]
    s_add_u32 s25, s25, 12288
    s_waitcnt lgkmcnt(9)
    v_mfma_f32_16x16x32_bf16 a[0:3], v[224:227], v[136:139], a[0:3]
    s_sub_u32 s26, s25, 159744
    s_min_u32 s25, s25, s26
    v_mfma_f32_16x16x32_bf16 a[4:7], v[224:227], v[140:143], a[4:7]
    ds_read_b64_tr_b16 v[248:249], v26 offset:128
    v_mfma_f32_16x16x32_bf16 a[8:11], v[224:227], v[144:147], a[8:11]
    ds_read_b64_tr_b16 v[250:251], v26 offset:6272
    v_mfma_f32_16x16x32_bf16 a[12:15], v[228:231], v[136:139], a[12:15]
    v_exp_f32 v124, v124
    v_mfma_f32_16x16x32_bf16 a[16:19], v[228:231], v[140:143], a[16:19]
    ds_read_b64_tr_b16 v[252:253], v27 offset:128
    v_exp_f32 v125, v125
    v_mfma_f32_16x16x32_bf16 a[20:23], v[228:231], v[144:147], a[20:23]
    ds_read_b64_tr_b16 v[254:255], v27 offset:6272
    s_waitcnt lgkmcnt(9)
    v_mfma_f32_16x16x32_bf16 a[24:27], v[232:235], v[136:139], a[24:27]
    v_exp_f32 v126, v126
    v_mfma_f32_16x16x32_bf16 a[28:31], v[232:235], v[140:143], a[28:31]
    ds_read_b64_tr_b16 v[224:225], v24 offset:256
    v_exp_f32 v127, v127
    v_mfma_f32_16x16x32_bf16 a[32:35], v[232:235], v[144:147], a[32:35]
    ds_read_b64_tr_b16 v[226:227], v24 offset:6400
    v_cvt_pk_bf16_f32 v150, v124, v125
    v_mfma_f32_16x16x32_bf16 a[36:39], v[236:239], v[136:139], a[36:39]
    v_cvt_pk_bf16_f32 v151, v126, v127
    v_exp_f32 v116, v116
    v_mfma_f32_16x16x32_bf16 a[40:43], v[236:239], v[140:143], a[40:43]
    ds_read_b64_tr_b16 v[228:229], v25 offset:256
    v_exp_f32 v117, v117
    v_mfma_f32_16x16x32_bf16 a[44:47], v[236:239], v[144:147], a[44:47]
    ds_read_b64_tr_b16 v[230:231], v25 offset:6400
    s_waitcnt lgkmcnt(8)
    v_mfma_f32_16x16x32_bf16 a[48:51], v[240:243], v[136:139], a[48:51]
    v_exp_f32 v118, v118
    v_mfma_f32_16x16x32_bf16 a[52:55], v[240:243], v[140:143], a[52:55]
    ds_read_b64_tr_b16 v[232:233], v26 offset:256
    v_exp_f32 v119, v119
    v_mfma_f32_16x16x32_bf16 a[56:59], v[240:243], v[144:147], a[56:59]
    ds_read_b64_tr_b16 v[234:235], v26 offset:6400
    v_cvt_pk_bf16_f32 v152, v116, v117
    v_mfma_f32_16x16x32_bf16 a[60:63], v[244:247], v[136:139], a[60:63]
    v_cvt_pk_bf16_f32 v153, v118, v119
    v_exp_f32 v128, v128
    v_mfma_f32_16x16x32_bf16 a[64:67], v[244:247], v[140:143], a[64:67]
    ds_read_b64_tr_b16 v[236:237], v27 offset:256
    v_exp_f32 v129, v129
    v_mfma_f32_16x16x32_bf16 a[68:71], v[244:247], v[144:147], a[68:71]
    ds_read_b64_tr_b16 v[238:239], v27 offset:6400
    s_waitcnt lgkmcnt(8)
    v_mfma_f32_16x16x32_bf16 a[72:75], v[248:251], v[136:139], a[72:75]
    v_exp_f32 v130, v130
    v_mfma_f32_16x16x32_bf16 a[76:79], v[248:251], v[140:143], a[76:79]
    ds_read_b64_tr_b16 v[240:241], v28 offset:0
    v_exp_f32 v131, v131
    v_mfma_f32_16x16x32_bf16 a[80:83], v[248:251], v[144:147], a[80:83]
    ds_read_b64_tr_b16 v[242:243], v28 offset:6144
    v_cvt_pk_bf16_f32 v154, v128, v129
    v_mfma_f32_16x16x32_bf16 a[84:87], v[252:255], v[136:139], a[84:87]
    v_cvt_pk_bf16_f32 v155, v130, v131
    v_exp_f32 v120, v120
    v_mfma_f32_16x16x32_bf16 a[88:91], v[252:255], v[140:143], a[88:91]
    ds_read_b64_tr_b16 v[244:245], v29 offset:0
    v_exp_f32 v121, v121
    v_mfma_f32_16x16x32_bf16 a[92:95], v[252:255], v[144:147], a[92:95]
    ds_read_b64_tr_b16 v[246:247], v29 offset:6144
    s_waitcnt lgkmcnt(8)
    v_mfma_f32_16x16x32_bf16 a[96:99], v[224:227], v[136:139], a[96:99]
    v_exp_f32 v122, v122
    v_mfma_f32_16x16x32_bf16 a[100:103], v[224:227], v[140:143], a[100:103]
    ds_read_b64_tr_b16 v[248:249], v30 offset:0
    v_exp_f32 v123, v123
    v_mfma_f32_16x16x32_bf16 a[104:107], v[224:227], v[144:147], a[104:107]
    ds_read_b64_tr_b16 v[250:251], v30 offset:6144
    v_cvt_pk_bf16_f32 v156, v120, v121
    v_mfma_f32_16x16x32_bf16 a[108:111], v[228:231], v[136:139], a[108:111]
    v_cvt_pk_bf16_f32 v157, v122, v123
    v_exp_f32 v132, v132
    v_mfma_f32_16x16x32_bf16 a[112:115], v[228:231], v[140:143], a[112:115]
    ds_read_b64_tr_b16 v[252:253], v31 offset:0
    v_max3_f32 v172, v40, v41, v42
    v_mfma_f32_16x16x32_bf16 a[116:119], v[228:231], v[144:147], a[116:119]
    ds_read_b64_tr_b16 v[254:255], v31 offset:6144
    v_exp_f32 v133, v133
    s_waitcnt lgkmcnt(8)
    v_mfma_f32_16x16x32_bf16 a[120:123], v[232:235], v[136:139], a[120:123]
    v_exp_f32 v134, v134
    v_mfma_f32_16x16x32_bf16 a[124:127], v[232:235], v[140:143], a[124:127]
    ds_read_b64_tr_b16 v[224:225], v28 offset:128
    v_exp_f32 v135, v135
    v_mfma_f32_16x16x32_bf16 a[128:131], v[232:235], v[144:147], a[128:131]
    ds_read_b64_tr_b16 v[226:227], v28 offset:6272
    v_cvt_pk_bf16_f32 v158, v132, v133
    v_mfma_f32_16x16x32_bf16 a[132:135], v[236:239], v[136:139], a[132:135]
    v_cvt_pk_bf16_f32 v159, v134, v135
    v_max3_f32 v173, v44, v45, v46
    v_mfma_f32_16x16x32_bf16 a[136:139], v[236:239], v[140:143], a[136:139]
    ds_read_b64_tr_b16 v[228:229], v29 offset:128
    v_max3_f32 v174, v48, v49, v50
    v_mfma_f32_16x16x32_bf16 a[140:143], v[236:239], v[144:147], a[140:143]
    ds_read_b64_tr_b16 v[230:231], v29 offset:6272
    v_max3_f32 v172, v172, v43, v52
    v_mfma_f32_16x16x32_bf16 a[144:147], a[228:231], v[148:151], a[144:147]
    v_add_u32 v18, s25, v22
    v_add_u32 v19, s25, v23
    v_mfma_f32_16x16x32_bf16 a[148:151], a[228:231], v[152:155], a[148:151]
    s_add_u32 s25, s25, 12288
    s_sub_u32 s26, s25, 159744
    v_mfma_f32_16x16x32_bf16 a[152:155], a[228:231], v[156:159], a[152:155]
    s_min_u32 s25, s25, s26
    s_waitcnt lgkmcnt(8)
    v_mfma_f32_16x16x32_bf16 a[0:3], v[240:243], v[148:151], a[0:3]
    v_max3_f32 v173, v173, v47, v56
    v_max3_f32 v174, v174, v51, v60
    v_mfma_f32_16x16x32_bf16 a[4:7], v[240:243], v[152:155], a[4:7]
    ds_read_b64_tr_b16 v[232:233], v30 offset:128
    v_max3_f32 v172, v172, v53, v54
    v_mfma_f32_16x16x32_bf16 a[8:11], v[240:243], v[156:159], a[8:11]
    ds_read_b64_tr_b16 v[234:235], v30 offset:6272
    v_max3_f32 v173, v173, v57, v58
    v_mfma_f32_16x16x32_bf16 a[12:15], v[244:247], v[148:151], a[12:15]
    v_max3_f32 v174, v174, v61, v62
    v_max3_f32 v172, v172, v55, v64
    v_mfma_f32_16x16x32_bf16 a[16:19], v[244:247], v[152:155], a[16:19]
    ds_read_b64_tr_b16 v[236:237], v31 offset:128
    v_max3_f32 v173, v173, v59, v68
    v_mfma_f32_16x16x32_bf16 a[20:23], v[244:247], v[156:159], a[20:23]
    ds_read_b64_tr_b16 v[238:239], v31 offset:6272
    s_waitcnt lgkmcnt(8)
    v_mfma_f32_16x16x32_bf16 a[24:27], v[248:251], v[148:151], a[24:27]
    v_max3_f32 v174, v174, v63, v72
    v_max3_f32 v172, v172, v65, v66
    v_mfma_f32_16x16x32_bf16 a[28:31], v[248:251], v[152:155], a[28:31]
    ds_read_b64_tr_b16 v[240:241], v28 offset:256
    v_max3_f32 v173, v173, v69, v70
    v_mfma_f32_16x16x32_bf16 a[32:35], v[248:251], v[156:159], a[32:35]
    ds_read_b64_tr_b16 v[242:243], v28 offset:6400
    v_max3_f32 v174, v174, v73, v74
    v_mfma_f32_16x16x32_bf16 a[36:39], v[252:255], v[148:151], a[36:39]
    v_max3_f32 v172, v172, v67, v76
    v_max3_f32 v173, v173, v71, v80
    v_mfma_f32_16x16x32_bf16 a[40:43], v[252:255], v[152:155], a[40:43]
    ds_read_b64_tr_b16 v[244:245], v29 offset:256
    v_max3_f32 v174, v174, v75, v84
    v_mfma_f32_16x16x32_bf16 a[44:47], v[252:255], v[156:159], a[44:47]
    ds_read_b64_tr_b16 v[246:247], v29 offset:6400
    s_waitcnt lgkmcnt(8)
    v_mfma_f32_16x16x32_bf16 a[48:51], v[224:227], v[148:151], a[48:51]
    v_max3_f32 v172, v172, v77, v78
    v_max3_f32 v173, v173, v81, v82
    v_mfma_f32_16x16x32_bf16 a[52:55], v[224:227], v[152:155], a[52:55]
    ds_read_b64_tr_b16 v[248:249], v30 offset:256
    v_max3_f32 v174, v174, v85, v86
    v_mfma_f32_16x16x32_bf16 a[56:59], v[224:227], v[156:159], a[56:59]
    ds_read_b64_tr_b16 v[250:251], v30 offset:6400
    v_max_f32 v172, v172, v79
    v_mfma_f32_16x16x32_bf16 a[60:63], v[228:231], v[148:151], a[60:63]
    v_max_f32 v173, v173, v83
    v_max_f32 v174, v174, v87
    v_mfma_f32_16x16x32_bf16 a[64:67], v[228:231], v[152:155], a[64:67]
    ds_read_b64_tr_b16 v[252:253], v31 offset:256
    v_max3_f32 v175, v172, v173, v174
    v_mfma_f32_16x16x32_bf16 a[68:71], v[228:231], v[156:159], a[68:71]
    ds_read_b64_tr_b16 v[254:255], v31 offset:6400
    s_waitcnt lgkmcnt(8)
    v_mfma_f32_16x16x32_bf16 a[72:75], v[232:235], v[148:151], a[72:75]
    s_add_u32 s29, s29, 2
    s_cmp_ge_u32 s28, s29
    s_cbranch_scc0 L_sl6
L_bk6:
    v_mfma_f32_16x16x32_bf16 a[76:79], v[232:235], v[152:155], a[76:79]
    v_mfma_f32_16x16x32_bf16 a[80:83], v[232:235], v[156:159], a[80:83]
    ds_read_b128 v[224:227], v18 offset:0
    v_mfma_f32_16x16x32_bf16 a[84:87], v[236:239], v[148:151], a[84:87]
    v_mfma_f32_16x16x32_bf16 a[88:91], v[236:239], v[152:155], a[88:91]
    v_mfma_f32_16x16x32_bf16 a[92:95], v[236:239], v[156:159], a[92:95]
    ds_read_b128 v[228:231], v19 offset:0
    s_waitcnt lgkmcnt(6)
    v_mfma_f32_16x16x32_bf16 a[96:99], v[240:243], v[148:151], a[96:99]
    v_mfma_f32_16x16x32_bf16 a[100:103], v[240:243], v[152:155], a[100:103]
    v_mfma_f32_16x16x32_bf16 a[104:107], v[240:243], v[156:159], a[104:107]
    ds_read_b128 v[232:235], v18 offset:128
    v_mfma_f32_16x16x32_bf16 a[108:111], v[244:247], v[148:151], a[108:111]
    v_mfma_f32_16x16x32_bf16 a[112:115], v[244:247], v[152:155], a[112:115]
    v_mfma_f32_16x16x32_bf16 a[116:119], v[244:247], v[156:159], a[116:119]
    ds_read_b128 v[236:239], v19 offset:128
    s_waitcnt lgkmcnt(4)
    v_mfma_f32_16x16x32_bf16 a[120:123], v[248:251], v[148:151], a[120:123]
    v_mfma_f32_16x16x32_bf16 a[124:127], v[248:251], v[152:155], a[124:127]
    v_mfma_f32_16x16x32_bf16 a[128:131], v[248:251], v[156:159], a[128:131]
    ds_read_b128 v[240:243], v18 offset:256
    v_mfma_f32_16x16x32_bf16 a[132:135], v[252:255], v[148:151], a[132:135]
    v_add_u32 v221, 2, v221
    ds_write_b32 v220, v221
    v_mfma_f32_16x16x32_bf16 a[136:139], v[252:255], v[152:155], a[136:139]
    v_mfma_f32_16x16x32_bf16 a[140:143], v[252:255], v[156:159], a[140:143]
    ds_read_b128 v[244:247], v19 offset:256
    v_cmp_lt_f32 vcc, s63, v175
    s_cbranch_vccz L_norareb
    s_call_b64 s[66:67], L_rare0
L_norareb:
    s_waitcnt lgkmcnt(5)
    v_mfma_f32_16x16x32_bf16 v[88:91], v[224:227], a[156:159], v[160:163]
    v_add_u32 v20, s25, v22
    v_add_u32 v21, s25, v23
    v_mfma_f32_16x16x32_bf16 v[92:95], v[224:227], a[180:183], v[164:167]
    s_add_u32 s25, s25, 12288
    s_sub_u32 s26, s25, 159744
    v_mfma_f32_16x16x32_bf16 v[96:99], v[224:227], a[204:207], v[168:171]
    ds_read_b128 v[248:251], v18 offset:6144
    s_min_u32 s25, s25, s26
    v_mfma_f32_16x16x32_bf16 v[88:91], v[228:231], a[160:163], v[88:91]
    v_exp_f32 v40, v40
    v_mfma_f32_16x16x32_bf16 v[92:95], v[228:231], a[184:187], v[92:95]
    v_exp_f32 v41, v41
    v_mfma_f32_16x16x32_bf16 v[96:99], v[228:231], a[208:211], v[96:99]
    ds_read_b128 v[252:255], v19 offset:6144
    s_waitcnt lgkmcnt(5)
    v_mfma_f32_16x16x32_bf16 v[88:91], v[232:235], a[164:167], v[88:91]
    v_exp_f32 v42, v42
    v_mfma_f32_16x16x32_bf16 v[92:95], v[232:235], a[188:191], v[92:95]
    v_exp_f32 v43, v43
    v_mfma_f32_16x16x32_bf16 v[96:99], v[232:235], a[212:215], v[96:99]
    ds_read_b128 v[224:227], v18 offset:6272
    v_cvt_pk_bf16_f32 v136, v40, v41
    v_mfma_f32_16x16x32_bf16 v[88:91], v[236:239], a[168:171], v[88:91]
    v_cvt_pk_bf16_f32 v137, v42, v43
    v_mfma_f32_16x16x32_bf16 v[92:95], v[236:239], a[192:195], v[92:95]
    v_exp_f32 v52, v52
    v_mfma_f32_16x16x32_bf16 v[96:99], v[236:239], a[216:219], v[96:99]
    ds_read_b128 v[228:231], v19 offset:6272
    s_waitcnt lgkmcnt(4)
    v_mfma_f32_16x16x32_bf16 v[88:91], v[240:243], a[172:175], v[88:91]
    v_exp_f32 v53, v53
    v_mfma_f32_16x16x32_bf16 v[92:95], v[240:243], a[196:199], v[92:95]
    v_exp_f32 v54, v54
    v_mfma_f32_16x16x32_bf16 v[96:99], v[240:243], a[220:223], v[96:99]
    ds_read_b128 v[232:235], v18 offset:6400
    v_mfma_f32_16x16x32_bf16 v[88:91], v[244:247], a[176:179], v[88:91]
    v_exp_f32 v55, v55
    v_mfma_f32_16x16x32_bf16 v[92:95], v[244:247], a[200:203], v[92:95]
    v_cvt_pk_bf16_f32 v138, v52, v53
    v_mfma_f32_16x16x32_bf16 v[96:99], v[244:247], a[224:227], v[96:99]
    ds_read_b128 v[236:239], v19 offset:6400
    s_waitcnt lgkmcnt(4)
    v_mfma_f32_16x16x32_bf16 v[100:103], v[248:251], a[156:159], v[160:163]
    v_cvt_pk_bf16_f32 v139, v54, v55
    v_mfma_f32_16x16x32_bf16 v[104:107], v[248:251], a[180:183], v[164:167]
    v_exp_f32 v44, v44
    v_mfma_f32_16x16x32_bf16 v[108:111], v[248:251], a[204:207], v[168:171]
    ds_read_b128 v[240:243], v20 offset:0
    v_mfma_f32_16x16x32_bf16 v[100:103], v[252:255], a[160:163], v[100:103]
    v_exp_f32 v45, v45
    v_mfma_f32_16x16x32_bf16 v[104:107], v[252:255], a[184:187], v[104:107]
    v_exp_f32 v46, v46
    v_mfma_f32_16x16x32_bf16 v[108:111], v[252:255], a[208:211], v[108:111]
    ds_read_b128 v[244:247], v21 offset:0
    s_waitcnt lgkmcnt(4)
    v_mfma_f32_16x16x32_bf16 v[100:103], v[224:227], a[164:167], v[100:103]
    v_exp_f32 v47, v47
    v_mfma_f32_16x16x32_bf16 v[104:107], v[224:227], a[188:191], v[104:107]
    v_cvt_pk_bf16_f32 v140, v44, v45
    v_mfma_f32_16x16x32_bf16 v[108:111], v[224:227], a[212:215], v[108:111]
    ds_read_b128 v[248:251], v20 offset:128
    v_cvt_pk_bf16_f32 v141, v46, v47
    v_mfma_f32_16x16x32_bf16 v[100:103], v[228:231], a[168:171], v[100:103]
    v_exp_f32 v56, v56
    v_mfma_f32_16x16x32_bf16 v[104:107], v[228:231], a[192:195], v[104:107]
    v_exp_f32 v57, v57
    v_mfma_f32_16x16x32_bf16 v[108:111], v[228:231], a[216:219], v[108:111]
    ds_read_b128 v[252:255], v21 offset:128
    s_waitcnt lgkmcnt(4)
    v_mfma_f32_16x16x32_bf16 v[100:103], v[232:235], a[172:175], v[100:103]
    v_exp_f32 v58, v58
    v_mfma_f32_16x16x32_bf16 v[104:107], v[232:235], a[196:199], v[104:107]
    v_exp_f32 v59, v59
    v_mfma_f32_16x16x32_bf16 v[108:111], v[232:235], a[220:223], v[108:111]
    ds_read_b128 v[224:227], v20 offset:256
    v_cvt_pk_bf16_f32 v142, v56, v57
    v_mfma_f32_16x16x32_bf16 v[100:103], v[236:239], a[176:179], v[100:103]
    v_cvt_pk_bf16_f32 v143, v58, v59
    v_mfma_f32_16x16x32_bf16 v[104:107], v[236:239], a[200:203], v[104:107]
    v_exp_f32 v48, v48
    v_mfma_f32_16x16x32_bf16 v[108:111], v[236:239], a[224:227], v[108:111]
    ds_read_b128 v[228:231], v21 offset:256
    s_waitcnt lgkmcnt(4)
    v_mfma_f32_16x16x32_bf16 v[112:115], v[240:243], a[156:159], v[160:163]
    v_add_u32 v24, s25, v32
    v_add_u32 v25, s25, v33
    v_mfma_f32_16x16x32_bf16 v[116:119], v[240:243], a[180:183], v[164:167]
    v_add_u32 v26, s25, v34
    v_add_u32 v27, s25, v35
    v_mfma_f32_16x16x32_bf16 v[120:123], v[240:243], a[204:207], v[168:171]
    ds_read_b128 v[232:235], v20 offset:6144
    s_add_u32 s25, s25, 12288
    v_mfma_f32_16x16x32_bf16 v[112:115], v[244:247], a[160:163], v[112:115]
    s_sub_u32 s26, s25, 159744
    s_min_u32 s25, s25, s26
    v_mfma_f32_16x16x32_bf16 v[116:119], v[244:247], a[184:187], v[116:119]
    v_exp_f32 v49, v49
    v_mfma_f32_16x16x32_bf16 v[120:123], v[244:247], a[208:211], v[120:123]
    ds_read_b128 v[236:239], v21 offset:6144
    s_waitcnt lgkmcnt(4)
    v_mfma_f32_16x16x32_bf16 v[112:115], v[248:251], a[164:167], v[112:115]
    v_exp_f32 v50, v50
    v_mfma_f32_16x16x32_bf16 v[116:119], v[248:251], a[188:191], v[116:119]
    v_exp_f32 v51, v51
    v_mfma_f32_16x16x32_bf16 v[120:123], v[248:251], a[212:215], v[120:123]
    ds_read_b128 v[240:243], v20 offset:6272
    v_cvt_pk_bf16_f32 v144, v48, v49
    v_mfma_f32_16x16x32_bf16 v[112:115], v[252:255], a[168:171], v[112:115]
    v_cvt_pk_bf16_f32 v145, v50, v51
    v_mfma_f32_16x16x32_bf16 v[116:119], v[252:255], a[192:195], v[116:119]
    v_exp_f32 v60, v60
    v_mfma_f32_16x16x32_bf16 v[120:123], v[252:255], a[216:219], v[120:123]
    ds_read_b128 v[244:247], v21 offset:6272
    s_waitcnt lgkmcnt(4)
    v_mfma_f32_16x16x32_bf16 v[112:115], v[224:227], a[172:175], v[112:115]
    v_exp_f32 v61, v61
    v_mfma_f32_16x16x32_bf16 v[116:119], v[224:227], a[196:199], v[116:119]
    v_exp_f32 v62, v62
    v_mfma_f32_16x16x32_bf16 v[120:123], v[224:227], a[220:223], v[120:123]
    ds_read_b128 v[248:251], v20 offset:6400
    v_mfma_f32_16x16x32_bf16 v[112:115], v[228:231], a[176:179], v[112:115]
    v_exp_f32 v63, v63
    v_mfma_f32_16x16x32_bf16 v[116:119], v[228:231], a[200:203], v[116:119]
    v_cvt_pk_bf16_f32 v146, v60, v61
    v_mfma_f32_16x16x32_bf16 v[120:123], v[228:231], a[224:227], v[120:123]
    ds_read_b128 v[252:255], v21 offset:6400
    s_waitcnt lgkmcnt(4)
    v_mfma_f32_16x16x32_bf16 v[124:127], v[232:235], a[156:159], v[160:163]
    s_add_u32 s29, s29, 2
    s_cmp_ge_u32 s28, s29
    s_cbranch_scc0 L_sl7
L_bk7:
    v_mfma_f32_16x16x32_bf16 v[128:131], v[232:235], a[180:183], v[164:167]
    ds_read_b64_tr_b16 v[224:225], v24 offset:0
    v_cvt_pk_bf16_f32 v147, v62, v63
    v_mfma_f32_16x16x32_bf16 v[132:135], v[232:235], a[204:207], v[168:171]
    ds_read_b64_tr_b16 v[226:227], v24 offset:6144
    v_mfma_f32_16x16x32_bf16 v[124:127], v[236:239], a[160:163], v[124:127]
    v_exp_f32 v64, v64
    v_mfma_f32_16x16x32_bf16 v[128:131], v[236:239], a[184:187], v[128:131]
    ds_read_b64_tr_b16 v[228:229], v25 offset:0
    v_mfma_f32_16x16x32_bf16 v[132:135], v[236:239], a[208:211], v[132:135]
    ds_read_b64_tr_b16 v[230:231], v25 offset:6144
    s_waitcnt lgkmcnt(6)
    v_mfma_f32_16x16x32_bf16 v[124:127], v[240:243], a[164:167], v[124:127]
    v_exp_f32 v65, v65
    v_mfma_f32_16x16x32_bf16 v[128:131], v[240:243], a[188:191], v[128:131]
    ds_read_b64_tr_b16 v[232:233], v26 offset:0
    v_mfma_f32_16x16x32_bf16 v[132:135], v[240:243], a[212:215], v[132:135]
    ds_read_b64_tr_b16 v[234:235], v26 offset:6144
    v_mfma_f32_16x16x32_bf16 v[124:127], v[244:247], a[168:171], v[124:127]
    v_exp_f32 v66, v66
    v_mfma_f32_16x16x32_bf16 v[128:131], v[244:247], a[192:195], v[128:131]
    ds_read_b64_tr_b16 v[236:237], v27 offset:0
    v_mfma_f32_16x16x32_bf16 v[132:135], v[244:247], a[216:219], v[132:135]
    ds_read_b64_tr_b16 v[238:239], v27 offset:6144
    s_waitcnt lgkmcnt(8)
    v_mfma_f32_16x16x32_bf16 v[124:127], v[248:251], a[172:175], v[124:127]
    v_exp_f32 v67, v67
    v_mfma_f32_16x16x32_bf16 v[128:131], v[248:251], a[196:199], v[128:131]
    ds_read_b64_tr_b16 v[240:241], v24 offset:128
    v_cvt_pk_bf16_f32 v148, v64, v65
    v_mfma_f32_16x16x32_bf16 v[132:135], v[248:251], a[220:223], v[132:135]
    ds_read_b64_tr_b16 v[242:243], v24 offset:6272
    v_cvt_pk_bf16_f32 v149, v66, v67
    v_mfma_f32_16x16x32_bf16 v[124:127], v[252:255], a[176:179], v[124:127]
    v_add_u32 v221, 2, v221
    ds_write_b32 v220, v221
    v_mfma_f32_16x16x32_bf16 v[128:131], v[252:255], a[200:203], v[128:131]
    ds_read_b64_tr_b16 v[244:245], v25 offset:128
    v_mfma_f32_16x16x32_bf16 v[132:135], v[252:255], a[224:227], v[132:135]
    ds_read_b64_tr_b16 v[246:247], v25 offset:6272
    v_mfma_f32_16x16x32_bf16 a[144:147], a[228:231], v[136:139], a[144:147]
    v_add_u32 v28, s25, v32
    v_add_u32 v29, s25, v33
    v_mfma_f32_16x16x32_bf16 a[148:151], a[228:231], v[140:143], a[148:151]
    v_add_u32 v30, s25, v34
    v_add_u32 v31, s25, v35
    v_mfma_f32_16x16x32_bf16 a[152:155], a[228:231], v[144:147], a[152:155]
    s_add_u32 s25, s25, 12288
    s_waitcnt lgkmcnt(9)
    v_mfma_f32_16x16x32_bf16 a[0:3], v[224:227], v[136:139], a[0:3]
    s_sub_u32 s26, s25, 159744
    s_min_u32 s25, s25, s26
    v_mfma_f32_16x16x32_bf16 a[4:7], v[224:227], v[140:143], a[4:7]
    ds_read_b64_tr_b16 v[248:249], v26 offset:128
    v_mfma_f32_16x16x32_bf16 a[8:11], v[224:227], v[144:147], a[8:11]
    ds_read_b64_tr_b16 v[250:251], v26 offset:6272
    v_mfma_f32_16x16x32_bf16 a[12:15], v[228:231], v[136:139], a[12:15]
    v_exp_f32 v76, v76
    v_mfma_f32_16x16x32_bf16 a[16:19], v[228:231], v[140:143], a[16:19]
    ds_read_b64_tr_b16 v[252:253], v27 offset:128
    v_exp_f32 v77, v77
    v_mfma_f32_16x16x32_bf16 a[20:23], v[228:231], v[144:147], a[20:23]
    ds_read_b64_tr_b16 v[254:255], v27 offset:6272
    s_waitcnt lgkmcnt(9)
    v_mfma_f32_16x16x32_bf16 a[24:27], v[232:235], v[136:139], a[24:27]
    v_exp_f32 v78, v78
    v_mfma_f32_16x16x32_bf16 a[28:31], v[232:235], v[140:143], a[28:31]
    ds_read_b64_tr_b16 v[224:225], v24 offset:256
    v_exp_f32 v79, v79
    v_mfma_f32_16x16x32_bf16 a[32:35], v[232:235], v[144:147], a[32:35]
    ds_read_b64_tr_b16 v[226:227], v24 offset:6400
    v_cvt_pk_bf16_f32 v150, v76, v77
    v_mfma_f32_16x16x32_bf16 a[36:39], v[236:239], v[136:139], a[36:39]
    v_cvt_pk_bf16_f32 v151, v78, v79
    v_exp_f32 v68, v68
    v_mfma_f32_16x16x32_bf16 a[40:43], v[236:239], v[140:143], a[40:43]
    ds_read_b64_tr_b16 v[228:229], v25 offset:256
    v_exp_f32 v69, v69
    v_mfma_f32_16x16x32_bf16 a[44:47], v[236:239], v[144:147], a[44:47]
    ds_read_b64_tr_b16 v[230:231], v25 offset:6400
    s_waitcnt lgkmcnt(8)
    v_mfma_f32_16x16x32_bf16 a[48:51], v[240:243], v[136:139], a[48:51]
    v_exp_f32 v70, v70
    v_mfma_f32_16x16x32_bf16 a[52:55], v[240:243], v[140:143], a[52:55]
    ds_read_b64_tr_b16 v[232:233], v26 offset:256
    v_exp_f32 v71, v71
    v_mfma_f32_16x16x32_bf16 a[56:59], v[240:243], v[144:147], a[56:59]
    ds_read_b64_tr_b16 v[234:235], v26 offset:6400
    v_cvt_pk_bf16_f32 v152, v68, v69
    v_mfma_f32_16x16x32_bf16 a[60:63], v[244:247], v[136:139], a[60:63]
    v_cvt_pk_bf16_f32 v153, v70, v71
    v_exp_f32 v80, v80
    v_mfma_f32_16x16x32_bf16 a[64:67], v[244:247], v[140:143], a[64:67]
    ds_read_b64_tr_b16 v[236:237], v27 offset:256
    v_exp_f32 v81, v81
    v_mfma_f32_16x16x32_bf16 a[68:71], v[244:247], v[144:147], a[68:71]
    ds_read_b64_tr_b16 v[238:239], v27 offset:6400
    s_waitcnt lgkmcnt(8)
    v_mfma_f32_16x16x32_bf16 a[72:75], v[248:251], v[136:139], a[72:75]
    v_exp_f32 v82, v82
    v_mfma_f32_16x16x32_bf16 a[76:79], v[248:251], v[140:143], a[76:79]
    ds_read_b64_tr_b16 v[240:241], v28 offset:0
    v_exp_f32 v83, v83
    v_mfma_f32_16x16x32_bf16 a[80:83], v[248:251], v[144:147], a[80:83]
    ds_read_b64_tr_b16 v[242:243], v28 offset:6144
    v_cvt_pk_bf16_f32 v154, v80, v81
    v_mfma_f32_16x16x32_bf16 a[84:87], v[252:255], v[136:139], a[84:87]
    v_cvt_pk_bf16_f32 v155, v82, v83
    v_exp_f32 v72, v72
    v_mfma_f32_16x16x32_bf16 a[88:91], v[252:255], v[140:143], a[88:91]
    ds_read_b64_tr_b16 v[244:245], v29 offset:0
    v_exp_f32 v73, v73
    v_mfma_f32_16x16x32_bf16 a[92:95], v[252:255], v[144:147], a[92:95]
    ds_read_b64_tr_b16 v[246:247], v29 offset:6144
    s_waitcnt lgkmcnt(8)
    v_mfma_f32_16x16x32_bf16 a[96:99], v[224:227], v[136:139], a[96:99]
    v_exp_f32 v74, v74
    v_mfma_f32_16x16x32_bf16 a[100:103], v[224:227], v[140:143], a[100:103]
    ds_read_b64_tr_b16 v[248:249], v30 offset:0
    v_exp_f32 v75, v75
    v_mfma_f32_16x16x32_bf16 a[104:107], v[224:227], v[144:147], a[104:107]
    ds_read_b64_tr_b16 v[250:251], v30 offset:6144
    v_cvt_pk_bf16_f32 v156, v72, v73
    v_mfma_f32_16x16x32_bf16 a[108:111], v[228:231], v[136:139], a[108:111]
    v_cvt_pk_bf16_f32 v157, v74, v75
    v_exp_f32 v84, v84
    v_mfma_f32_16x16x32_bf16 a[112:115], v[228:231], v[140:143], a[112:115]
    ds_read_b64_tr_b16 v[252:253], v31 offset:0
    v_max3_f32 v172, v88, v89, v90
    v_mfma_f32_16x16x32_bf16 a[116:119], v[228:231], v[144:147], a[116:119]
    ds_read_b64_tr_b16 v[254:255], v31 offset:6144
    v_exp_f32 v85, v85
    s_waitcnt lgkmcnt(8)
    v_mfma_f32_16x16x32_bf16 a[120:123], v[232:235], v[136:139], a[120:123]
    v_exp_f32 v86, v86
    v_mfma_f32_16x16x32_bf16 a[124:127], v[232:235], v[140:143], a[124:127]
    ds_read_b64_tr_b16 v[224:225], v28 offset:128
    v_exp_f32 v87, v87
    v_mfma_f32_16x16x32_bf16 a[128:131], v[232:235], v[144:147], a[128:131]
    ds_read_b64_tr_b16 v[226:227], v28 offset:6272
    v_cvt_pk_bf16_f32 v158, v84, v85
    v_mfma_f32_16x16x32_bf16 a[132:135], v[236:239], v[136:139], a[132:135]
    v_cvt_pk_bf16_f32 v159, v86, v87
    v_max3_f32 v173, v92, v93, v94
    v_mfma_f32_16x16x32_bf16 a[136:139], v[236:239], v[140:143], a[136:139]
    ds_read_b64_tr_b16 v[228:229], v29 offset:128
    v_max3_f32 v174, v96, v97, v98
    v_mfma_f32_16x16x32_bf16 a[140:143], v[236:239], v[144:147], a[140:143]
    ds_read_b64_tr_b16 v[230:231], v29 offset:6272
    v_max3_f32 v172, v172, v91, v100
    v_mfma_f32_16x16x32_bf16 a[144:147], a[228:231], v[148:151], a[144:147]
    v_add_u32 v18, s25, v22
    v_add_u32 v19, s25, v23
    v_mfma_f32_16x16x32_bf16 a[148:151], a[228:231], v[152:155], a[148:151]
    s_add_u32 s25, s25, 12288
    s_sub_u32 s26, s25, 159744
    v_mfma_f32_16x16x32_bf16 a[152:155], a[228:231], v[156:159], a[152:155]
    s_min_u32 s25, s25, s26
    s_waitcnt lgkmcnt(8)
    v_mfma_f32_16x16x32_bf16 a[0:3], v[240:243], v[148:151], a[0:3]
    v_max3_f32 v173, v173, v95, v104
    v_max3_f32 v174, v174, v99, v108
    v_mfma_f32_16x16x32_bf16 a[4:7], v[240:243], v[152:155], a[4:7]
    ds_read_b64_tr_b16 v[232:233], v30 offset:128
    v_max3_f32 v172, v172, v101, v102
    v_mfma_f32_16x16x32_bf16 a[8:11], v[240:243], v[156:159], a[8:11]
    ds_read_b64_tr_b16 v[234:235], v30 offset:6272
    v_max3_f32 v173, v173, v105, v106
    v_mfma_f32_16x16x32_bf16 a[12:15], v[244:247], v[148:151], a[12:15]
    v_max3_f32 v174, v174, v109, v110
    v_max3_f32 v172, v172, v103, v112
    v_mfma_f32_16x16x32_bf16 a[16:19], v[244:247], v[152:155], a[16:19]
    ds_read_b64_tr_b16 v[236:237], v31 offset:128
    v_max3_f32 v173, v173, v107, v116
    v_mfma_f32_16x16x32_bf16 a[20:23], v[244:247], v[156:159], a[20:23]
    ds_read_b64_tr_b16 v[238:239], v31 offset:6272
    s_waitcnt lgkmcnt(8)
    v_mfma_f32_16x16x32_bf16 a[24:27], v[248:251], v[148:151], a[24:27]
    v_max3_f32 v174, v174, v111, v120
    v_max3_f32 v172, v172, v113, v114
    v_mfma_f32_16x16x32_bf16 a[28:31], v[248:251], v[152:155], a[28:31]
    ds_read_b64_tr_b16 v[240:241], v28 offset:256
    v_max3_f32 v173, v173, v117, v118
    v_mfma_f32_16x16x32_bf16 a[32:35], v[248:251], v[156:159], a[32:35]
    ds_read_b64_tr_b16 v[242:243], v28 offset:6400
    v_max3_f32 v174, v174, v121, v122
    v_mfma_f32_16x16x32_bf16 a[36:39], v[252:255], v[148:151], a[36:39]
    v_max3_f32 v172, v172, v115, v124
    v_max3_f32 v173, v173, v119, v128
    v_mfma_f32_16x16x32_bf16 a[40:43], v[252:255], v[152:155], a[40:43]
    ds_read_b64_tr_b16 v[244:245], v29 offset:256
    v_max3_f32 v174, v174, v123, v132
    v_mfma_f32_16x16x32_bf16 a[44:47], v[252:255], v[156:159], a[44:47]
    ds_read_b64_tr_b16 v[246:247], v29 offset:6400
    s_waitcnt lgkmcnt(8)
    v_mfma_f32_16x16x32_bf16 a[48:51], v[224:227], v[148:151], a[48:51]
    v_max3_f32 v172, v172, v125, v126
    v_max3_f32 v173, v173, v129, v130
    v_mfma_f32_16x16x32_bf16 a[52:55], v[224:227], v[152:155], a[52:55]
    ds_read_b64_tr_b16 v[248:249], v30 offset:256
    v_max3_f32 v174, v174, v133, v134
    v_mfma_f32_16x16x32_bf16 a[56:59], v[224:227], v[156:159], a[56:59]
    ds_read_b64_tr_b16 v[250:251], v30 offset:6400
    v_max_f32 v172, v172, v127
    v_mfma_f32_16x16x32_bf16 a[60:63], v[228:231], v[148:151], a[60:63]
    v_max_f32 v173, v173, v131
    v_max_f32 v174, v174, v135
    v_mfma_f32_16x16x32_bf16 a[64:67], v[228:231], v[152:155], a[64:67]
    ds_read_b64_tr_b16 v[252:253], v31 offset:256
    v_max3_f32 v175, v172, v173, v174
    v_mfma_f32_16x16x32_bf16 a[68:71], v[228:231], v[156:159], a[68:71]
    ds_read_b64_tr_b16 v[254:255], v31 offset:6400
    s_waitcnt lgkmcnt(8)
    v_mfma_f32_16x16x32_bf16 a[72:75], v[232:235], v[148:151], a[72:75]
    s_add_u32 s29, s29, 2
    s_cmp_ge_u32 s28, s29
    s_cbranch_scc0 L_sl8
L_bk8:
    v_mfma_f32_16x16x32_bf16 a[76:79], v[232:235], v[152:155], a[76:79]
    v_mfma_f32_16x16x32_bf16 a[80:83], v[232:235], v[156:159], a[80:83]
    ds_read_b128 v[224:227], v18 offset:0
    v_mfma_f32_16x16x32_bf16 a[84:87], v[236:239], v[148:151], a[84:87]
    v_mfma_f32_16x16x32_bf16 a[88:91], v[236:239], v[152:155], a[88:91]
    v_mfma_f32_16x16x32_bf16 a[92:95], v[236:239], v[156:159], a[92:95]
    ds_read_b128 v[228:231], v19 offset:0
    s_waitcnt lgkmcnt(6)
    v_mfma_f32_16x16x32_bf16 a[96:99], v[240:243], v[148:151], a[96:99]
    v_mfma_f32_16x16x32_bf16 a[100:103], v[240:243], v[152:155], a[100:103]
    v_mfma_f32_16x16x32_bf16 a[104:107], v[240:243], v[156:159], a[104:107]
    ds_read_b128 v[232:235], v18 offset:128
    v_mfma_f32_16x16x32_bf16 a[108:111], v[244:247], v[148:151], a[108:111]
    v_mfma_f32_16x16x32_bf16 a[112:115], v[244:247], v[152:155], a[112:115]
    v_mfma_f32_16x16x32_bf16 a[116:119], v[244:247], v[156:159], a[116:119]
    ds_read_b128 v[236:239], v19 offset:128
    s_waitcnt lgkmcnt(4)
    v_mfma_f32_16x16x32_bf16 a[120:123], v[248:251], v[148:151], a[120:123]
    v_mfma_f32_16x16x32_bf16 a[124:127], v[248:251], v[152:155], a[124:127]
    v_mfma_f32_16x16x32_bf16 a[128:131], v[248:251], v[156:159], a[128:131]
    ds_read_b128 v[240:243], v18 offset:256
    v_mfma_f32_16x16x32_bf16 a[132:135], v[252:255], v[148:151], a[132:135]
    v_add_u32 v221, 2, v221
    ds_write_b32 v220, v221
    v_mfma_f32_16x16x32_bf16 a[136:139], v[252:255], v[152:155], a[136:139]
    v_mfma_f32_16x16x32_bf16 a[140:143], v[252:255], v[156:159], a[140:143]
    ds_read_b128 v[244:247], v19 offset:256
    v_cmp_lt_f32 vcc, s63, v175
    s_cbranch_vccz L_norarec
    s_call_b64 s[66:67], L_rare1
L_norarec:
    s_add_u32 s61, s61, 1
    s_cmp_lt_u32 s61, 3
    s_cbranch_scc1 L_B
    s_mov_b32 s25, 122880
    v_add_u32 v24, s25, v32
    v_add_u32 v25, s25, v33
    v_add_u32 v26, s25, v34
    v_add_u32 v27, s25, v35
    s_add_u32 s25, s25, 12288
    s_sub_u32 s26, s25, 159744
    s_min_u32 s25, s25, s26
    s_cmp_ge_u32 s28, 52
    s_cbranch_scc0 L_sl9
L_bk9:
    s_waitcnt lgkmcnt(6)
    ds_read_b64_tr_b16 v[224:225], v24 offset:0
    ds_read_b64_tr_b16 v[226:227], v24 offset:6144
    s_waitcnt lgkmcnt(7)
    ds_read_b64_tr_b16 v[228:229], v25 offset:0
    ds_read_b64_tr_b16 v[230:231], v25 offset:6144
    s_waitcnt lgkmcnt(8)
    ds_read_b64_tr_b16 v[232:233], v26 offset:0
    ds_read_b64_tr_b16 v[234:235], v26 offset:6144
    s_waitcnt lgkmcnt(9)
    ds_read_b64_tr_b16 v[236:237], v27 offset:0
    ds_read_b64_tr_b16 v[238:239], v27 offset:6144
    s_waitcnt lgkmcnt(10)
    ds_read_b64_tr_b16 v[240:241], v24 offset:128
    ds_read_b64_tr_b16 v[242:243], v24 offset:6272
    s_waitcnt lgkmcnt(10)
    ds_read_b64_tr_b16 v[244:245], v25 offset:128
    ds_read_b64_tr_b16 v[246:247], v25 offset:6272
    v_exp_f32 v88, v88
    v_exp_f32 v89, v89
    v_exp_f32 v90, v90
    v_exp_f32 v91, v91
    v_cvt_pk_bf16_f32 v136, v88, v89
    v_cvt_pk_bf16_f32 v137, v90, v91
    v_exp_f32 v100, v100
    v_exp_f32 v101, v101
    v_exp_f32 v102, v102
    v_exp_f32 v103, v103
    v_cvt_pk_bf16_f32 v138, v100, v101
    v_cvt_pk_bf16_f32 v139, v102, v103
    v_exp_f32 v92, v92
    v_exp_f32 v93, v93
    v_exp_f32 v94, v94
    v_exp_f32 v95, v95
    v_cvt_pk_bf16_f32 v140, v92, v93
    v_cvt_pk_bf16_f32 v141, v94, v95
    v_exp_f32 v104, v104
    v_exp_f32 v105, v105
    v_exp_f32 v106, v106
    v_exp_f32 v107, v107
    v_cvt_pk_bf16_f32 v142, v104, v105
    v_cvt_pk_bf16_f32 v143, v106, v107
    v_exp_f32 v96, v96
    v_exp_f32 v97, v97
    v_exp_f32 v98, v98
    v_exp_f32 v99, v99
    v_cvt_pk_bf16_f32 v144, v96, v97
    v_cvt_pk_bf16_f32 v145, v98, v99
    v_exp_f32 v108, v108
    v_exp_f32 v109, v109
    v_exp_f32 v110, v110
    v_exp_f32 v111, v111
    v_cvt_pk_bf16_f32 v146, v108, v109
    v_cvt_pk_bf16_f32 v147, v110, v111
    v_mfma_f32_16x16x32_bf16 a[144:147], a[228:231], v[136:139], a[144:147]
    v_add_u32 v28, s25, v32
    v_add_u32 v29, s25, v33
    v_mfma_f32_16x16x32_bf16 a[148:151], a[228:231], v[140:143], a[148:151]
    v_add_u32 v30, s25, v34
    v_add_u32 v31, s25, v35
    v_exp_f32 v112, v112
    v_mfma_f32_16x16x32_bf16 a[152:155], a[228:231], v[144:147], a[152:155]
    s_add_u32 s25, s25, 12288
    v_exp_f32 v113, v113
    s_waitcnt lgkmcnt(8)
    v_mfma_f32_16x16x32_bf16 a[0:3], v[224:227], v[136:139], a[0:3]
    s_sub_u32 s26, s25, 159744
    s_min_u32 s25, s25, s26
    v_exp_f32 v114, v114
    v_mfma_f32_16x16x32_bf16 a[4:7], v[224:227], v[140:143], a[4:7]
    ds_read_b64_tr_b16 v[248:249], v26 offset:128
    v_exp_f32 v115, v115
    v_mfma_f32_16x16x32_bf16 a[8:11], v[224:227], v[144:147], a[8:11]
    ds_read_b64_tr_b16 v[250:251], v26 offset:6272
    v_cvt_pk_bf16_f32 v148, v112, v113
    v_cvt_pk_bf16_f32 v149, v114, v115
    v_mfma_f32_16x16x32_bf16 a[12:15], v[228:231], v[136:139], a[12:15]
    v_exp_f32 v124, v124
    v_mfma_f32_16x16x32_bf16 a[16:19], v[228:231], v[140:143], a[16:19]
    ds_read_b64_tr_b16 v[252:253], v27 offset:128
    v_exp_f32 v125, v125
    v_mfma_f32_16x16x32_bf16 a[20:23], v[228:231], v[144:147], a[20:23]
    ds_read_b64_tr_b16 v[254:255], v27 offset:6272
    s_waitcnt lgkmcnt(8)
    v_mfma_f32_16x16x32_bf16 a[24:27], v[232:235], v[136:139], a[24:27]
    v_exp_f32 v126, v126
    v_mfma_f32_16x16x32_bf16 a[28:31], v[232:235], v[140:143], a[28:31]
    ds_read_b64_tr_b16 v[224:225], v24 offset:256
    v_exp_f32 v127, v127
    v_mfma_f32_16x16x32_bf16 a[32:35], v[232:235], v[144:147], a[32:35]
    ds_read_b64_tr_b16 v[226:227], v24 offset:6400
    v_cvt_pk_bf16_f32 v150, v124, v125
    v_mfma_f32_16x16x32_bf16 a[36:39], v[236:239], v[136:139], a[36:39]
    v_cvt_pk_bf16_f32 v151, v126, v127
    v_exp_f32 v116, v116
    v_mfma_f32_16x16x32_bf16 a[40:43], v[236:239], v[140:143], a[40:43]
    ds_read_b64_tr_b16 v[228:229], v25 offset:256
    v_exp_f32 v117, v117
    v_mfma_f32_16x16x32_bf16 a[44:47], v[236:239], v[144:147], a[44:47]
    ds_read_b64_tr_b16 v[230:231], v25 offset:6400
    s_waitcnt lgkmcnt(8)
    v_mfma_f32_16x16x32_bf16 a[48:51], v[240:243], v[136:139], a[48:51]
    v_exp_f32 v118, v118
    v_mfma_f32_16x16x32_bf16 a[52:55], v[240:243], v[140:143], a[52:55]
    ds_read_b64_tr_b16 v[232:233], v26 offset:256
    v_exp_f32 v119, v119
    v_mfma_f32_16x16x32_bf16 a[56:59], v[240:243], v[144:147], a[56:59]
    ds_read_b64_tr_b16 v[234:235], v26 offset:6400
    v_cvt_pk_bf16_f32 v152, v116, v117
    v_mfma_f32_16x16x32_bf16 a[60:63], v[244:247], v[136:139], a[60:63]
    v_cvt_pk_bf16_f32 v153, v118, v119
    v_exp_f32 v128, v128
    v_mfma_f32_16x16x32_bf16 a[64:67], v[244:247], v[140:143], a[64:67]
    ds_read_b64_tr_b16 v[236:237], v27 offset:256
    v_exp_f32 v129, v129
    v_mfma_f32_16x16x32_bf16 a[68:71], v[244:247], v[144:147], a[68:71]
    ds_read_b64_tr_b16 v[238:239], v27 offset:6400
    s_waitcnt lgkmcnt(8)
    v_mfma_f32_16x16x32_bf16 a[72:75], v[248:251], v[136:139], a[72:75]
    v_exp_f32 v130, v130
    v_mfma_f32_16x16x32_bf16 a[76:79], v[248:251], v[140:143], a[76:79]
    ds_read_b64_tr_b16 v[240:241], v28 offset:0
    v_exp_f32 v131, v131
    v_mfma_f32_16x16x32_bf16 a[80:83], v[248:251], v[144:147], a[80:83]
    ds_read_b64_tr_b16 v[242:243], v28 offset:6144
    v_cvt_pk_bf16_f32 v154, v128, v129
    v_mfma_f32_16x16x32_bf16 a[84:87], v[252:255], v[136:139], a[84:87]
    v_cvt_pk_bf16_f32 v155, v130, v131
    v_exp_f32 v120, v120
    v_mfma_f32_16x16x32_bf16 a[88:91], v[252:255], v[140:143], a[88:91]
    ds_read_b64_tr_b16 v[244:245], v29 offset:0
    v_exp_f32 v121, v121
    v_mfma_f32_16x16x32_bf16 a[92:95], v[252:255], v[144:147], a[92:95]
    ds_read_b64_tr_b16 v[246:247], v29 offset:6144
    s_waitcnt lgkmcnt(8)
    v_mfma_f32_16x16x32_bf16 a[96:99], v[224:227], v[136:139], a[96:99]
    v_exp_f32 v122, v122
    v_mfma_f32_16x16x32_bf16 a[100:103], v[224:227], v[140:143], a[100:103]
    ds_read_b64_tr_b16 v[248:249], v30 offset:0
    v_exp_f32 v123, v123
    v_mfma_f32_16x16x32_bf16 a[104:107], v[224:227], v[144:147], a[104:107]
    ds_read_b64_tr_b16 v[250:251], v30 offset:6144
    v_cvt_pk_bf16_f32 v156, v120, v121
    v_mfma_f32_16x16x32_bf16 a[108:111], v[228:231], v[136:139], a[108:111]
    v_cvt_pk_bf16_f32 v157, v122, v123
    v_exp_f32 v132, v132
    v_mfma_f32_16x16x32_bf16 a[112:115], v[228:231], v[140:143], a[112:115]
    ds_read_b64_tr_b16 v[252:253], v31 offset:0
    s_lshl_b32 s27, s22, 5
    v_mfma_f32_16x16x32_bf16 a[116:119], v[228:231], v[144:147], a[116:119]
    ds_read_b64_tr_b16 v[254:255], v31 offset:6144
    v_exp_f32 v133, v133
    s_waitcnt lgkmcnt(8)
    v_mfma_f32_16x16x32_bf16 a[120:123], v[232:235], v[136:139], a[120:123]
    v_exp_f32 v134, v134
    v_mfma_f32_16x16x32_bf16 a[124:127], v[232:235], v[140:143], a[124:127]
    ds_read_b64_tr_b16 v[224:225], v28 offset:128
    v_exp_f32 v135, v135
    v_mfma_f32_16x16x32_bf16 a[128:131], v[232:235], v[144:147], a[128:131]
    ds_read_b64_tr_b16 v[226:227], v28 offset:6272
    v_cvt_pk_bf16_f32 v158, v132, v133
    v_mfma_f32_16x16x32_bf16 a[132:135], v[236:239], v[136:139], a[132:135]
    v_cvt_pk_bf16_f32 v159, v134, v135
    s_add_u32 s60, s27, s24
    v_mfma_f32_16x16x32_bf16 a[136:139], v[236:239], v[140:143], a[136:139]
    ds_read_b64_tr_b16 v[228:229], v29 offset:128
    s_mul_i32 s52, s20, 18432
    v_mfma_f32_16x16x32_bf16 a[140:143], v[236:239], v[144:147], a[140:143]
    ds_read_b64_tr_b16 v[230:231], v29 offset:6272
    s_mul_i32 s30, s60, 55424
    v_mfma_f32_16x16x32_bf16 a[144:147], a[228:231], v[148:151], a[144:147]
    v_add_u32 v14, 147456, v10
    v_add_u32 v15, 147456, v11
    v_mfma_f32_16x16x32_bf16 a[148:151], a[228:231], v[152:155], a[148:151]
    v_add_u32 v16, 147456, v12
    v_add_u32 v17, 147456, v13
    v_mfma_f32_16x16x32_bf16 a[152:155], a[228:231], v[156:159], a[152:155]
    s_add_u32 s30, s30, s52
    s_waitcnt lgkmcnt(8)
    v_mfma_f32_16x16x32_bf16 a[0:3], v[240:243], v[148:151], a[0:3]
    s_mul_i32 s54, s20, 6144
    s_mul_i32 s55, s60, 55424
    v_mfma_f32_16x16x32_bf16 a[4:7], v[240:243], v[152:155], a[4:7]
    ds_read_b64_tr_b16 v[232:233], v30 offset:128
    s_add_u32 s54, s54, s55
    s_add_u32 s54, s54, 16777216
    v_mfma_f32_16x16x32_bf16 a[8:11], v[240:243], v[156:159], a[8:11]
    ds_read_b64_tr_b16 v[234:235], v30 offset:6272
    s_mul_i32 s61, s60, 3
    v_mfma_f32_16x16x32_bf16 a[12:15], v[244:247], v[148:151], a[12:15]
    s_add_u32 s61, s61, s20
    s_lshl_b32 s61, s61, 7
    s_xor_b32 s32, s60, 2
    v_mfma_f32_16x16x32_bf16 a[16:19], v[244:247], v[152:155], a[16:19]
    ds_read_b64_tr_b16 v[236:237], v31 offset:128
    s_mul_i32 s32, s32, 55424
    v_mfma_f32_16x16x32_bf16 a[20:23], v[244:247], v[156:159], a[20:23]
    ds_read_b64_tr_b16 v[238:239], v31 offset:6272
    s_add_u32 s32, s32, s52
    s_waitcnt lgkmcnt(8)
    v_mfma_f32_16x16x32_bf16 a[24:27], v[248:251], v[148:151], a[24:27]
    s_xor_b32 s33, s60, 1
    s_mul_i32 s33, s33, 55424
    v_mfma_f32_16x16x32_bf16 a[28:31], v[248:251], v[152:155], a[28:31]
    ds_read_b64_tr_b16 v[240:241], v28 offset:256
    s_add_u32 s33, s33, s52
    s_xor_b32 s34, s60, 3
    v_mfma_f32_16x16x32_bf16 a[32:35], v[248:251], v[156:159], a[32:35]
    ds_read_b64_tr_b16 v[242:243], v28 offset:6400
    s_mul_i32 s34, s34, 55424
    v_mfma_f32_16x16x32_bf16 a[36:39], v[252:255], v[148:151], a[36:39]
    s_add_u32 s34, s34, s52
    s_add_u32 s60, s61, 46137344
    s_mul_i32 s55, s23, 384
    v_mfma_f32_16x16x32_bf16 a[40:43], v[252:255], v[152:155], a[40:43]
    ds_read_b64_tr_b16 v[244:245], v29 offset:256
    s_sub_u32 s61, s60, s55
    v_mfma_f32_16x16x32_bf16 a[44:47], v[252:255], v[156:159], a[44:47]
    ds_read_b64_tr_b16 v[246:247], v29 offset:6400
    s_lshl_b32 s55, s22, 2
    s_waitcnt lgkmcnt(8)
    v_mfma_f32_16x16x32_bf16 a[48:51], v[224:227], v[148:151], a[48:51]
    s_add_u32 s55, s55, s23
    s_mul_i32 s55, s55, 3
    v_mfma_f32_16x16x32_bf16 a[52:55], v[224:227], v[152:155], a[52:55]
    ds_read_b64_tr_b16 v[248:249], v30 offset:256
    s_add_u32 s55, s55, s20
    s_lshl_b32 s55, s55, 3
    v_mfma_f32_16x16x32_bf16 a[56:59], v[224:227], v[156:159], a[56:59]
    ds_read_b64_tr_b16 v[250:251], v30 offset:6400
    s_add_u32 s55, s55, s21
    v_mfma_f32_16x16x32_bf16 a[60:63], v[228:231], v[148:151], a[60:63]
    s_lshl_b32 s55, s55, 7
    s_add_u32 s55, s55, 46235648
    s_lshl_b32 s53, s36, 11
    v_mfma_f32_16x16x32_bf16 a[64:67], v[228:231], v[152:155], a[64:67]
    ds_read_b64_tr_b16 v[252:253], v31 offset:256
    s_add_u32 s45, s54, s53
    s_mul_i32 s36, s36, 6144
    v_mfma_f32_16x16x32_bf16 a[68:71], v[228:231], v[156:159], a[68:71]
    ds_read_b64_tr_b16 v[254:255], v31 offset:6400
    s_waitcnt lgkmcnt(8)
    v_mfma_f32_16x16x32_bf16 a[72:75], v[232:235], v[148:151], a[72:75]
    s_cmp_ge_u32 s28, 54
    s_cbranch_scc0 L_sl10
L_bk10:
    v_mfma_f32_16x16x32_bf16 a[76:79], v[232:235], v[152:155], a[76:79]
    ds_read_b64_tr_b16 v[224:225], v14 offset:0
    s_add_u32 s39, s30, s36
    s_add_u32 s42, s32, s36
    v_mfma_f32_16x16x32_bf16 a[80:83], v[232:235], v[156:159], a[80:83]
    ds_read_b64_tr_b16 v[226:227], v14 offset:2048
    s_lshl_b32 s53, s37, 11
    v_mfma_f32_16x16x32_bf16 a[84:87], v[236:239], v[148:151], a[84:87]
    s_add_u32 s46, s54, s53
    s_mul_i32 s37, s37, 6144
    s_add_u32 s40, s30, s37
    v_mfma_f32_16x16x32_bf16 a[88:91], v[236:239], v[152:155], a[88:91]
    ds_read_b64_tr_b16 v[228:229], v15 offset:0
    s_add_u32 s43, s32, s37
    v_mfma_f32_16x16x32_bf16 a[92:95], v[236:239], v[156:159], a[92:95]
    ds_read_b64_tr_b16 v[230:231], v15 offset:2048
    s_lshl_b32 s53, s38, 11
    s_waitcnt lgkmcnt(8)
    v_mfma_f32_16x16x32_bf16 a[96:99], v[240:243], v[148:151], a[96:99]
    s_add_u32 s47, s54, s53
    s_mul_i32 s38, s38, 6144
    v_mfma_f32_16x16x32_bf16 a[100:103], v[240:243], v[152:155], a[100:103]
    ds_read_b64_tr_b16 v[232:233], v16 offset:0
    s_add_u32 s41, s30, s38
    s_add_u32 s44, s32, s38
    v_mfma_f32_16x16x32_bf16 a[104:107], v[240:243], v[156:159], a[104:107]
    ds_read_b64_tr_b16 v[234:235], v16 offset:2048
    v_and_b32 v217, 3, v1
    v_mfma_f32_16x16x32_bf16 a[108:111], v[244:247], v[148:151], a[108:111]
    v_max_u32 v217, 1, v217
    v_lshrrev_b32 v218, 1, v217
    v_lshlrev_b32 v217, 1, v217
    v_mfma_f32_16x16x32_bf16 a[112:115], v[244:247], v[152:155], a[112:115]
    ds_read_b64_tr_b16 v[236:237], v17 offset:0
    v_and_b32 v217, 2, v217
    v_or_b32 v217, v217, v218
    v_mfma_f32_16x16x32_bf16 a[116:119], v[244:247], v[156:159], a[116:119]
    ds_read_b64_tr_b16 v[238:239], v17 offset:2048
    s_waitcnt lgkmcnt(8)
    v_mfma_f32_16x16x32_bf16 a[120:123], v[248:251], v[148:151], a[120:123]
    v_xor_b32 v217, s23, v217
    v_mul_u32_u24 v217, 384, v217
    v_add_u32 v218, 4096, v9
    v_mfma_f32_16x16x32_bf16 a[124:127], v[248:251], v[152:155], a[124:127]
    ds_read_b64_tr_b16 v[240:241], v14 offset:4096
    v_mov_b32 v2, 159744
    v_mfma_f32_16x16x32_bf16 a[128:131], v[248:251], v[156:159], a[128:131]
    ds_read_b64_tr_b16 v[242:243], v14 offset:6144
    ds_read_b64 v[22:23], v2
    v_mov_b32 v8, 0
    v_mfma_f32_16x16x32_bf16 a[132:135], v[252:255], v[148:151], a[132:135]
    v_add_u32 v221, 2, v221
    ds_write_b32 v220, v221
    v_mfma_f32_16x16x32_bf16 a[136:139], v[252:255], v[152:155], a[136:139]
    ds_read_b64_tr_b16 v[244:245], v15 offset:4096
    s_mov_b32 s63, 0
    v_mfma_f32_16x16x32_bf16 a[140:143], v[252:255], v[156:159], a[140:143]
    ds_read_b64_tr_b16 v[246:247], v15 offset:6144
    v_accvgpr_read_b32 v2, a144
    v_accvgpr_read_b32 v4, a148
    v_accvgpr_read_b32 v6, a152
    s_waitcnt lgkmcnt(3)
    v_readfirstlane_b32 s68, v22
    v_readfirstlane_b32 s69, v23
    v_mov_b32 v29, v23
    v_rcp_f32 v2, v2
    v_rcp_f32 v4, v4
    v_rcp_f32 v6, v6
    v_mov_b32 v3, v2
    v_mov_b32 v5, v4
    v_mov_b32 v7, v6
    v_accvgpr_read_b32 v176, a0
    v_accvgpr_read_b32 v177, a1
    v_accvgpr_read_b32 v178, a2
    v_accvgpr_read_b32 v179, a3
    v_accvgpr_read_b32 v180, a12
    v_accvgpr_read_b32 v181, a13
    v_accvgpr_read_b32 v182, a14
    v_accvgpr_read_b32 v183, a15
    v_pk_mul_f32 v[176:177], v[176:177], v[2:3]
    v_pk_mul_f32 v[178:179], v[178:179], v[2:3]
    v_pk_mul_f32 v[180:181], v[180:181], v[2:3]
    v_pk_mul_f32 v[182:183], v[182:183], v[2:3]
    v_cvt_pk_bf16_f32 v32, v176, v177
    v_cvt_pk_bf16_f32 v33, v178, v179
    v_cvt_pk_bf16_f32 v34, v180, v181
    v_cvt_pk_bf16_f32 v35, v182, v183
    buffer_store_dwordx4 v[32:35], v9, s[48:51], s39 offen offset:0 sc1
    v_accvgpr_read_b32 v184, a4
    v_accvgpr_read_b32 v185, a5
    v_accvgpr_read_b32 v186, a6
    v_accvgpr_read_b32 v187, a7
    v_accvgpr_read_b32 v188, a16
    v_accvgpr_read_b32 v189, a17
    v_accvgpr_read_b32 v190, a18
    v_accvgpr_read_b32 v191, a19
    v_pk_mul_f32 v[184:185], v[184:185], v[4:5]
    v_pk_mul_f32 v[186:187], v[186:187], v[4:5]
    v_pk_mul_f32 v[188:189], v[188:189], v[4:5]
    v_pk_mul_f32 v[190:191], v[190:191], v[4:5]
    v_cvt_pk_bf16_f32 v56, v184, v185
    v_cvt_pk_bf16_f32 v57, v186, v187
    v_cvt_pk_bf16_f32 v58, v188, v189
    v_cvt_pk_bf16_f32 v59, v190, v191
    buffer_store_dwordx4 v[56:59], v9, s[48:51], s40 offen offset:0 sc1
    v_accvgpr_read_b32 v192, a8
    v_accvgpr_read_b32 v193, a9
    v_accvgpr_read_b32 v194, a10
    v_accvgpr_read_b32 v195, a11
    v_accvgpr_read_b32 v196, a20
    v_accvgpr_read_b32 v197, a21
    v_accvgpr_read_b32 v198, a22
    v_accvgpr_read_b32 v199, a23
    v_pk_mul_f32 v[192:193], v[192:193], v[6:7]
    v_pk_mul_f32 v[194:195], v[194:195], v[6:7]
    v_pk_mul_f32 v[196:197], v[196:197], v[6:7]
    v_pk_mul_f32 v[198:199], v[198:199], v[6:7]
    v_cvt_pk_bf16_f32 v80, v192, v193
    v_cvt_pk_bf16_f32 v81, v194, v195
    v_cvt_pk_bf16_f32 v82, v196, v197
    v_cvt_pk_bf16_f32 v83, v198, v199
    buffer_store_dwordx4 v[80:83], v9, s[48:51], s41 offen offset:0 sc1
    v_mfma_f32_16x16x32_bf16 a[144:147], v[224:227], v[32:35], 0
    v_add_u32 v18, 0, v10
    v_add_u32 v19, 0, v11
    v_accvgpr_read_b32 v200, a24
    v_accvgpr_read_b32 v201, a25
    v_mfma_f32_16x16x32_bf16 a[148:151], v[224:227], v[56:59], 0
    ds_read_b64_tr_b16 v[248:249], v16 offset:4096
    v_add_u32 v20, 0, v12
    v_accvgpr_read_b32 v202, a26
    v_accvgpr_read_b32 v203, a27
    v_mfma_f32_16x16x32_bf16 a[152:155], v[224:227], v[80:83], 0
    ds_read_b64_tr_b16 v[250:251], v16 offset:6144
    v_add_u32 v21, 0, v13
    v_accvgpr_read_b32 v204, a36
    v_accvgpr_read_b32 v205, a37
    v_mfma_f32_16x16x32_bf16 a[156:159], v[228:231], v[32:35], 0
    v_accvgpr_read_b32 v206, a38
    v_accvgpr_read_b32 v207, a39
    v_pk_mul_f32 v[200:201], v[200:201], v[2:3]
    v_pk_mul_f32 v[202:203], v[202:203], v[2:3]
    v_mfma_f32_16x16x32_bf16 a[160:163], v[228:231], v[56:59], 0
    ds_read_b64_tr_b16 v[252:253], v17 offset:4096
    v_pk_mul_f32 v[204:205], v[204:205], v[2:3]
    v_pk_mul_f32 v[206:207], v[206:207], v[2:3]
    v_cvt_pk_bf16_f32 v36, v200, v201
    v_mfma_f32_16x16x32_bf16 a[164:167], v[228:231], v[80:83], 0
    ds_read_b64_tr_b16 v[254:255], v17 offset:6144
    v_cvt_pk_bf16_f32 v37, v202, v203
    v_mfma_f32_16x16x32_bf16 a[168:171], v[232:235], v[32:35], 0
    v_cvt_pk_bf16_f32 v38, v204, v205
    v_cvt_pk_bf16_f32 v39, v206, v207
    buffer_store_dwordx4 v[36:39], v9, s[48:51], s39 offen offset:1024 sc1
    v_mfma_f32_16x16x32_bf16 a[172:175], v[232:235], v[56:59], 0
    ds_read_b64_tr_b16 v[224:225], v14 offset:8192
    v_accvgpr_read_b32 v176, a28
    v_accvgpr_read_b32 v177, a29
    v_accvgpr_read_b32 v178, a30
    v_mfma_f32_16x16x32_bf16 a[176:179], v[232:235], v[80:83], 0
    ds_read_b64_tr_b16 v[226:227], v14 offset:10240
    v_accvgpr_read_b32 v179, a31
    v_accvgpr_read_b32 v180, a40
    v_accvgpr_read_b32 v181, a41
    v_mfma_f32_16x16x32_bf16 a[180:183], v[236:239], v[32:35], 0
    v_accvgpr_read_b32 v182, a42
    v_accvgpr_read_b32 v183, a43
    v_pk_mul_f32 v[176:177], v[176:177], v[4:5]
    v_pk_mul_f32 v[178:179], v[178:179], v[4:5]
    v_pk_mul_f32 v[180:181], v[180:181], v[4:5]
    v_pk_mul_f32 v[182:183], v[182:183], v[4:5]
    v_cvt_pk_bf16_f32 v60, v176, v177
    v_cvt_pk_bf16_f32 v61, v178, v179
    v_cvt_pk_bf16_f32 v62, v180, v181
    v_cvt_pk_bf16_f32 v63, v182, v183
    buffer_store_dwordx4 v[60:63], v9, s[48:51], s40 offen offset:1024 sc1
    v_accvgpr_read_b32 v184, a32
    v_accvgpr_read_b32 v185, a33
    v_accvgpr_read_b32 v186, a34
    v_accvgpr_read_b32 v187, a35
    v_accvgpr_read_b32 v188, a44
    v_accvgpr_read_b32 v189, a45
    v_accvgpr_read_b32 v190, a46
    v_accvgpr_read_b32 v191, a47
    v_pk_mul_f32 v[184:185], v[184:185], v[6:7]
    v_pk_mul_f32 v[186:187], v[186:187], v[6:7]
    v_pk_mul_f32 v[188:189], v[188:189], v[6:7]
    v_pk_mul_f32 v[190:191], v[190:191], v[6:7]
    v_cvt_pk_bf16_f32 v84, v184, v185
    v_cvt_pk_bf16_f32 v85, v186, v187
    v_cvt_pk_bf16_f32 v86, v188, v189
    v_cvt_pk_bf16_f32 v87, v190, v191
    buffer_store_dwordx4 v[84:87], v9, s[48:51], s41 offen offset:1024 sc1
    v_mfma_f32_16x16x32_bf16 a[184:187], v[236:239], v[56:59], 0
    ds_read_b64_tr_b16 v[228:229], v15 offset:8192
    v_accvgpr_read_b32 v192, a48
    v_accvgpr_read_b32 v193, a49
    v_accvgpr_read_b32 v194, a50
    v_mfma_f32_16x16x32_bf16 a[188:191], v[236:239], v[80:83], 0
    ds_read_b64_tr_b16 v[230:231], v15 offset:10240
    v_accvgpr_read_b32 v195, a51
    v_accvgpr_read_b32 v196, a60
    s_waitcnt lgkmcnt(8)
    v_mfma_f32_16x16x32_bf16 a[144:147], v[240:243], v[36:39], a[144:147]
    v_accvgpr_read_b32 v197, a61
    v_accvgpr_read_b32 v198, a62
    v_accvgpr_read_b32 v199, a63
    v_pk_mul_f32 v[192:193], v[192:193], v[2:3]
    v_mfma_f32_16x16x32_bf16 a[148:151], v[240:243], v[60:63], a[148:151]
    ds_read_b64_tr_b16 v[232:233], v16 offset:8192
    v_pk_mul_f32 v[194:195], v[194:195], v[2:3]
    v_pk_mul_f32 v[196:197], v[196:197], v[2:3]
    v_pk_mul_f32 v[198:199], v[198:199], v[2:3]
    v_mfma_f32_16x16x32_bf16 a[152:155], v[240:243], v[84:87], a[152:155]
    ds_read_b64_tr_b16 v[234:235], v16 offset:10240
    v_cvt_pk_bf16_f32 v40, v192, v193
    v_cvt_pk_bf16_f32 v41, v194, v195
    v_mfma_f32_16x16x32_bf16 a[156:159], v[244:247], v[36:39], a[156:159]
    v_cvt_pk_bf16_f32 v42, v196, v197
    v_cvt_pk_bf16_f32 v43, v198, v199
    buffer_store_dwordx4 v[40:43], v9, s[48:51], s39 offen offset:2048 sc1
    v_mfma_f32_16x16x32_bf16 a[160:163], v[244:247], v[60:63], a[160:163]
    ds_read_b64_tr_b16 v[236:237], v17 offset:8192
    v_accvgpr_read_b32 v200, a52
    v_accvgpr_read_b32 v201, a53
    v_accvgpr_read_b32 v202, a54
    v_mfma_f32_16x16x32_bf16 a[164:167], v[244:247], v[84:87], a[164:167]
    ds_read_b64_tr_b16 v[238:239], v17 offset:10240
    v_accvgpr_read_b32 v203, a55
    v_accvgpr_read_b32 v204, a64
    s_waitcnt lgkmcnt(8)
    v_mfma_f32_16x16x32_bf16 a[168:171], v[248:251], v[36:39], a[168:171]
    v_accvgpr_read_b32 v205, a65
    v_accvgpr_read_b32 v206, a66
    v_accvgpr_read_b32 v207, a67
    v_pk_mul_f32 v[200:201], v[200:201], v[4:5]
    v_mfma_f32_16x16x32_bf16 a[172:175], v[248:251], v[60:63], a[172:175]
    ds_read_b64_tr_b16 v[240:241], v18 offset:0
    v_pk_mul_f32 v[202:203], v[202:203], v[4:5]
    v_pk_mul_f32 v[204:205], v[204:205], v[4:5]
    v_pk_mul_f32 v[206:207], v[206:207], v[4:5]
    v_mfma_f32_16x16x32_bf16 a[176:179], v[248:251], v[84:87], a[176:179]
    ds_read_b64_tr_b16 v[242:243], v18 offset:2048
    v_cvt_pk_bf16_f32 v64, v200, v201
    v_cvt_pk_bf16_f32 v65, v202, v203
    v_mfma_f32_16x16x32_bf16 a[180:183], v[252:255], v[36:39], a[180:183]
    v_cvt_pk_bf16_f32 v66, v204, v205
    v_cvt_pk_bf16_f32 v67, v206, v207
    buffer_store_dwordx4 v[64:67], v9, s[48:51], s40 offen offset:2048 sc1
    v_accvgpr_read_b32 v176, a56
    v_accvgpr_read_b32 v177, a57
    v_accvgpr_read_b32 v178, a58
    v_accvgpr_read_b32 v179, a59
    v_accvgpr_read_b32 v180, a68
    v_accvgpr_read_b32 v181, a69
    v_accvgpr_read_b32 v182, a70
    v_accvgpr_read_b32 v183, a71
    v_pk_mul_f32 v[176:177], v[176:177], v[6:7]
    v_pk_mul_f32 v[178:179], v[178:179], v[6:7]
    v_pk_mul_f32 v[180:181], v[180:181], v[6:7]
    v_pk_mul_f32 v[182:183], v[182:183], v[6:7]
    v_cvt_pk_bf16_f32 v88, v176, v177
    v_cvt_pk_bf16_f32 v89, v178, v179
    v_cvt_pk_bf16_f32 v90, v180, v181
    v_cvt_pk_bf16_f32 v91, v182, v183
    buffer_store_dwordx4 v[88:91], v9, s[48:51], s41 offen offset:2048 sc1
    v_mfma_f32_16x16x32_bf16 a[184:187], v[252:255], v[60:63], a[184:187]
    ds_read_b64_tr_b16 v[244:245], v19 offset:0
    v_accvgpr_read_b32 v184, a72
    v_accvgpr_read_b32 v185, a73
    v_accvgpr_read_b32 v186, a74
    v_mfma_f32_16x16x32_bf16 a[188:191], v[252:255], v[84:87], a[188:191]
    ds_read_b64_tr_b16 v[246:247], v19 offset:2048
    v_accvgpr_read_b32 v187, a75
    v_accvgpr_read_b32 v188, a84
    s_waitcnt lgkmcnt(8)
    v_mfma_f32_16x16x32_bf16 a[144:147], v[224:227], v[40:43], a[144:147]
    v_accvgpr_read_b32 v189, a85
    v_accvgpr_read_b32 v190, a86
    v_accvgpr_read_b32 v191, a87
    v_pk_mul_f32 v[184:185], v[184:185], v[2:3]
    v_mfma_f32_16x16x32_bf16 a[148:151], v[224:227], v[64:67], a[148:151]
    ds_read_b64_tr_b16 v[248:249], v20 offset:0
    v_pk_mul_f32 v[186:187], v[186:187], v[2:3]
    v_pk_mul_f32 v[188:189], v[188:189], v[2:3]
    v_pk_mul_f32 v[190:191], v[190:191], v[2:3]
    v_mfma_f32_16x16x32_bf16 a[152:155], v[224:227], v[88:91], a[152:155]
    ds_read_b64_tr_b16 v[250:251], v20 offset:2048
    v_cvt_pk_bf16_f32 v44, v184, v185
    v_cvt_pk_bf16_f32 v45, v186, v187
    v_mfma_f32_16x16x32_bf16 a[156:159], v[228:231], v[40:43], a[156:159]
    v_cvt_pk_bf16_f32 v46, v188, v189
    v_cvt_pk_bf16_f32 v47, v190, v191
    buffer_store_dwordx4 v[44:47], v9, s[48:51], s39 offen offset:3072 sc1
    v_mfma_f32_16x16x32_bf16 a[160:163], v[228:231], v[64:67], a[160:163]
    ds_read_b64_tr_b16 v[252:253], v21 offset:0
    v_accvgpr_read_b32 v192, a76
    v_accvgpr_read_b32 v193, a77
    v_accvgpr_read_b32 v194, a78
    v_mfma_f32_16x16x32_bf16 a[164:167], v[228:231], v[88:91], a[164:167]
    ds_read_b64_tr_b16 v[254:255], v21 offset:2048
    v_accvgpr_read_b32 v195, a79
    v_accvgpr_read_b32 v196, a88
    s_waitcnt lgkmcnt(8)
    v_mfma_f32_16x16x32_bf16 a[168:171], v[232:235], v[40:43], a[168:171]
    v_accvgpr_read_b32 v197, a89
    v_accvgpr_read_b32 v198, a90
    v_accvgpr_read_b32 v199, a91
    v_pk_mul_f32 v[192:193], v[192:193], v[4:5]
    v_mfma_f32_16x16x32_bf16 a[172:175], v[232:235], v[64:67], a[172:175]
    ds_read_b64_tr_b16 v[224:225], v18 offset:4096
    v_pk_mul_f32 v[194:195], v[194:195], v[4:5]
    v_pk_mul_f32 v[196:197], v[196:197], v[4:5]
    v_pk_mul_f32 v[198:199], v[198:199], v[4:5]
    v_mfma_f32_16x16x32_bf16 a[176:179], v[232:235], v[88:91], a[176:179]
    ds_read_b64_tr_b16 v[226:227], v18 offset:6144
    v_cvt_pk_bf16_f32 v68, v192, v193
    v_cvt_pk_bf16_f32 v69, v194, v195
    v_mfma_f32_16x16x32_bf16 a[180:183], v[236:239], v[40:43], a[180:183]
    v_cvt_pk_bf16_f32 v70, v196, v197
    v_cvt_pk_bf16_f32 v71, v198, v199
    buffer_store_dwordx4 v[68:71], v9, s[48:51], s40 offen offset:3072 sc1
    v_mfma_f32_16x16x32_bf16 a[184:187], v[236:239], v[64:67], a[184:187]
    ds_read_b64_tr_b16 v[228:229], v19 offset:4096
    v_accvgpr_read_b32 v200, a80
    v_accvgpr_read_b32 v201, a81
    v_accvgpr_read_b32 v202, a82
    v_mfma_f32_16x16x32_bf16 a[188:191], v[236:239], v[88:91], a[188:191]
    ds_read_b64_tr_b16 v[230:231], v19 offset:6144
    v_accvgpr_read_b32 v203, a83
    v_accvgpr_read_b32 v204, a92
    s_waitcnt lgkmcnt(8)
    v_mfma_f32_16x16x32_bf16 a[192:195], v[240:243], v[32:35], 0
    v_add_u32 v14, 12288, v10
    v_add_u32 v15, 12288, v11
    v_accvgpr_read_b32 v205, a93
    v_accvgpr_read_b32 v206, a94
    v_mfma_f32_16x16x32_bf16 a[196:199], v[240:243], v[56:59], 0
    ds_read_b64_tr_b16 v[232:233], v20 offset:4096
    v_add_u32 v16, 12288, v12
    v_accvgpr_read_b32 v207, a95
    v_pk_mul_f32 v[200:201], v[200:201], v[6:7]
    v_mfma_f32_16x16x32_bf16 a[200:203], v[240:243], v[80:83], 0
    ds_read_b64_tr_b16 v[234:235], v20 offset:6144
    v_add_u32 v17, 12288, v13
    v_pk_mul_f32 v[202:203], v[202:203], v[6:7]
    v_pk_mul_f32 v[204:205], v[204:205], v[6:7]
    v_mfma_f32_16x16x32_bf16 a[204:207], v[244:247], v[32:35], 0
    v_pk_mul_f32 v[206:207], v[206:207], v[6:7]
    v_cvt_pk_bf16_f32 v92, v200, v201
    v_cvt_pk_bf16_f32 v93, v202, v203
    v_mfma_f32_16x16x32_bf16 a[208:211], v[244:247], v[56:59], 0
    ds_read_b64_tr_b16 v[236:237], v21 offset:4096
    v_cvt_pk_bf16_f32 v94, v204, v205
    v_cvt_pk_bf16_f32 v95, v206, v207
    v_mfma_f32_16x16x32_bf16 a[212:215], v[244:247], v[80:83], 0
    ds_read_b64_tr_b16 v[238:239], v21 offset:6144
    buffer_store_dwordx4 v[92:95], v9, s[48:51], s41 offen offset:3072 sc1
    v_accvgpr_read_b32 v176, a96
    s_waitcnt lgkmcnt(8)
    v_mfma_f32_16x16x32_bf16 a[216:219], v[248:251], v[32:35], 0
    v_accvgpr_read_b32 v177, a97
    v_accvgpr_read_b32 v178, a98
    v_accvgpr_read_b32 v179, a99
    v_accvgpr_read_b32 v180, a108
    v_mfma_f32_16x16x32_bf16 a[220:223], v[248:251], v[56:59], 0
    ds_read_b64_tr_b16 v[240:241], v18 offset:8192
    v_accvgpr_read_b32 v181, a109
    v_accvgpr_read_b32 v182, a110
    v_accvgpr_read_b32 v183, a111
    v_mfma_f32_16x16x32_bf16 a[224:227], v[248:251], v[80:83], 0
    ds_read_b64_tr_b16 v[242:243], v18 offset:10240
    v_pk_mul_f32 v[176:177], v[176:177], v[2:3]
    v_pk_mul_f32 v[178:179], v[178:179], v[2:3]
    v_pk_mul_f32 v[180:181], v[180:181], v[2:3]
    v_mfma_f32_16x16x32_bf16 a[228:231], v[252:255], v[32:35], 0
    v_pk_mul_f32 v[182:183], v[182:183], v[2:3]
    v_cvt_pk_bf16_f32 v48, v176, v177
    v_cvt_pk_bf16_f32 v49, v178, v179
    v_mfma_f32_16x16x32_bf16 a[232:235], v[252:255], v[56:59], 0
    ds_read_b64_tr_b16 v[244:245], v19 offset:8192
    v_cvt_pk_bf16_f32 v50, v180, v181
    v_cvt_pk_bf16_f32 v51, v182, v183
    v_mfma_f32_16x16x32_bf16 a[236:239], v[252:255], v[80:83], 0
    ds_read_b64_tr_b16 v[246:247], v19 offset:10240
    s_add_u32 s62, s39, 4096
    buffer_store_dwordx4 v[48:51], v9, s[48:51], s62 offen offset:0 sc1
    s_waitcnt lgkmcnt(8)
    v_mfma_f32_16x16x32_bf16 a[192:195], v[224:227], v[36:39], a[192:195]
    v_accvgpr_read_b32 v184, a100
    v_accvgpr_read_b32 v185, a101
    v_accvgpr_read_b32 v186, a102
    v_accvgpr_read_b32 v187, a103
    v_mfma_f32_16x16x32_bf16 a[196:199], v[224:227], v[60:63], a[196:199]
    ds_read_b64_tr_b16 v[248:249], v20 offset:8192
    v_accvgpr_read_b32 v188, a112
    v_accvgpr_read_b32 v189, a113
    v_accvgpr_read_b32 v190, a114
    v_mfma_f32_16x16x32_bf16 a[200:203], v[224:227], v[84:87], a[200:203]
    ds_read_b64_tr_b16 v[250:251], v20 offset:10240
    v_accvgpr_read_b32 v191, a115
    v_pk_mul_f32 v[184:185], v[184:185], v[4:5]
    v_pk_mul_f32 v[186:187], v[186:187], v[4:5]
    v_mfma_f32_16x16x32_bf16 a[204:207], v[228:231], v[36:39], a[204:207]
    v_pk_mul_f32 v[188:189], v[188:189], v[4:5]
    v_pk_mul_f32 v[190:191], v[190:191], v[4:5]
    v_cvt_pk_bf16_f32 v72, v184, v185
    v_mfma_f32_16x16x32_bf16 a[208:211], v[228:231], v[60:63], a[208:211]
    ds_read_b64_tr_b16 v[252:253], v21 offset:8192
    v_cvt_pk_bf16_f32 v73, v186, v187
    v_cvt_pk_bf16_f32 v74, v188, v189
    v_mfma_f32_16x16x32_bf16 a[212:215], v[228:231], v[84:87], a[212:215]
    ds_read_b64_tr_b16 v[254:255], v21 offset:10240
    v_cvt_pk_bf16_f32 v75, v190, v191
    s_waitcnt lgkmcnt(8)
    v_mfma_f32_16x16x32_bf16 a[216:219], v[232:235], v[36:39], a[216:219]
    s_cmp_ge_u32 s28, 56
    s_cbranch_scc0 L_sl11
L_bk11:
    s_add_u32 s62, s40, 4096
    buffer_store_dwordx4 v[72:75], v9, s[48:51], s62 offen offset:0 sc1
    v_mfma_f32_16x16x32_bf16 a[220:223], v[232:235], v[60:63], a[220:223]
    ds_read_b64_tr_b16 v[224:225], v14 offset:0
    v_accvgpr_read_b32 v192, a104
    v_accvgpr_read_b32 v193, a105
    v_accvgpr_read_b32 v194, a106
    v_mfma_f32_16x16x32_bf16 a[224:227], v[232:235], v[84:87], a[224:227]
    ds_read_b64_tr_b16 v[226:227], v14 offset:2048
    v_accvgpr_read_b32 v195, a107
    v_accvgpr_read_b32 v196, a116
    v_accvgpr_read_b32 v197, a117
    v_mfma_f32_16x16x32_bf16 a[228:231], v[236:239], v[36:39], a[228:231]
    v_accvgpr_read_b32 v198, a118
    v_accvgpr_read_b32 v199, a119
    v_pk_mul_f32 v[192:193], v[192:193], v[6:7]
    v_pk_mul_f32 v[194:195], v[194:195], v[6:7]
    v_mfma_f32_16x16x32_bf16 a[232:235], v[236:239], v[60:63], a[232:235]
    ds_read_b64_tr_b16 v[228:229], v15 offset:0
    v_pk_mul_f32 v[196:197], v[196:197], v[6:7]
    v_pk_mul_f32 v[198:199], v[198:199], v[6:7]
    v_cvt_pk_bf16_f32 v96, v192, v193
    v_mfma_f32_16x16x32_bf16 a[236:239], v[236:239], v[84:87], a[236:239]
    ds_read_b64_tr_b16 v[230:231], v15 offset:2048
    v_cvt_pk_bf16_f32 v97, v194, v195
    s_waitcnt lgkmcnt(8)
    v_mfma_f32_16x16x32_bf16 a[192:195], v[240:243], v[40:43], a[192:195]
    v_cvt_pk_bf16_f32 v98, v196, v197
    v_cvt_pk_bf16_f32 v99, v198, v199
    s_add_u32 s62, s41, 4096
    v_mfma_f32_16x16x32_bf16 a[196:199], v[240:243], v[64:67], a[196:199]
    ds_read_b64_tr_b16 v[232:233], v16 offset:0
    buffer_store_dwordx4 v[96:99], v9, s[48:51], s62 offen offset:0 sc1
    v_accvgpr_read_b32 v200, a120
    v_accvgpr_read_b32 v201, a121
    v_mfma_f32_16x16x32_bf16 a[200:203], v[240:243], v[88:91], a[200:203]
    ds_read_b64_tr_b16 v[234:235], v16 offset:2048
    v_accvgpr_read_b32 v202, a122
    v_accvgpr_read_b32 v203, a123
    v_accvgpr_read_b32 v204, a132
    v_mfma_f32_16x16x32_bf16 a[204:207], v[244:247], v[40:43], a[204:207]
    v_accvgpr_read_b32 v205, a133
    v_accvgpr_read_b32 v206, a134
    v_accvgpr_read_b32 v207, a135
    v_pk_mul_f32 v[200:201], v[200:201], v[2:3]
    v_mfma_f32_16x16x32_bf16 a[208:211], v[244:247], v[64:67], a[208:211]
    ds_read_b64_tr_b16 v[236:237], v17 offset:0
    v_pk_mul_f32 v[202:203], v[202:203], v[2:3]
    v_pk_mul_f32 v[204:205], v[204:205], v[2:3]
    v_pk_mul_f32 v[206:207], v[206:207], v[2:3]
    v_mfma_f32_16x16x32_bf16 a[212:215], v[244:247], v[88:91], a[212:215]
    ds_read_b64_tr_b16 v[238:239], v17 offset:2048
    v_cvt_pk_bf16_f32 v52, v200, v201
    s_waitcnt lgkmcnt(8)
    v_mfma_f32_16x16x32_bf16 a[216:219], v[248:251], v[40:43], a[216:219]
    v_cvt_pk_bf16_f32 v53, v202, v203
    v_cvt_pk_bf16_f32 v54, v204, v205
    v_cvt_pk_bf16_f32 v55, v206, v207
    v_mfma_f32_16x16x32_bf16 a[220:223], v[248:251], v[64:67], a[220:223]
    ds_read_b64_tr_b16 v[240:241], v14 offset:4096
    s_add_u32 s62, s39, 4096
    buffer_store_dwordx4 v[52:55], v9, s[48:51], s62 offen offset:1024 sc1
    v_accvgpr_read_b32 v176, a124
    v_mfma_f32_16x16x32_bf16 a[224:227], v[248:251], v[88:91], a[224:227]
    ds_read_b64_tr_b16 v[242:243], v14 offset:6144
    v_accvgpr_read_b32 v177, a125
    v_accvgpr_read_b32 v178, a126
    v_mfma_f32_16x16x32_bf16 a[228:231], v[252:255], v[40:43], a[228:231]
    v_add_u32 v221, 2, v221
    ds_write_b32 v220, v221
    v_mfma_f32_16x16x32_bf16 a[232:235], v[252:255], v[64:67], a[232:235]
    ds_read_b64_tr_b16 v[244:245], v15 offset:4096
    v_accvgpr_read_b32 v179, a127
    v_accvgpr_read_b32 v180, a136
    v_mfma_f32_16x16x32_bf16 a[236:239], v[252:255], v[88:91], a[236:239]
    ds_read_b64_tr_b16 v[246:247], v15 offset:6144
    s_waitcnt lgkmcnt(9)
    v_mfma_f32_16x16x32_bf16 a[0:3], v[224:227], v[32:35], 0
    v_add_u32 v18, 24576, v10
    v_add_u32 v19, 24576, v11
    v_accvgpr_read_b32 v181, a137
    v_accvgpr_read_b32 v182, a138
    v_mfma_f32_16x16x32_bf16 a[4:7], v[224:227], v[56:59], 0
    ds_read_b64_tr_b16 v[248:249], v16 offset:4096
    v_add_u32 v20, 24576, v12
    v_accvgpr_read_b32 v183, a139
    v_pk_mul_f32 v[176:177], v[176:177], v[4:5]
    v_mfma_f32_16x16x32_bf16 a[8:11], v[224:227], v[80:83], 0
    ds_read_b64_tr_b16 v[250:251], v16 offset:6144
    v_add_u32 v21, 24576, v13
    v_pk_mul_f32 v[178:179], v[178:179], v[4:5]
    v_pk_mul_f32 v[180:181], v[180:181], v[4:5]
    v_mfma_f32_16x16x32_bf16 a[12:15], v[228:231], v[32:35], 0
    v_pk_mul_f32 v[182:183], v[182:183], v[4:5]
    v_cvt_pk_bf16_f32 v76, v176, v177
    v_mfma_f32_16x16x32_bf16 a[16:19], v[228:231], v[56:59], 0
    ds_read_b64_tr_b16 v[252:253], v17 offset:4096
    v_cvt_pk_bf16_f32 v77, v178, v179
    v_cvt_pk_bf16_f32 v78, v180, v181
    v_mfma_f32_16x16x32_bf16 a[20:23], v[228:231], v[80:83], 0
    ds_read_b64_tr_b16 v[254:255], v17 offset:6144
    s_waitcnt lgkmcnt(9)
    v_mfma_f32_16x16x32_bf16 a[24:27], v[232:235], v[32:35], 0
    v_cvt_pk_bf16_f32 v79, v182, v183
    s_add_u32 s62, s40, 4096
    v_mfma_f32_16x16x32_bf16 a[28:31], v[232:235], v[56:59], 0
    ds_read_b64_tr_b16 v[224:225], v14 offset:8192
    buffer_store_dwordx4 v[76:79], v9, s[48:51], s62 offen offset:1024 sc1
    v_accvgpr_read_b32 v184, a128
    v_mfma_f32_16x16x32_bf16 a[32:35], v[232:235], v[80:83], 0
    ds_read_b64_tr_b16 v[226:227], v14 offset:10240
    v_accvgpr_read_b32 v185, a129
    v_mfma_f32_16x16x32_bf16 a[36:39], v[236:239], v[32:35], 0
    v_accvgpr_read_b32 v186, a130
    v_accvgpr_read_b32 v187, a131
    v_accvgpr_read_b32 v188, a140
    v_mfma_f32_16x16x32_bf16 a[40:43], v[236:239], v[56:59], 0
    ds_read_b64_tr_b16 v[228:229], v15 offset:8192
    v_accvgpr_read_b32 v189, a141
    v_mfma_f32_16x16x32_bf16 a[44:47], v[236:239], v[80:83], 0
    ds_read_b64_tr_b16 v[230:231], v15 offset:10240
    v_accvgpr_read_b32 v190, a142
    s_waitcnt lgkmcnt(8)
    v_mfma_f32_16x16x32_bf16 a[0:3], v[240:243], v[36:39], a[0:3]
    v_accvgpr_read_b32 v191, a143
    v_pk_mul_f32 v[184:185], v[184:185], v[6:7]
    v_mfma_f32_16x16x32_bf16 a[4:7], v[240:243], v[60:63], a[4:7]
    ds_read_b64_tr_b16 v[232:233], v16 offset:8192
    v_pk_mul_f32 v[186:187], v[186:187], v[6:7]
    v_pk_mul_f32 v[188:189], v[188:189], v[6:7]
    v_mfma_f32_16x16x32_bf16 a[8:11], v[240:243], v[84:87], a[8:11]
    ds_read_b64_tr_b16 v[234:235], v16 offset:10240
    v_pk_mul_f32 v[190:191], v[190:191], v[6:7]
    v_mfma_f32_16x16x32_bf16 a[12:15], v[244:247], v[36:39], a[12:15]
    v_cvt_pk_bf16_f32 v100, v184, v185
    v_cvt_pk_bf16_f32 v101, v186, v187
    v_mfma_f32_16x16x32_bf16 a[16:19], v[244:247], v[60:63], a[16:19]
    ds_read_b64_tr_b16 v[236:237], v17 offset:8192
    v_cvt_pk_bf16_f32 v102, v188, v189
    v_cvt_pk_bf16_f32 v103, v190, v191
    v_mfma_f32_16x16x32_bf16 a[20:23], v[244:247], v[84:87], a[20:23]
    ds_read_b64_tr_b16 v[238:239], v17 offset:10240
    s_waitcnt lgkmcnt(8)
    v_mfma_f32_16x16x32_bf16 a[24:27], v[248:251], v[36:39], a[24:27]
    s_add_u32 s62, s41, 4096
    buffer_store_dwordx4 v[100:103], v9, s[48:51], s62 offen offset:1024 sc1
    v_mfma_f32_16x16x32_bf16 a[28:31], v[248:251], v[60:63], a[28:31]
    ds_read_b64_tr_b16 v[240:241], v18 offset:0
    v_mfma_f32_16x16x32_bf16 a[32:35], v[248:251], v[84:87], a[32:35]
    ds_read_b64_tr_b16 v[242:243], v18 offset:2048
    v_mfma_f32_16x16x32_bf16 a[36:39], v[252:255], v[36:39], a[36:39]
    v_mfma_f32_16x16x32_bf16 a[40:43], v[252:255], v[60:63], a[40:43]
    ds_read_b64_tr_b16 v[244:245], v19 offset:0
    v_mfma_f32_16x16x32_bf16 a[44:47], v[252:255], v[84:87], a[44:47]
    ds_read_b64_tr_b16 v[246:247], v19 offset:2048
    s_waitcnt lgkmcnt(8)
    v_mfma_f32_16x16x32_bf16 a[0:3], v[224:227], v[40:43], a[0:3]
    v_mfma_f32_16x16x32_bf16 a[4:7], v[224:227], v[64:67], a[4:7]
    ds_read_b64_tr_b16 v[248:249], v20 offset:0
    v_mfma_f32_16x16x32_bf16 a[8:11], v[224:227], v[88:91], a[8:11]
    ds_read_b64_tr_b16 v[250:251], v20 offset:2048
    v_mfma_f32_16x16x32_bf16 a[12:15], v[228:231], v[40:43], a[12:15]
    v_mfma_f32_16x16x32_bf16 a[16:19], v[228:231], v[64:67], a[16:19]
    ds_read_b64_tr_b16 v[252:253], v21 offset:0
    v_mfma_f32_16x16x32_bf16 a[20:23], v[228:231], v[88:91], a[20:23]
    ds_read_b64_tr_b16 v[254:255], v21 offset:2048
    s_waitcnt lgkmcnt(8)
    v_mfma_f32_16x16x32_bf16 a[24:27], v[232:235], v[40:43], a[24:27]
    v_mfma_f32_16x16x32_bf16 a[28:31], v[232:235], v[64:67], a[28:31]
    ds_read_b64_tr_b16 v[224:225], v18 offset:4096
    v_mfma_f32_16x16x32_bf16 a[32:35], v[232:235], v[88:91], a[32:35]
    ds_read_b64_tr_b16 v[226:227], v18 offset:6144
    v_mfma_f32_16x16x32_bf16 a[36:39], v[236:239], v[40:43], a[36:39]
    v_mfma_f32_16x16x32_bf16 a[40:43], v[236:239], v[64:67], a[40:43]
    ds_read_b64_tr_b16 v[228:229], v19 offset:4096
    v_mfma_f32_16x16x32_bf16 a[44:47], v[236:239], v[88:91], a[44:47]
    ds_read_b64_tr_b16 v[230:231], v19 offset:6144
    s_waitcnt vmcnt(0)
    buffer_store_dwordx2 v[22:23], v8, s[48:51], s60 offen sc1
    buffer_load_dwordx2 v[26:27], v217, s[48:51], s61 offen sc1
    s_waitcnt lgkmcnt(8)
    v_mfma_f32_16x16x32_bf16 a[144:147], v[240:243], v[44:47], a[144:147]
    v_add_u32 v14, 36864, v10
    v_add_u32 v15, 36864, v11
    v_mfma_f32_16x16x32_bf16 a[148:151], v[240:243], v[68:71], a[148:151]
    ds_read_b64_tr_b16 v[232:233], v20 offset:4096
    v_add_u32 v16, 36864, v12
    v_mfma_f32_16x16x32_bf16 a[152:155], v[240:243], v[92:95], a[152:155]
    ds_read_b64_tr_b16 v[234:235], v20 offset:6144
    v_add_u32 v17, 36864, v13
    v_mfma_f32_16x16x32_bf16 a[156:159], v[244:247], v[44:47], a[156:159]
    v_mfma_f32_16x16x32_bf16 a[160:163], v[244:247], v[68:71], a[160:163]
    ds_read_b64_tr_b16 v[236:237], v21 offset:4096
    v_mfma_f32_16x16x32_bf16 a[164:167], v[244:247], v[92:95], a[164:167]
    ds_read_b64_tr_b16 v[238:239], v21 offset:6144
    s_waitcnt lgkmcnt(8)
    v_mfma_f32_16x16x32_bf16 a[168:171], v[248:251], v[44:47], a[168:171]
    v_mfma_f32_16x16x32_bf16 a[172:175], v[248:251], v[68:71], a[172:175]
    ds_read_b64_tr_b16 v[240:241], v18 offset:8192
    v_mfma_f32_16x16x32_bf16 a[176:179], v[248:251], v[92:95], a[176:179]
    ds_read_b64_tr_b16 v[242:243], v18 offset:10240
    v_mfma_f32_16x16x32_bf16 a[180:183], v[252:255], v[44:47], a[180:183]
    v_mfma_f32_16x16x32_bf16 a[184:187], v[252:255], v[68:71], a[184:187]
    ds_read_b64_tr_b16 v[244:245], v19 offset:8192
    v_mfma_f32_16x16x32_bf16 a[188:191], v[252:255], v[92:95], a[188:191]
    ds_read_b64_tr_b16 v[246:247], v19 offset:10240
    s_waitcnt lgkmcnt(8)
    v_mfma_f32_16x16x32_bf16 a[144:147], v[224:227], v[48:51], a[144:147]
    v_mfma_f32_16x16x32_bf16 a[148:151], v[224:227], v[72:75], a[148:151]
    ds_read_b64_tr_b16 v[248:249], v20 offset:8192
    v_mfma_f32_16x16x32_bf16 a[152:155], v[224:227], v[96:99], a[152:155]
    ds_read_b64_tr_b16 v[250:251], v20 offset:10240
    v_mfma_f32_16x16x32_bf16 a[156:159], v[228:231], v[48:51], a[156:159]
    v_mfma_f32_16x16x32_bf16 a[160:163], v[228:231], v[72:75], a[160:163]
    ds_read_b64_tr_b16 v[252:253], v21 offset:8192
    v_mfma_f32_16x16x32_bf16 a[164:167], v[228:231], v[96:99], a[164:167]
    ds_read_b64_tr_b16 v[254:255], v21 offset:10240
    s_waitcnt lgkmcnt(8)
    v_mfma_f32_16x16x32_bf16 a[168:171], v[232:235], v[48:51], a[168:171]
    s_cmp_ge_u32 s28, 58
    s_cbranch_scc0 L_sl12
L_bk12:
    v_mfma_f32_16x16x32_bf16 a[172:175], v[232:235], v[72:75], a[172:175]
    ds_read_b64_tr_b16 v[224:225], v14 offset:0
    v_mfma_f32_16x16x32_bf16 a[176:179], v[232:235], v[96:99], a[176:179]
    ds_read_b64_tr_b16 v[226:227], v14 offset:2048
    v_mfma_f32_16x16x32_bf16 a[180:183], v[236:239], v[48:51], a[180:183]
    v_mfma_f32_16x16x32_bf16 a[184:187], v[236:239], v[72:75], a[184:187]
    ds_read_b64_tr_b16 v[228:229], v15 offset:0
    v_mfma_f32_16x16x32_bf16 a[188:191], v[236:239], v[96:99], a[188:191]
    ds_read_b64_tr_b16 v[230:231], v15 offset:2048
    s_waitcnt lgkmcnt(8)
    v_mfma_f32_16x16x32_bf16 a[144:147], v[240:243], v[52:55], a[144:147]
    v_mfma_f32_16x16x32_bf16 a[148:151], v[240:243], v[76:79], a[148:151]
    ds_read_b64_tr_b16 v[232:233], v16 offset:0
    v_mfma_f32_16x16x32_bf16 a[152:155], v[240:243], v[100:103], a[152:155]
    ds_read_b64_tr_b16 v[234:235], v16 offset:2048
    v_mfma_f32_16x16x32_bf16 a[156:159], v[244:247], v[52:55], a[156:159]
    v_mfma_f32_16x16x32_bf16 a[160:163], v[244:247], v[76:79], a[160:163]
    ds_read_b64_tr_b16 v[236:237], v17 offset:0
    v_mfma_f32_16x16x32_bf16 a[164:167], v[244:247], v[100:103], a[164:167]
    ds_read_b64_tr_b16 v[238:239], v17 offset:2048
    s_waitcnt lgkmcnt(8)
    v_mfma_f32_16x16x32_bf16 a[168:171], v[248:251], v[52:55], a[168:171]
    v_mfma_f32_16x16x32_bf16 a[172:175], v[248:251], v[76:79], a[172:175]
    ds_read_b64_tr_b16 v[240:241], v14 offset:4096
    v_mfma_f32_16x16x32_bf16 a[176:179], v[248:251], v[100:103], a[176:179]
    ds_read_b64_tr_b16 v[242:243], v14 offset:6144
    v_mfma_f32_16x16x32_bf16 a[180:183], v[252:255], v[52:55], a[180:183]
    v_add_u32 v221, 2, v221
    ds_write_b32 v220, v221
    v_mfma_f32_16x16x32_bf16 a[184:187], v[252:255], v[76:79], a[184:187]
    ds_read_b64_tr_b16 v[244:245], v15 offset:4096
    v_mfma_f32_16x16x32_bf16 a[188:191], v[252:255], v[100:103], a[188:191]
    ds_read_b64_tr_b16 v[246:247], v15 offset:6144
    s_waitcnt lgkmcnt(9)
    v_mfma_f32_16x16x32_bf16 a[192:195], v[224:227], v[44:47], a[192:195]
    v_add_u32 v18, 49152, v10
    v_add_u32 v19, 49152, v11
    v_mfma_f32_16x16x32_bf16 a[196:199], v[224:227], v[68:71], a[196:199]
    ds_read_b64_tr_b16 v[248:249], v16 offset:4096
    v_add_u32 v20, 49152, v12
    v_mfma_f32_16x16x32_bf16 a[200:203], v[224:227], v[92:95], a[200:203]
    ds_read_b64_tr_b16 v[250:251], v16 offset:6144
    v_add_u32 v21, 49152, v13
    v_mfma_f32_16x16x32_bf16 a[204:207], v[228:231], v[44:47], a[204:207]
    v_mfma_f32_16x16x32_bf16 a[208:211], v[228:231], v[68:71], a[208:211]
    ds_read_b64_tr_b16 v[252:253], v17 offset:4096
    v_mfma_f32_16x16x32_bf16 a[212:215], v[228:231], v[92:95], a[212:215]
    ds_read_b64_tr_b16 v[254:255], v17 offset:6144
    s_waitcnt lgkmcnt(9)
    v_mfma_f32_16x16x32_bf16 a[216:219], v[232:235], v[44:47], a[216:219]
    v_mfma_f32_16x16x32_bf16 a[220:223], v[232:235], v[68:71], a[220:223]
    ds_read_b64_tr_b16 v[224:225], v14 offset:8192
    v_mfma_f32_16x16x32_bf16 a[224:227], v[232:235], v[92:95], a[224:227]
    ds_read_b64_tr_b16 v[226:227], v14 offset:10240
    v_mfma_f32_16x16x32_bf16 a[228:231], v[236:239], v[44:47], a[228:231]
    v_mfma_f32_16x16x32_bf16 a[232:235], v[236:239], v[68:71], a[232:235]
    ds_read_b64_tr_b16 v[228:229], v15 offset:8192
    v_mfma_f32_16x16x32_bf16 a[236:239], v[236:239], v[92:95], a[236:239]
    ds_read_b64_tr_b16 v[230:231], v15 offset:10240
    s_waitcnt lgkmcnt(8)
    v_mfma_f32_16x16x32_bf16 a[192:195], v[240:243], v[48:51], a[192:195]
    v_mfma_f32_16x16x32_bf16 a[196:199], v[240:243], v[72:75], a[196:199]
    ds_read_b64_tr_b16 v[232:233], v16 offset:8192
    v_mfma_f32_16x16x32_bf16 a[200:203], v[240:243], v[96:99], a[200:203]
    ds_read_b64_tr_b16 v[234:235], v16 offset:10240
    v_mfma_f32_16x16x32_bf16 a[204:207], v[244:247], v[48:51], a[204:207]
    v_mfma_f32_16x16x32_bf16 a[208:211], v[244:247], v[72:75], a[208:211]
    ds_read_b64_tr_b16 v[236:237], v17 offset:8192
    v_mfma_f32_16x16x32_bf16 a[212:215], v[244:247], v[96:99], a[212:215]
    ds_read_b64_tr_b16 v[238:239], v17 offset:10240
    s_waitcnt lgkmcnt(8)
    v_mfma_f32_16x16x32_bf16 a[216:219], v[248:251], v[48:51], a[216:219]
    v_mfma_f32_16x16x32_bf16 a[220:223], v[248:251], v[72:75], a[220:223]
    ds_read_b64_tr_b16 v[240:241], v18 offset:0
    v_mfma_f32_16x16x32_bf16 a[224:227], v[248:251], v[96:99], a[224:227]
    ds_read_b64_tr_b16 v[242:243], v18 offset:2048
    v_mfma_f32_16x16x32_bf16 a[228:231], v[252:255], v[48:51], a[228:231]
    v_mfma_f32_16x16x32_bf16 a[232:235], v[252:255], v[72:75], a[232:235]
    ds_read_b64_tr_b16 v[244:245], v19 offset:0
    v_mfma_f32_16x16x32_bf16 a[236:239], v[252:255], v[96:99], a[236:239]
    ds_read_b64_tr_b16 v[246:247], v19 offset:2048
    s_waitcnt lgkmcnt(8)
    v_mfma_f32_16x16x32_bf16 a[192:195], v[224:227], v[52:55], a[192:195]
    v_mfma_f32_16x16x32_bf16 a[196:199], v[224:227], v[76:79], a[196:199]
    ds_read_b64_tr_b16 v[248:249], v20 offset:0
    v_mfma_f32_16x16x32_bf16 a[200:203], v[224:227], v[100:103], a[200:203]
    ds_read_b64_tr_b16 v[250:251], v20 offset:2048
    v_mfma_f32_16x16x32_bf16 a[204:207], v[228:231], v[52:55], a[204:207]
    v_mfma_f32_16x16x32_bf16 a[208:211], v[228:231], v[76:79], a[208:211]
    ds_read_b64_tr_b16 v[252:253], v21 offset:0
    v_mfma_f32_16x16x32_bf16 a[212:215], v[228:231], v[100:103], a[212:215]
    ds_read_b64_tr_b16 v[254:255], v21 offset:2048
    s_waitcnt lgkmcnt(8)
    v_mfma_f32_16x16x32_bf16 a[216:219], v[232:235], v[52:55], a[216:219]
    v_mfma_f32_16x16x32_bf16 a[220:223], v[232:235], v[76:79], a[220:223]
    ds_read_b64_tr_b16 v[224:225], v18 offset:4096
    v_mfma_f32_16x16x32_bf16 a[224:227], v[232:235], v[100:103], a[224:227]
    ds_read_b64_tr_b16 v[226:227], v18 offset:6144
    v_mfma_f32_16x16x32_bf16 a[228:231], v[236:239], v[52:55], a[228:231]
    v_mfma_f32_16x16x32_bf16 a[232:235], v[236:239], v[76:79], a[232:235]
    ds_read_b64_tr_b16 v[228:229], v19 offset:4096
    v_mfma_f32_16x16x32_bf16 a[236:239], v[236:239], v[100:103], a[236:239]
    ds_read_b64_tr_b16 v[230:231], v19 offset:6144
    s_waitcnt vmcnt(0)
    v_cmp_eq_u32 vcc, s68, v26
    s_nop 1
    v_cmp_eq_u32 s[64:65], s69, v27
    s_and_b64 vcc, vcc, s[64:65]
    s_bitcmp1_b32 vcc_lo, 1
    s_cbranch_scc1 L_do5
    s_nop 1
    buffer_load_dwordx2 v[26:27], v217, s[48:51], s61 offen sc1
    s_branch L_nl5
L_do5:
    s_call_b64 s[66:67], L_loadBa
L_nl5:
    s_waitcnt lgkmcnt(8)
    v_mfma_f32_16x16x32_bf16 a[0:3], v[240:243], v[44:47], a[0:3]
    v_add_u32 v14, 61440, v10
    v_add_u32 v15, 61440, v11
    v_mfma_f32_16x16x32_bf16 a[4:7], v[240:243], v[68:71], a[4:7]
    ds_read_b64_tr_b16 v[232:233], v20 offset:4096
    v_add_u32 v16, 61440, v12
    v_mfma_f32_16x16x32_bf16 a[8:11], v[240:243], v[92:95], a[8:11]
    ds_read_b64_tr_b16 v[234:235], v20 offset:6144
    v_add_u32 v17, 61440, v13
    v_mfma_f32_16x16x32_bf16 a[12:15], v[244:247], v[44:47], a[12:15]
    v_mfma_f32_16x16x32_bf16 a[16:19], v[244:247], v[68:71], a[16:19]
    ds_read_b64_tr_b16 v[236:237], v21 offset:4096
    v_mfma_f32_16x16x32_bf16 a[20:23], v[244:247], v[92:95], a[20:23]
    ds_read_b64_tr_b16 v[238:239], v21 offset:6144
    s_waitcnt lgkmcnt(8)
    v_mfma_f32_16x16x32_bf16 a[24:27], v[248:251], v[44:47], a[24:27]
    v_mfma_f32_16x16x32_bf16 a[28:31], v[248:251], v[68:71], a[28:31]
    ds_read_b64_tr_b16 v[240:241], v18 offset:8192
    v_mfma_f32_16x16x32_bf16 a[32:35], v[248:251], v[92:95], a[32:35]
    ds_read_b64_tr_b16 v[242:243], v18 offset:10240
    v_mfma_f32_16x16x32_bf16 a[36:39], v[252:255], v[44:47], a[36:39]
    v_mfma_f32_16x16x32_bf16 a[40:43], v[252:255], v[68:71], a[40:43]
    ds_read_b64_tr_b16 v[244:245], v19 offset:8192
    v_mfma_f32_16x16x32_bf16 a[44:47], v[252:255], v[92:95], a[44:47]
    ds_read_b64_tr_b16 v[246:247], v19 offset:10240
    s_waitcnt lgkmcnt(8)
    v_mfma_f32_16x16x32_bf16 a[0:3], v[224:227], v[48:51], a[0:3]
    v_mfma_f32_16x16x32_bf16 a[4:7], v[224:227], v[72:75], a[4:7]
    ds_read_b64_tr_b16 v[248:249], v20 offset:8192
    v_mfma_f32_16x16x32_bf16 a[8:11], v[224:227], v[96:99], a[8:11]
    ds_read_b64_tr_b16 v[250:251], v20 offset:10240
    v_mfma_f32_16x16x32_bf16 a[12:15], v[228:231], v[48:51], a[12:15]
    v_mfma_f32_16x16x32_bf16 a[16:19], v[228:231], v[72:75], a[16:19]
    ds_read_b64_tr_b16 v[252:253], v21 offset:8192
    v_mfma_f32_16x16x32_bf16 a[20:23], v[228:231], v[96:99], a[20:23]
    ds_read_b64_tr_b16 v[254:255], v21 offset:10240
    s_waitcnt lgkmcnt(8)
    v_mfma_f32_16x16x32_bf16 a[24:27], v[232:235], v[48:51], a[24:27]
    s_cmp_ge_u32 s28, 60
    s_cbranch_scc0 L_sl13
L_bk13:
    v_mfma_f32_16x16x32_bf16 a[28:31], v[232:235], v[72:75], a[28:31]
    ds_read_b64_tr_b16 v[224:225], v14 offset:0
    v_mfma_f32_16x16x32_bf16 a[32:35], v[232:235], v[96:99], a[32:35]
    ds_read_b64_tr_b16 v[226:227], v14 offset:2048
    v_mfma_f32_16x16x32_bf16 a[36:39], v[236:239], v[48:51], a[36:39]
    v_mfma_f32_16x16x32_bf16 a[40:43], v[236:239], v[72:75], a[40:43]
    ds_read_b64_tr_b16 v[228:229], v15 offset:0
    v_mfma_f32_16x16x32_bf16 a[44:47], v[236:239], v[96:99], a[44:47]
    ds_read_b64_tr_b16 v[230:231], v15 offset:2048
    s_waitcnt lgkmcnt(8)
    v_mfma_f32_16x16x32_bf16 a[0:3], v[240:243], v[52:55], a[0:3]
    v_mfma_f32_16x16x32_bf16 a[4:7], v[240:243], v[76:79], a[4:7]
    ds_read_b64_tr_b16 v[232:233], v16 offset:0
    v_mfma_f32_16x16x32_bf16 a[8:11], v[240:243], v[100:103], a[8:11]
    ds_read_b64_tr_b16 v[234:235], v16 offset:2048
    v_mfma_f32_16x16x32_bf16 a[12:15], v[244:247], v[52:55], a[12:15]
    v_mfma_f32_16x16x32_bf16 a[16:19], v[244:247], v[76:79], a[16:19]
    ds_read_b64_tr_b16 v[236:237], v17 offset:0
    v_mfma_f32_16x16x32_bf16 a[20:23], v[244:247], v[100:103], a[20:23]
    ds_read_b64_tr_b16 v[238:239], v17 offset:2048
    s_waitcnt lgkmcnt(8)
    v_mfma_f32_16x16x32_bf16 a[24:27], v[248:251], v[52:55], a[24:27]
    v_mfma_f32_16x16x32_bf16 a[28:31], v[248:251], v[76:79], a[28:31]
    ds_read_b64_tr_b16 v[240:241], v14 offset:4096
    v_mfma_f32_16x16x32_bf16 a[32:35], v[248:251], v[100:103], a[32:35]
    ds_read_b64_tr_b16 v[242:243], v14 offset:6144
    v_mfma_f32_16x16x32_bf16 a[36:39], v[252:255], v[52:55], a[36:39]
    v_add_u32 v221, 2, v221
    ds_write_b32 v220, v221
    v_mfma_f32_16x16x32_bf16 a[40:43], v[252:255], v[76:79], a[40:43]
    ds_read_b64_tr_b16 v[244:245], v15 offset:4096
    v_mfma_f32_16x16x32_bf16 a[44:47], v[252:255], v[100:103], a[44:47]
    ds_read_b64_tr_b16 v[246:247], v15 offset:6144
    s_cmp_lg_u32 s63, 0
    s_cbranch_scc1 L_nl10
    s_mov_b32 s62, 0
L_sp10:
    s_waitcnt vmcnt(0)
    v_cmp_eq_u32 vcc, s68, v26
    s_nop 1
    v_cmp_eq_u32 s[64:65], s69, v27
    s_and_b64 vcc, vcc, s[64:65]
    s_bitcmp1_b32 vcc_lo, 1
    s_cbranch_scc1 L_do10
    s_nop 1
    buffer_load_dwordx2 v[26:27], v217, s[48:51], s61 offen sc1
    s_add_u32 s62, s62, 1
    s_cmp_lt_u32 s62, 200000
    s_cbranch_scc1 L_sp10
    s_waitcnt vmcnt(0)
L_do10:
    s_call_b64 s[66:67], L_loadBa
L_nl10:
    s_cmp_lg_u32 s63, 1
    s_cbranch_scc1 L_nl11
    s_call_b64 s[66:67], L_loadBb
L_nl11:
    buffer_load_dwordx2 v[26:27], v217, s[48:51], s61 offen sc1
    s_waitcnt vmcnt(16)
    s_waitcnt lgkmcnt(9)
    v_mfma_f32_16x16x32_bf16 a[144:147], v[224:227], v[104:107], a[144:147]
    v_add_u32 v18, 73728, v10
    v_add_u32 v19, 73728, v11
    v_mfma_f32_16x16x32_bf16 a[148:151], v[224:227], v[128:131], a[148:151]
    ds_read_b64_tr_b16 v[248:249], v16 offset:4096
    v_add_u32 v20, 73728, v12
    v_mfma_f32_16x16x32_bf16 a[152:155], v[224:227], v[152:155], a[152:155]
    ds_read_b64_tr_b16 v[250:251], v16 offset:6144
    v_add_u32 v21, 73728, v13
    v_mfma_f32_16x16x32_bf16 a[156:159], v[228:231], v[104:107], a[156:159]
    v_mfma_f32_16x16x32_bf16 a[160:163], v[228:231], v[128:131], a[160:163]
    ds_read_b64_tr_b16 v[252:253], v17 offset:4096
    v_mfma_f32_16x16x32_bf16 a[164:167], v[228:231], v[152:155], a[164:167]
    ds_read_b64_tr_b16 v[254:255], v17 offset:6144
    s_waitcnt lgkmcnt(9)
    v_mfma_f32_16x16x32_bf16 a[168:171], v[232:235], v[104:107], a[168:171]
    v_mfma_f32_16x16x32_bf16 a[172:175], v[232:235], v[128:131], a[172:175]
    ds_read_b64_tr_b16 v[224:225], v14 offset:8192
    v_mfma_f32_16x16x32_bf16 a[176:179], v[232:235], v[152:155], a[176:179]
    ds_read_b64_tr_b16 v[226:227], v14 offset:10240
    v_mfma_f32_16x16x32_bf16 a[180:183], v[236:239], v[104:107], a[180:183]
    v_mfma_f32_16x16x32_bf16 a[184:187], v[236:239], v[128:131], a[184:187]
    ds_read_b64_tr_b16 v[228:229], v15 offset:8192
    v_mfma_f32_16x16x32_bf16 a[188:191], v[236:239], v[152:155], a[188:191]
    ds_read_b64_tr_b16 v[230:231], v15 offset:10240
    s_waitcnt vmcnt(13)
    s_waitcnt lgkmcnt(8)
    v_mfma_f32_16x16x32_bf16 a[144:147], v[240:243], v[108:111], a[144:147]
    v_mfma_f32_16x16x32_bf16 a[148:151], v[240:243], v[132:135], a[148:151]
    ds_read_b64_tr_b16 v[232:233], v16 offset:8192
    v_mfma_f32_16x16x32_bf16 a[152:155], v[240:243], v[156:159], a[152:155]
    ds_read_b64_tr_b16 v[234:235], v16 offset:10240
    v_mfma_f32_16x16x32_bf16 a[156:159], v[244:247], v[108:111], a[156:159]
    v_mfma_f32_16x16x32_bf16 a[160:163], v[244:247], v[132:135], a[160:163]
    ds_read_b64_tr_b16 v[236:237], v17 offset:8192
    v_mfma_f32_16x16x32_bf16 a[164:167], v[244:247], v[156:159], a[164:167]
    ds_read_b64_tr_b16 v[238:239], v17 offset:10240
    s_waitcnt lgkmcnt(8)
    v_mfma_f32_16x16x32_bf16 a[168:171], v[248:251], v[108:111], a[168:171]
    v_mfma_f32_16x16x32_bf16 a[172:175], v[248:251], v[132:135], a[172:175]
    ds_read_b64_tr_b16 v[240:241], v18 offset:0
    v_mfma_f32_16x16x32_bf16 a[176:179], v[248:251], v[156:159], a[176:179]
    ds_read_b64_tr_b16 v[242:243], v18 offset:2048
    v_mfma_f32_16x16x32_bf16 a[180:183], v[252:255], v[108:111], a[180:183]
    v_mfma_f32_16x16x32_bf16 a[184:187], v[252:255], v[132:135], a[184:187]
    ds_read_b64_tr_b16 v[244:245], v19 offset:0
    v_mfma_f32_16x16x32_bf16 a[188:191], v[252:255], v[156:159], a[188:191]
    ds_read_b64_tr_b16 v[246:247], v19 offset:2048
    s_waitcnt vmcnt(10)
    s_waitcnt lgkmcnt(8)
    v_mfma_f32_16x16x32_bf16 a[144:147], v[224:227], v[112:115], a[144:147]
    v_mfma_f32_16x16x32_bf16 a[148:151], v[224:227], v[136:139], a[148:151]
    ds_read_b64_tr_b16 v[248:249], v20 offset:0
    v_mfma_f32_16x16x32_bf16 a[152:155], v[224:227], v[160:163], a[152:155]
    ds_read_b64_tr_b16 v[250:251], v20 offset:2048
    v_mfma_f32_16x16x32_bf16 a[156:159], v[228:231], v[112:115], a[156:159]
    v_mfma_f32_16x16x32_bf16 a[160:163], v[228:231], v[136:139], a[160:163]
    ds_read_b64_tr_b16 v[252:253], v21 offset:0
    v_mfma_f32_16x16x32_bf16 a[164:167], v[228:231], v[160:163], a[164:167]
    ds_read_b64_tr_b16 v[254:255], v21 offset:2048
    s_waitcnt lgkmcnt(8)
    v_mfma_f32_16x16x32_bf16 a[168:171], v[232:235], v[112:115], a[168:171]
    v_mfma_f32_16x16x32_bf16 a[172:175], v[232:235], v[136:139], a[172:175]
    ds_read_b64_tr_b16 v[224:225], v18 offset:4096
    v_mfma_f32_16x16x32_bf16 a[176:179], v[232:235], v[160:163], a[176:179]
    ds_read_b64_tr_b16 v[226:227], v18 offset:6144
    v_mfma_f32_16x16x32_bf16 a[180:183], v[236:239], v[112:115], a[180:183]
    v_mfma_f32_16x16x32_bf16 a[184:187], v[236:239], v[136:139], a[184:187]
    ds_read_b64_tr_b16 v[228:229], v19 offset:4096
    v_mfma_f32_16x16x32_bf16 a[188:191], v[236:239], v[160:163], a[188:191]
    ds_read_b64_tr_b16 v[230:231], v19 offset:6144
    s_mov_b32 s62, 0
L_sp7:
    s_waitcnt vmcnt(0)
    v_cmp_eq_u32 vcc, s68, v26
    s_nop 1
    v_cmp_eq_u32 s[64:65], s69, v27
    s_and_b64 vcc, vcc, s[64:65]
    s_cmp_eq_u64 vcc, -1
    s_cbranch_scc1 L_do7
    s_nop 1
    buffer_load_dwordx2 v[26:27], v217, s[48:51], s61 offen sc1
    s_add_u32 s62, s62, 1
    s_cmp_lt_u32 s62, 200000
    s_cbranch_scc1 L_sp7
    s_waitcnt vmcnt(0)
L_do7:
    s_waitcnt lgkmcnt(8)
    v_mfma_f32_16x16x32_bf16 a[144:147], v[240:243], v[116:119], a[144:147]
    v_add_u32 v14, 86016, v10
    v_add_u32 v15, 86016, v11
    v_mfma_f32_16x16x32_bf16 a[148:151], v[240:243], v[140:143], a[148:151]
    ds_read_b64_tr_b16 v[232:233], v20 offset:4096
    v_add_u32 v16, 86016, v12
    v_mfma_f32_16x16x32_bf16 a[152:155], v[240:243], v[164:167], a[152:155]
    ds_read_b64_tr_b16 v[234:235], v20 offset:6144
    v_add_u32 v17, 86016, v13
    v_mfma_f32_16x16x32_bf16 a[156:159], v[244:247], v[116:119], a[156:159]
    s_add_u32 s64, s33, s36
    buffer_load_dwordx4 v[32:35], v9, s[48:51], s64 offen offset:0 sc1
    v_mfma_f32_16x16x32_bf16 a[160:163], v[244:247], v[140:143], a[160:163]
    ds_read_b64_tr_b16 v[236:237], v21 offset:4096
    v_mfma_f32_16x16x32_bf16 a[164:167], v[244:247], v[164:167], a[164:167]
    ds_read_b64_tr_b16 v[238:239], v21 offset:6144
    s_waitcnt lgkmcnt(8)
    v_mfma_f32_16x16x32_bf16 a[168:171], v[248:251], v[116:119], a[168:171]
    s_add_u32 s64, s33, s37
    buffer_load_dwordx4 v[56:59], v9, s[48:51], s64 offen offset:0 sc1
    v_mfma_f32_16x16x32_bf16 a[172:175], v[248:251], v[140:143], a[172:175]
    ds_read_b64_tr_b16 v[240:241], v18 offset:8192
    v_mfma_f32_16x16x32_bf16 a[176:179], v[248:251], v[164:167], a[176:179]
    ds_read_b64_tr_b16 v[242:243], v18 offset:10240
    v_mfma_f32_16x16x32_bf16 a[180:183], v[252:255], v[116:119], a[180:183]
    v_mfma_f32_16x16x32_bf16 a[184:187], v[252:255], v[140:143], a[184:187]
    ds_read_b64_tr_b16 v[244:245], v19 offset:8192
    v_mfma_f32_16x16x32_bf16 a[188:191], v[252:255], v[164:167], a[188:191]
    ds_read_b64_tr_b16 v[246:247], v19 offset:10240
    s_waitcnt lgkmcnt(8)
    v_mfma_f32_16x16x32_bf16 a[144:147], v[224:227], v[120:123], a[144:147]
    s_add_u32 s64, s33, s38
    buffer_load_dwordx4 v[80:83], v9, s[48:51], s64 offen offset:0 sc1
    v_mfma_f32_16x16x32_bf16 a[148:151], v[224:227], v[144:147], a[148:151]
    ds_read_b64_tr_b16 v[248:249], v20 offset:8192
    v_mfma_f32_16x16x32_bf16 a[152:155], v[224:227], v[168:171], a[152:155]
    ds_read_b64_tr_b16 v[250:251], v20 offset:10240
    v_mfma_f32_16x16x32_bf16 a[156:159], v[228:231], v[120:123], a[156:159]
    s_add_u32 s64, s33, s36
    buffer_load_dwordx4 v[36:39], v9, s[48:51], s64 offen offset:1024 sc1
    v_mfma_f32_16x16x32_bf16 a[160:163], v[228:231], v[144:147], a[160:163]
    ds_read_b64_tr_b16 v[252:253], v21 offset:8192
    v_mfma_f32_16x16x32_bf16 a[164:167], v[228:231], v[168:171], a[164:167]
    ds_read_b64_tr_b16 v[254:255], v21 offset:10240
    s_waitcnt lgkmcnt(8)
    v_mfma_f32_16x16x32_bf16 a[168:171], v[232:235], v[120:123], a[168:171]
    s_cmp_ge_u32 s28, 62
    s_cbranch_scc0 L_sl14
L_bk14:
    v_mfma_f32_16x16x32_bf16 a[172:175], v[232:235], v[144:147], a[172:175]
    ds_read_b64_tr_b16 v[224:225], v14 offset:0
    v_mfma_f32_16x16x32_bf16 a[176:179], v[232:235], v[168:171], a[176:179]
    ds_read_b64_tr_b16 v[226:227], v14 offset:2048
    v_mfma_f32_16x16x32_bf16 a[180:183], v[236:239], v[120:123], a[180:183]
    s_add_u32 s64, s33, s37
    buffer_load_dwordx4 v[60:63], v9, s[48:51], s64 offen offset:1024 sc1
    v_mfma_f32_16x16x32_bf16 a[184:187], v[236:239], v[144:147], a[184:187]
    ds_read_b64_tr_b16 v[228:229], v15 offset:0
    v_mfma_f32_16x16x32_bf16 a[188:191], v[236:239], v[168:171], a[188:191]
    ds_read_b64_tr_b16 v[230:231], v15 offset:2048
    s_waitcnt lgkmcnt(8)
    v_mfma_f32_16x16x32_bf16 a[144:147], v[240:243], v[124:127], a[144:147]
    s_add_u32 s64, s33, s38
    buffer_load_dwordx4 v[84:87], v9, s[48:51], s64 offen offset:1024 sc1
    v_mfma_f32_16x16x32_bf16 a[148:151], v[240:243], v[148:151], a[148:151]
    ds_read_b64_tr_b16 v[232:233], v16 offset:0
    v_mfma_f32_16x16x32_bf16 a[152:155], v[240:243], v[172:175], a[152:155]
    ds_read_b64_tr_b16 v[234:235], v16 offset:2048
    v_mfma_f32_16x16x32_bf16 a[156:159], v[244:247], v[124:127], a[156:159]
    v_mfma_f32_16x16x32_bf16 a[160:163], v[244:247], v[148:151], a[160:163]
    ds_read_b64_tr_b16 v[236:237], v17 offset:0
    v_mfma_f32_16x16x32_bf16 a[164:167], v[244:247], v[172:175], a[164:167]
    ds_read_b64_tr_b16 v[238:239], v17 offset:2048
    s_waitcnt lgkmcnt(8)
    v_mfma_f32_16x16x32_bf16 a[168:171], v[248:251], v[124:127], a[168:171]
    s_add_u32 s64, s33, s36
    buffer_load_dwordx4 v[40:43], v9, s[48:51], s64 offen offset:2048 sc1
    v_mfma_f32_16x16x32_bf16 a[172:175], v[248:251], v[148:151], a[172:175]
    ds_read_b64_tr_b16 v[240:241], v14 offset:4096
    v_mfma_f32_16x16x32_bf16 a[176:179], v[248:251], v[172:175], a[176:179]
    ds_read_b64_tr_b16 v[242:243], v14 offset:6144
    v_mfma_f32_16x16x32_bf16 a[180:183], v[252:255], v[124:127], a[180:183]
    v_add_u32 v221, 2, v221
    ds_write_b32 v220, v221
    v_mfma_f32_16x16x32_bf16 a[184:187], v[252:255], v[148:151], a[184:187]
    ds_read_b64_tr_b16 v[244:245], v15 offset:4096
    v_mfma_f32_16x16x32_bf16 a[188:191], v[252:255], v[172:175], a[188:191]
    ds_read_b64_tr_b16 v[246:247], v15 offset:6144
    s_waitcnt lgkmcnt(9)
    v_mfma_f32_16x16x32_bf16 a[192:195], v[224:227], v[104:107], a[192:195]
    v_add_u32 v18, 98304, v10
    v_add_u32 v19, 98304, v11
    s_add_u32 s64, s33, s37
    buffer_load_dwordx4 v[64:67], v9, s[48:51], s64 offen offset:2048 sc1
    v_mfma_f32_16x16x32_bf16 a[196:199], v[224:227], v[128:131], a[196:199]
    ds_read_b64_tr_b16 v[248:249], v16 offset:4096
    v_add_u32 v20, 98304, v12
    v_mfma_f32_16x16x32_bf16 a[200:203], v[224:227], v[152:155], a[200:203]
    ds_read_b64_tr_b16 v[250:251], v16 offset:6144
    v_add_u32 v21, 98304, v13
    v_mfma_f32_16x16x32_bf16 a[204:207], v[228:231], v[104:107], a[204:207]
    s_add_u32 s64, s33, s38
    buffer_load_dwordx4 v[88:91], v9, s[48:51], s64 offen offset:2048 sc1
    v_accvgpr_read_b32 v176, a144
    v_accvgpr_read_b32 v177, a145
    v_mfma_f32_16x16x32_bf16 a[208:211], v[228:231], v[128:131], a[208:211]
    ds_read_b64_tr_b16 v[252:253], v17 offset:4096
    v_accvgpr_read_b32 v178, a146
    v_accvgpr_read_b32 v179, a147
    v_accvgpr_read_b32 v180, a156
    v_mfma_f32_16x16x32_bf16 a[212:215], v[228:231], v[152:155], a[212:215]
    ds_read_b64_tr_b16 v[254:255], v17 offset:6144
    v_accvgpr_read_b32 v181, a157
    v_accvgpr_read_b32 v182, a158
    s_waitcnt lgkmcnt(9)
    v_mfma_f32_16x16x32_bf16 a[216:219], v[232:235], v[104:107], a[216:219]
    v_accvgpr_read_b32 v183, a159
    v_cvt_pk_bf16_f32 v184, v176, v177
    v_mfma_f32_16x16x32_bf16 a[220:223], v[232:235], v[128:131], a[220:223]
    ds_read_b64_tr_b16 v[224:225], v14 offset:8192
    v_cvt_pk_bf16_f32 v185, v178, v179
    v_mfma_f32_16x16x32_bf16 a[224:227], v[232:235], v[152:155], a[224:227]
    ds_read_b64_tr_b16 v[226:227], v14 offset:10240
    v_cvt_pk_bf16_f32 v186, v180, v181
    v_mfma_f32_16x16x32_bf16 a[228:231], v[236:239], v[104:107], a[228:231]
    s_add_u32 s64, s33, s36
    buffer_load_dwordx4 v[44:47], v9, s[48:51], s64 offen offset:3072 sc1
    v_cvt_pk_bf16_f32 v187, v182, v183
    v_mfma_f32_16x16x32_bf16 a[232:235], v[236:239], v[128:131], a[232:235]
    ds_read_b64_tr_b16 v[228:229], v15 offset:8192
    s_add_u32 s62, s45, 0
    buffer_store_dwordx4 v[184:187], v9, s[48:51], s62 offen offset:0 sc1
    v_mfma_f32_16x16x32_bf16 a[236:239], v[236:239], v[152:155], a[236:239]
    ds_read_b64_tr_b16 v[230:231], v15 offset:10240
    s_waitcnt lgkmcnt(8)
    v_mfma_f32_16x16x32_bf16 a[192:195], v[240:243], v[108:111], a[192:195]
    s_add_u32 s64, s33, s37
    buffer_load_dwordx4 v[68:71], v9, s[48:51], s64 offen offset:3072 sc1
    v_accvgpr_read_b32 v188, a168
    v_accvgpr_read_b32 v189, a169
    v_mfma_f32_16x16x32_bf16 a[196:199], v[240:243], v[132:135], a[196:199]
    ds_read_b64_tr_b16 v[232:233], v16 offset:8192
    v_accvgpr_read_b32 v190, a170
    v_mfma_f32_16x16x32_bf16 a[200:203], v[240:243], v[156:159], a[200:203]
    ds_read_b64_tr_b16 v[234:235], v16 offset:10240
    v_accvgpr_read_b32 v191, a171
    v_mfma_f32_16x16x32_bf16 a[204:207], v[244:247], v[108:111], a[204:207]
    v_accvgpr_read_b32 v192, a180
    v_accvgpr_read_b32 v193, a181
    v_mfma_f32_16x16x32_bf16 a[208:211], v[244:247], v[132:135], a[208:211]
    ds_read_b64_tr_b16 v[236:237], v17 offset:8192
    v_accvgpr_read_b32 v194, a182
    v_mfma_f32_16x16x32_bf16 a[212:215], v[244:247], v[156:159], a[212:215]
    ds_read_b64_tr_b16 v[238:239], v17 offset:10240
    s_waitcnt lgkmcnt(8)
    v_mfma_f32_16x16x32_bf16 a[216:219], v[248:251], v[108:111], a[216:219]
    s_add_u32 s64, s33, s38
    buffer_load_dwordx4 v[92:95], v9, s[48:51], s64 offen offset:3072 sc1
    v_accvgpr_read_b32 v195, a183
    v_cvt_pk_bf16_f32 v196, v188, v189
    v_mfma_f32_16x16x32_bf16 a[220:223], v[248:251], v[132:135], a[220:223]
    ds_read_b64_tr_b16 v[240:241], v18 offset:0
    v_cvt_pk_bf16_f32 v197, v190, v191
    v_mfma_f32_16x16x32_bf16 a[224:227], v[248:251], v[156:159], a[224:227]
    ds_read_b64_tr_b16 v[242:243], v18 offset:2048
    v_cvt_pk_bf16_f32 v198, v192, v193
    v_mfma_f32_16x16x32_bf16 a[228:231], v[252:255], v[108:111], a[228:231]
    s_add_u32 s64, s33, s36
    buffer_load_dwordx4 v[48:51], v218, s[48:51], s64 offen offset:0 sc1
    v_cvt_pk_bf16_f32 v199, v194, v195
    v_mfma_f32_16x16x32_bf16 a[232:235], v[252:255], v[132:135], a[232:235]
    ds_read_b64_tr_b16 v[244:245], v19 offset:0
    buffer_store_dwordx4 v[196:199], v9, s[48:51], s62 offen offset:1024 sc1
    v_accvgpr_read_b32 v200, a148
    v_mfma_f32_16x16x32_bf16 a[236:239], v[252:255], v[156:159], a[236:239]
    ds_read_b64_tr_b16 v[246:247], v19 offset:2048
    s_waitcnt lgkmcnt(8)
    v_mfma_f32_16x16x32_bf16 a[192:195], v[224:227], v[112:115], a[192:195]
    v_accvgpr_read_b32 v201, a149
    v_accvgpr_read_b32 v202, a150
    v_mfma_f32_16x16x32_bf16 a[196:199], v[224:227], v[136:139], a[196:199]
    ds_read_b64_tr_b16 v[248:249], v20 offset:0
    v_accvgpr_read_b32 v203, a151
    v_mfma_f32_16x16x32_bf16 a[200:203], v[224:227], v[160:163], a[200:203]
    ds_read_b64_tr_b16 v[250:251], v20 offset:2048
    v_accvgpr_read_b32 v204, a160
    v_mfma_f32_16x16x32_bf16 a[204:207], v[228:231], v[112:115], a[204:207]
    s_add_u32 s64, s33, s37
    buffer_load_dwordx4 v[72:75], v218, s[48:51], s64 offen offset:0 sc1
    v_accvgpr_read_b32 v205, a161
    v_accvgpr_read_b32 v206, a162
    v_mfma_f32_16x16x32_bf16 a[208:211], v[228:231], v[136:139], a[208:211]
    ds_read_b64_tr_b16 v[252:253], v21 offset:0
    v_accvgpr_read_b32 v207, a163
    v_cvt_pk_bf16_f32 v208, v200, v201
    v_mfma_f32_16x16x32_bf16 a[212:215], v[228:231], v[160:163], a[212:215]
    ds_read_b64_tr_b16 v[254:255], v21 offset:2048
    s_waitcnt lgkmcnt(8)
    v_mfma_f32_16x16x32_bf16 a[216:219], v[232:235], v[112:115], a[216:219]
    v_cvt_pk_bf16_f32 v209, v202, v203
    v_mfma_f32_16x16x32_bf16 a[220:223], v[232:235], v[136:139], a[220:223]
    ds_read_b64_tr_b16 v[224:225], v18 offset:4096
    v_cvt_pk_bf16_f32 v210, v204, v205
    v_mfma_f32_16x16x32_bf16 a[224:227], v[232:235], v[160:163], a[224:227]
    ds_read_b64_tr_b16 v[226:227], v18 offset:6144
    v_cvt_pk_bf16_f32 v211, v206, v207
    v_mfma_f32_16x16x32_bf16 a[228:231], v[236:239], v[112:115], a[228:231]
    s_add_u32 s64, s33, s38
    buffer_load_dwordx4 v[96:99], v218, s[48:51], s64 offen offset:0 sc1
    s_add_u32 s62, s46, 0
    buffer_store_dwordx4 v[208:211], v9, s[48:51], s62 offen offset:0 sc1
    v_mfma_f32_16x16x32_bf16 a[232:235], v[236:239], v[136:139], a[232:235]
    ds_read_b64_tr_b16 v[228:229], v19 offset:4096
    v_accvgpr_read_b32 v176, a172
    v_mfma_f32_16x16x32_bf16 a[236:239], v[236:239], v[160:163], a[236:239]
    ds_read_b64_tr_b16 v[230:231], v19 offset:6144
    s_waitcnt lgkmcnt(8)
    v_mfma_f32_16x16x32_bf16 a[192:195], v[240:243], v[116:119], a[192:195]
    v_add_u32 v14, 110592, v10
    v_add_u32 v15, 110592, v11
    v_accvgpr_read_b32 v177, a173
    v_accvgpr_read_b32 v178, a174
    v_mfma_f32_16x16x32_bf16 a[196:199], v[240:243], v[140:143], a[196:199]
    ds_read_b64_tr_b16 v[232:233], v20 offset:4096
    v_add_u32 v16, 110592, v12
    s_add_u32 s64, s33, s36
    buffer_load_dwordx4 v[52:55], v218, s[48:51], s64 offen offset:1024 sc1
    v_mfma_f32_16x16x32_bf16 a[200:203], v[240:243], v[164:167], a[200:203]
    ds_read_b64_tr_b16 v[234:235], v20 offset:6144
    v_add_u32 v17, 110592, v13
    v_accvgpr_read_b32 v179, a175
    v_accvgpr_read_b32 v180, a184
    v_mfma_f32_16x16x32_bf16 a[204:207], v[244:247], v[116:119], a[204:207]
    v_accvgpr_read_b32 v181, a185
    v_accvgpr_read_b32 v182, a186
    v_accvgpr_read_b32 v183, a187
    v_mfma_f32_16x16x32_bf16 a[208:211], v[244:247], v[140:143], a[208:211]
    ds_read_b64_tr_b16 v[236:237], v21 offset:4096
    v_cvt_pk_bf16_f32 v184, v176, v177
    v_mfma_f32_16x16x32_bf16 a[212:215], v[244:247], v[164:167], a[212:215]
    ds_read_b64_tr_b16 v[238:239], v21 offset:6144
    s_waitcnt lgkmcnt(8)
    v_mfma_f32_16x16x32_bf16 a[216:219], v[248:251], v[116:119], a[216:219]
    s_add_u32 s64, s33, s37
    buffer_load_dwordx4 v[76:79], v218, s[48:51], s64 offen offset:1024 sc1
    v_cvt_pk_bf16_f32 v185, v178, v179
    v_mfma_f32_16x16x32_bf16 a[220:223], v[248:251], v[140:143], a[220:223]
    ds_read_b64_tr_b16 v[240:241], v18 offset:8192
    v_cvt_pk_bf16_f32 v186, v180, v181
    v_mfma_f32_16x16x32_bf16 a[224:227], v[248:251], v[164:167], a[224:227]
    ds_read_b64_tr_b16 v[242:243], v18 offset:10240
    v_cvt_pk_bf16_f32 v187, v182, v183
    v_mfma_f32_16x16x32_bf16 a[228:231], v[252:255], v[116:119], a[228:231]
    s_add_u32 s64, s33, s38
    buffer_load_dwordx4 v[100:103], v218, s[48:51], s64 offen offset:1024 sc1
    buffer_store_dwordx4 v[184:187], v9, s[48:51], s62 offen offset:1024 sc1
    v_accvgpr_read_b32 v188, a152
    v_mfma_f32_16x16x32_bf16 a[232:235], v[252:255], v[140:143], a[232:235]
    ds_read_b64_tr_b16 v[244:245], v19 offset:8192
    v_accvgpr_read_b32 v189, a153
    v_mfma_f32_16x16x32_bf16 a[236:239], v[252:255], v[164:167], a[236:239]
    ds_read_b64_tr_b16 v[246:247], v19 offset:10240
    v_accvgpr_read_b32 v190, a154
    s_waitcnt lgkmcnt(8)
    v_mfma_f32_16x16x32_bf16 a[192:195], v[224:227], v[120:123], a[192:195]
    v_accvgpr_read_b32 v191, a155
    v_accvgpr_read_b32 v192, a164
    v_mfma_f32_16x16x32_bf16 a[196:199], v[224:227], v[144:147], a[196:199]
    ds_read_b64_tr_b16 v[248:249], v20 offset:8192
    v_accvgpr_read_b32 v193, a165
    v_mfma_f32_16x16x32_bf16 a[200:203], v[224:227], v[168:171], a[200:203]
    ds_read_b64_tr_b16 v[250:251], v20 offset:10240
    v_accvgpr_read_b32 v194, a166
    v_mfma_f32_16x16x32_bf16 a[204:207], v[228:231], v[120:123], a[204:207]
    s_add_u32 s64, s34, s36
    buffer_load_dwordx4 a[48:51], v9, s[48:51], s64 offen offset:0 sc1
    v_accvgpr_read_b32 v195, a167
    v_cvt_pk_bf16_f32 v196, v188, v189
    v_mfma_f32_16x16x32_bf16 a[208:211], v[228:231], v[144:147], a[208:211]
    ds_read_b64_tr_b16 v[252:253], v21 offset:8192
    v_cvt_pk_bf16_f32 v197, v190, v191
    v_mfma_f32_16x16x32_bf16 a[212:215], v[228:231], v[168:171], a[212:215]
    ds_read_b64_tr_b16 v[254:255], v21 offset:10240
    s_waitcnt lgkmcnt(8)
    v_mfma_f32_16x16x32_bf16 a[216:219], v[232:235], v[120:123], a[216:219]
    s_cmp_ge_u32 s28, 64
    s_cbranch_scc0 L_sl15
L_bk15:
    v_mfma_f32_16x16x32_bf16 a[220:223], v[232:235], v[144:147], a[220:223]
    ds_read_b64_tr_b16 v[224:225], v14 offset:0
    v_cvt_pk_bf16_f32 v198, v192, v193
    v_mfma_f32_16x16x32_bf16 a[224:227], v[232:235], v[168:171], a[224:227]
    ds_read_b64_tr_b16 v[226:227], v14 offset:2048
    v_cvt_pk_bf16_f32 v199, v194, v195
    v_mfma_f32_16x16x32_bf16 a[228:231], v[236:239], v[120:123], a[228:231]
    s_add_u32 s64, s34, s37
    buffer_load_dwordx4 a[72:75], v9, s[48:51], s64 offen offset:0 sc1
    s_add_u32 s62, s47, 0
    buffer_store_dwordx4 v[196:199], v9, s[48:51], s62 offen offset:0 sc1
    v_mfma_f32_16x16x32_bf16 a[232:235], v[236:239], v[144:147], a[232:235]
    ds_read_b64_tr_b16 v[228:229], v15 offset:0
    v_accvgpr_read_b32 v200, a176
    v_mfma_f32_16x16x32_bf16 a[236:239], v[236:239], v[168:171], a[236:239]
    ds_read_b64_tr_b16 v[230:231], v15 offset:2048
    s_waitcnt lgkmcnt(8)
    v_mfma_f32_16x16x32_bf16 a[192:195], v[240:243], v[124:127], a[192:195]
    s_add_u32 s64, s34, s38
    buffer_load_dwordx4 a[96:99], v9, s[48:51], s64 offen offset:0 sc1
    v_accvgpr_read_b32 v201, a177
    v_accvgpr_read_b32 v202, a178
    v_mfma_f32_16x16x32_bf16 a[196:199], v[240:243], v[148:151], a[196:199]
    ds_read_b64_tr_b16 v[232:233], v16 offset:0
    v_accvgpr_read_b32 v203, a179
    v_mfma_f32_16x16x32_bf16 a[200:203], v[240:243], v[172:175], a[200:203]
    ds_read_b64_tr_b16 v[234:235], v16 offset:2048
    v_accvgpr_read_b32 v204, a188
    v_mfma_f32_16x16x32_bf16 a[204:207], v[244:247], v[124:127], a[204:207]
    v_accvgpr_read_b32 v205, a189
    v_accvgpr_read_b32 v206, a190
    v_accvgpr_read_b32 v207, a191
    v_mfma_f32_16x16x32_bf16 a[208:211], v[244:247], v[148:151], a[208:211]
    ds_read_b64_tr_b16 v[236:237], v17 offset:0
    v_cvt_pk_bf16_f32 v208, v200, v201
    v_mfma_f32_16x16x32_bf16 a[212:215], v[244:247], v[172:175], a[212:215]
    ds_read_b64_tr_b16 v[238:239], v17 offset:2048
    s_waitcnt lgkmcnt(8)
    v_mfma_f32_16x16x32_bf16 a[216:219], v[248:251], v[124:127], a[216:219]
    s_add_u32 s64, s34, s36
    buffer_load_dwordx4 a[52:55], v9, s[48:51], s64 offen offset:1024 sc1
    v_cvt_pk_bf16_f32 v209, v202, v203
    v_mfma_f32_16x16x32_bf16 a[220:223], v[248:251], v[148:151], a[220:223]
    ds_read_b64_tr_b16 v[240:241], v14 offset:4096
    v_cvt_pk_bf16_f32 v210, v204, v205
    v_mfma_f32_16x16x32_bf16 a[224:227], v[248:251], v[172:175], a[224:227]
    ds_read_b64_tr_b16 v[242:243], v14 offset:6144
    v_cvt_pk_bf16_f32 v211, v206, v207
    v_mfma_f32_16x16x32_bf16 a[228:231], v[252:255], v[124:127], a[228:231]
    v_add_u32 v221, 2, v221
    ds_write_b32 v220, v221
    s_add_u32 s64, s34, s37
    buffer_load_dwordx4 a[76:79], v9, s[48:51], s64 offen offset:1024 sc1
    v_mfma_f32_16x16x32_bf16 a[232:235], v[252:255], v[148:151], a[232:235]
    ds_read_b64_tr_b16 v[244:245], v15 offset:4096
    buffer_store_dwordx4 v[208:211], v9, s[48:51], s62 offen offset:1024 sc1
    v_mfma_f32_16x16x32_bf16 a[236:239], v[252:255], v[172:175], a[236:239]
    ds_read_b64_tr_b16 v[246:247], v15 offset:6144
    s_waitcnt lgkmcnt(9)
    v_mfma_f32_16x16x32_bf16 a[0:3], v[224:227], v[104:107], a[0:3]
    v_add_u32 v18, 122880, v10
    v_add_u32 v19, 122880, v11
    v_mfma_f32_16x16x32_bf16 a[4:7], v[224:227], v[128:131], a[4:7]
    ds_read_b64_tr_b16 v[248:249], v16 offset:4096
    v_add_u32 v20, 122880, v12
    v_mfma_f32_16x16x32_bf16 a[8:11], v[224:227], v[152:155], a[8:11]
    ds_read_b64_tr_b16 v[250:251], v16 offset:6144
    v_add_u32 v21, 122880, v13
    v_mfma_f32_16x16x32_bf16 a[12:15], v[228:231], v[104:107], a[12:15]
    s_add_u32 s64, s34, s38
    buffer_load_dwordx4 a[100:103], v9, s[48:51], s64 offen offset:1024 sc1
    v_mfma_f32_16x16x32_bf16 a[16:19], v[228:231], v[128:131], a[16:19]
    ds_read_b64_tr_b16 v[252:253], v17 offset:4096
    v_mfma_f32_16x16x32_bf16 a[20:23], v[228:231], v[152:155], a[20:23]
    ds_read_b64_tr_b16 v[254:255], v17 offset:6144
    s_waitcnt lgkmcnt(9)
    v_mfma_f32_16x16x32_bf16 a[24:27], v[232:235], v[104:107], a[24:27]
    s_add_u32 s64, s34, s36
    buffer_load_dwordx4 a[56:59], v9, s[48:51], s64 offen offset:2048 sc1
    v_mfma_f32_16x16x32_bf16 a[28:31], v[232:235], v[128:131], a[28:31]
    ds_read_b64_tr_b16 v[224:225], v14 offset:8192
    v_mfma_f32_16x16x32_bf16 a[32:35], v[232:235], v[152:155], a[32:35]
    ds_read_b64_tr_b16 v[226:227], v14 offset:10240
    v_mfma_f32_16x16x32_bf16 a[36:39], v[236:239], v[104:107], a[36:39]
    v_mfma_f32_16x16x32_bf16 a[40:43], v[236:239], v[128:131], a[40:43]
    ds_read_b64_tr_b16 v[228:229], v15 offset:8192
    v_mfma_f32_16x16x32_bf16 a[44:47], v[236:239], v[152:155], a[44:47]
    ds_read_b64_tr_b16 v[230:231], v15 offset:10240
    s_waitcnt lgkmcnt(8)
    v_mfma_f32_16x16x32_bf16 a[0:3], v[240:243], v[108:111], a[0:3]
    s_add_u32 s64, s34, s37
    buffer_load_dwordx4 a[80:83], v9, s[48:51], s64 offen offset:2048 sc1
    v_mfma_f32_16x16x32_bf16 a[4:7], v[240:243], v[132:135], a[4:7]
    ds_read_b64_tr_b16 v[232:233], v16 offset:8192
    v_mfma_f32_16x16x32_bf16 a[8:11], v[240:243], v[156:159], a[8:11]
    ds_read_b64_tr_b16 v[234:235], v16 offset:10240
    v_mfma_f32_16x16x32_bf16 a[12:15], v[244:247], v[108:111], a[12:15]
    s_add_u32 s64, s34, s38
    buffer_load_dwordx4 a[104:107], v9, s[48:51], s64 offen offset:2048 sc1
    v_mfma_f32_16x16x32_bf16 a[16:19], v[244:247], v[132:135], a[16:19]
    ds_read_b64_tr_b16 v[236:237], v17 offset:8192
    v_mfma_f32_16x16x32_bf16 a[20:23], v[244:247], v[156:159], a[20:23]
    ds_read_b64_tr_b16 v[238:239], v17 offset:10240
    s_waitcnt lgkmcnt(8)
    v_mfma_f32_16x16x32_bf16 a[24:27], v[248:251], v[108:111], a[24:27]
    v_mfma_f32_16x16x32_bf16 a[28:31], v[248:251], v[132:135], a[28:31]
    ds_read_b64_tr_b16 v[240:241], v18 offset:0
    v_mfma_f32_16x16x32_bf16 a[32:35], v[248:251], v[156:159], a[32:35]
    ds_read_b64_tr_b16 v[242:243], v18 offset:2048
    v_mfma_f32_16x16x32_bf16 a[36:39], v[252:255], v[108:111], a[36:39]
    s_add_u32 s64, s34, s36
    buffer_load_dwordx4 a[60:63], v9, s[48:51], s64 offen offset:3072 sc1
    v_mfma_f32_16x16x32_bf16 a[40:43], v[252:255], v[132:135], a[40:43]
    ds_read_b64_tr_b16 v[244:245], v19 offset:0
    v_mfma_f32_16x16x32_bf16 a[44:47], v[252:255], v[156:159], a[44:47]
    ds_read_b64_tr_b16 v[246:247], v19 offset:2048
    s_waitcnt lgkmcnt(8)
    v_mfma_f32_16x16x32_bf16 a[0:3], v[224:227], v[112:115], a[0:3]
    v_mfma_f32_16x16x32_bf16 a[4:7], v[224:227], v[136:139], a[4:7]
    ds_read_b64_tr_b16 v[248:249], v20 offset:0
    v_mfma_f32_16x16x32_bf16 a[8:11], v[224:227], v[160:163], a[8:11]
    ds_read_b64_tr_b16 v[250:251], v20 offset:2048
    v_mfma_f32_16x16x32_bf16 a[12:15], v[228:231], v[112:115], a[12:15]
    s_add_u32 s64, s34, s37
    buffer_load_dwordx4 a[84:87], v9, s[48:51], s64 offen offset:3072 sc1
    v_mfma_f32_16x16x32_bf16 a[16:19], v[228:231], v[136:139], a[16:19]
    ds_read_b64_tr_b16 v[252:253], v21 offset:0
    v_mfma_f32_16x16x32_bf16 a[20:23], v[228:231], v[160:163], a[20:23]
    ds_read_b64_tr_b16 v[254:255], v21 offset:2048
    s_waitcnt lgkmcnt(8)
    v_mfma_f32_16x16x32_bf16 a[24:27], v[232:235], v[112:115], a[24:27]
    s_add_u32 s64, s34, s38
    buffer_load_dwordx4 a[108:111], v9, s[48:51], s64 offen offset:3072 sc1
    v_mfma_f32_16x16x32_bf16 a[28:31], v[232:235], v[136:139], a[28:31]
    ds_read_b64_tr_b16 v[224:225], v18 offset:4096
    v_mfma_f32_16x16x32_bf16 a[32:35], v[232:235], v[160:163], a[32:35]
    ds_read_b64_tr_b16 v[226:227], v18 offset:6144
    v_mfma_f32_16x16x32_bf16 a[36:39], v[236:239], v[112:115], a[36:39]
    v_mfma_f32_16x16x32_bf16 a[40:43], v[236:239], v[136:139], a[40:43]
    ds_read_b64_tr_b16 v[228:229], v19 offset:4096
    v_mfma_f32_16x16x32_bf16 a[44:47], v[236:239], v[160:163], a[44:47]
    ds_read_b64_tr_b16 v[230:231], v19 offset:6144
    s_waitcnt lgkmcnt(8)
    v_mfma_f32_16x16x32_bf16 a[0:3], v[240:243], v[116:119], a[0:3]
    v_add_u32 v14, 135168, v10
    v_add_u32 v15, 135168, v11
    s_add_u32 s64, s34, s36
    buffer_load_dwordx4 a[64:67], v218, s[48:51], s64 offen offset:0 sc1
    v_mfma_f32_16x16x32_bf16 a[4:7], v[240:243], v[140:143], a[4:7]
    ds_read_b64_tr_b16 v[232:233], v20 offset:4096
    v_add_u32 v16, 135168, v12
    v_mfma_f32_16x16x32_bf16 a[8:11], v[240:243], v[164:167], a[8:11]
    ds_read_b64_tr_b16 v[234:235], v20 offset:6144
    v_add_u32 v17, 135168, v13
    v_mfma_f32_16x16x32_bf16 a[12:15], v[244:247], v[116:119], a[12:15]
    s_add_u32 s64, s34, s37
    buffer_load_dwordx4 a[88:91], v218, s[48:51], s64 offen offset:0 sc1
    v_mfma_f32_16x16x32_bf16 a[16:19], v[244:247], v[140:143], a[16:19]
    ds_read_b64_tr_b16 v[236:237], v21 offset:4096
    v_mfma_f32_16x16x32_bf16 a[20:23], v[244:247], v[164:167], a[20:23]
    ds_read_b64_tr_b16 v[238:239], v21 offset:6144
    s_waitcnt lgkmcnt(8)
    v_mfma_f32_16x16x32_bf16 a[24:27], v[248:251], v[116:119], a[24:27]
    v_mfma_f32_16x16x32_bf16 a[28:31], v[248:251], v[140:143], a[28:31]
    ds_read_b64_tr_b16 v[240:241], v18 offset:8192
    v_mfma_f32_16x16x32_bf16 a[32:35], v[248:251], v[164:167], a[32:35]
    ds_read_b64_tr_b16 v[242:243], v18 offset:10240
    v_mfma_f32_16x16x32_bf16 a[36:39], v[252:255], v[116:119], a[36:39]
    s_add_u32 s64, s34, s38
    buffer_load_dwordx4 a[112:115], v218, s[48:51], s64 offen offset:0 sc1
    v_mfma_f32_16x16x32_bf16 a[40:43], v[252:255], v[140:143], a[40:43]
    ds_read_b64_tr_b16 v[244:245], v19 offset:8192
    v_mfma_f32_16x16x32_bf16 a[44:47], v[252:255], v[164:167], a[44:47]
    ds_read_b64_tr_b16 v[246:247], v19 offset:10240
    s_waitcnt lgkmcnt(8)
    v_mfma_f32_16x16x32_bf16 a[0:3], v[224:227], v[120:123], a[0:3]
    s_add_u32 s64, s34, s36
    buffer_load_dwordx4 a[68:71], v218, s[48:51], s64 offen offset:1024 sc1
    v_mfma_f32_16x16x32_bf16 a[4:7], v[224:227], v[144:147], a[4:7]
    ds_read_b64_tr_b16 v[248:249], v20 offset:8192
    v_mfma_f32_16x16x32_bf16 a[8:11], v[224:227], v[168:171], a[8:11]
    ds_read_b64_tr_b16 v[250:251], v20 offset:10240
    v_mfma_f32_16x16x32_bf16 a[12:15], v[228:231], v[120:123], a[12:15]
    v_mfma_f32_16x16x32_bf16 a[16:19], v[228:231], v[144:147], a[16:19]
    ds_read_b64_tr_b16 v[252:253], v21 offset:8192
    s_waitcnt vmcnt(11)
    v_add_u32 v28, 1, v22
    buffer_store_dwordx2 v[28:29], v8, s[48:51], s55 offen sc1
    v_mfma_f32_16x16x32_bf16 a[20:23], v[228:231], v[168:171], a[20:23]
    ds_read_b64_tr_b16 v[254:255], v21 offset:10240
    s_waitcnt lgkmcnt(8)
    v_mfma_f32_16x16x32_bf16 a[24:27], v[232:235], v[120:123], a[24:27]
    s_cmp_ge_u32 s28, 66
    s_cbranch_scc0 L_sl16
L_bk16:
    v_mfma_f32_16x16x32_bf16 a[28:31], v[232:235], v[144:147], a[28:31]
    ds_read_b64_tr_b16 v[224:225], v14 offset:0
    s_add_u32 s64, s34, s37
    buffer_load_dwordx4 a[92:95], v218, s[48:51], s64 offen offset:1024 sc1
    v_mfma_f32_16x16x32_bf16 a[32:35], v[232:235], v[168:171], a[32:35]
    ds_read_b64_tr_b16 v[226:227], v14 offset:2048
    v_mfma_f32_16x16x32_bf16 a[36:39], v[236:239], v[120:123], a[36:39]
    v_mfma_f32_16x16x32_bf16 a[40:43], v[236:239], v[144:147], a[40:43]
    ds_read_b64_tr_b16 v[228:229], v15 offset:0
    v_mfma_f32_16x16x32_bf16 a[44:47], v[236:239], v[168:171], a[44:47]
    ds_read_b64_tr_b16 v[230:231], v15 offset:2048
    s_waitcnt lgkmcnt(8)
    v_mfma_f32_16x16x32_bf16 a[0:3], v[240:243], v[124:127], a[0:3]
    s_add_u32 s64, s34, s38
    buffer_load_dwordx4 a[116:119], v218, s[48:51], s64 offen offset:1024 sc1
    v_mfma_f32_16x16x32_bf16 a[4:7], v[240:243], v[148:151], a[4:7]
    ds_read_b64_tr_b16 v[232:233], v16 offset:0
    v_mfma_f32_16x16x32_bf16 a[8:11], v[240:243], v[172:175], a[8:11]
    ds_read_b64_tr_b16 v[234:235], v16 offset:2048
    v_mfma_f32_16x16x32_bf16 a[12:15], v[244:247], v[124:127], a[12:15]
    v_mfma_f32_16x16x32_bf16 a[16:19], v[244:247], v[148:151], a[16:19]
    ds_read_b64_tr_b16 v[236:237], v17 offset:0
    v_mfma_f32_16x16x32_bf16 a[20:23], v[244:247], v[172:175], a[20:23]
    ds_read_b64_tr_b16 v[238:239], v17 offset:2048
    s_waitcnt lgkmcnt(8)
    v_mfma_f32_16x16x32_bf16 a[24:27], v[248:251], v[124:127], a[24:27]
    v_mfma_f32_16x16x32_bf16 a[28:31], v[248:251], v[148:151], a[28:31]
    ds_read_b64_tr_b16 v[240:241], v14 offset:4096
    v_mfma_f32_16x16x32_bf16 a[32:35], v[248:251], v[172:175], a[32:35]
    ds_read_b64_tr_b16 v[242:243], v14 offset:6144
    v_mfma_f32_16x16x32_bf16 a[36:39], v[252:255], v[124:127], a[36:39]
    v_add_u32 v221, 2, v221
    ds_write_b32 v220, v221
    v_mfma_f32_16x16x32_bf16 a[40:43], v[252:255], v[148:151], a[40:43]
    ds_read_b64_tr_b16 v[244:245], v15 offset:4096
    v_mfma_f32_16x16x32_bf16 a[44:47], v[252:255], v[172:175], a[44:47]
    ds_read_b64_tr_b16 v[246:247], v15 offset:6144
    s_waitcnt vmcnt(40)
    s_waitcnt lgkmcnt(9)
    v_mfma_f32_16x16x32_bf16 a[192:195], v[224:227], v[32:35], a[192:195]
    v_add_u32 v18, 147456, v10
    v_add_u32 v19, 147456, v11
    v_mfma_f32_16x16x32_bf16 a[196:199], v[224:227], v[56:59], a[196:199]
    ds_read_b64_tr_b16 v[248:249], v16 offset:4096
    v_add_u32 v20, 147456, v12
    v_mfma_f32_16x16x32_bf16 a[200:203], v[224:227], v[80:83], a[200:203]
    ds_read_b64_tr_b16 v[250:251], v16 offset:6144
    v_add_u32 v21, 147456, v13
    v_mfma_f32_16x16x32_bf16 a[204:207], v[228:231], v[32:35], a[204:207]
    v_mfma_f32_16x16x32_bf16 a[208:211], v[228:231], v[56:59], a[208:211]
    ds_read_b64_tr_b16 v[252:253], v17 offset:4096
    v_mfma_f32_16x16x32_bf16 a[212:215], v[228:231], v[80:83], a[212:215]
    ds_read_b64_tr_b16 v[254:255], v17 offset:6144
    s_waitcnt lgkmcnt(9)
    v_mfma_f32_16x16x32_bf16 a[216:219], v[232:235], v[32:35], a[216:219]
    v_mfma_f32_16x16x32_bf16 a[220:223], v[232:235], v[56:59], a[220:223]
    ds_read_b64_tr_b16 v[224:225], v14 offset:8192
    v_mfma_f32_16x16x32_bf16 a[224:227], v[232:235], v[80:83], a[224:227]
    ds_read_b64_tr_b16 v[226:227], v14 offset:10240
    v_mfma_f32_16x16x32_bf16 a[228:231], v[236:239], v[32:35], a[228:231]
    v_mfma_f32_16x16x32_bf16 a[232:235], v[236:239], v[56:59], a[232:235]
    ds_read_b64_tr_b16 v[228:229], v15 offset:8192
    v_mfma_f32_16x16x32_bf16 a[236:239], v[236:239], v[80:83], a[236:239]
    ds_read_b64_tr_b16 v[230:231], v15 offset:10240
    s_waitcnt vmcnt(37)
    s_waitcnt lgkmcnt(8)
    v_mfma_f32_16x16x32_bf16 a[192:195], v[240:243], v[36:39], a[192:195]
    v_mfma_f32_16x16x32_bf16 a[196:199], v[240:243], v[60:63], a[196:199]
    ds_read_b64_tr_b16 v[232:233], v16 offset:8192
    v_mfma_f32_16x16x32_bf16 a[200:203], v[240:243], v[84:87], a[200:203]
    ds_read_b64_tr_b16 v[234:235], v16 offset:10240
    v_mfma_f32_16x16x32_bf16 a[204:207], v[244:247], v[36:39], a[204:207]
    v_mfma_f32_16x16x32_bf16 a[208:211], v[244:247], v[60:63], a[208:211]
    ds_read_b64_tr_b16 v[236:237], v17 offset:8192
    v_mfma_f32_16x16x32_bf16 a[212:215], v[244:247], v[84:87], a[212:215]
    ds_read_b64_tr_b16 v[238:239], v17 offset:10240
    s_waitcnt lgkmcnt(8)
    v_mfma_f32_16x16x32_bf16 a[216:219], v[248:251], v[36:39], a[216:219]
    v_mfma_f32_16x16x32_bf16 a[220:223], v[248:251], v[60:63], a[220:223]
    ds_read_b64_tr_b16 v[240:241], v18 offset:0
    v_mfma_f32_16x16x32_bf16 a[224:227], v[248:251], v[84:87], a[224:227]
    ds_read_b64_tr_b16 v[242:243], v18 offset:2048
    v_mfma_f32_16x16x32_bf16 a[228:231], v[252:255], v[36:39], a[228:231]
    v_mfma_f32_16x16x32_bf16 a[232:235], v[252:255], v[60:63], a[232:235]
    ds_read_b64_tr_b16 v[244:245], v19 offset:0
    v_mfma_f32_16x16x32_bf16 a[236:239], v[252:255], v[84:87], a[236:239]
    ds_read_b64_tr_b16 v[246:247], v19 offset:2048
    s_waitcnt vmcnt(34)
    s_waitcnt lgkmcnt(8)
    v_mfma_f32_16x16x32_bf16 a[192:195], v[224:227], v[40:43], a[192:195]
    v_mfma_f32_16x16x32_bf16 a[196:199], v[224:227], v[64:67], a[196:199]
    ds_read_b64_tr_b16 v[248:249], v20 offset:0
    v_mfma_f32_16x16x32_bf16 a[200:203], v[224:227], v[88:91], a[200:203]
    ds_read_b64_tr_b16 v[250:251], v20 offset:2048
    v_mfma_f32_16x16x32_bf16 a[204:207], v[228:231], v[40:43], a[204:207]
    v_mfma_f32_16x16x32_bf16 a[208:211], v[228:231], v[64:67], a[208:211]
    ds_read_b64_tr_b16 v[252:253], v21 offset:0
    v_mfma_f32_16x16x32_bf16 a[212:215], v[228:231], v[88:91], a[212:215]
    ds_read_b64_tr_b16 v[254:255], v21 offset:2048
    s_waitcnt lgkmcnt(8)
    v_mfma_f32_16x16x32_bf16 a[216:219], v[232:235], v[40:43], a[216:219]
    v_mfma_f32_16x16x32_bf16 a[220:223], v[232:235], v[64:67], a[220:223]
    ds_read_b64_tr_b16 v[224:225], v18 offset:4096
    v_mfma_f32_16x16x32_bf16 a[224:227], v[232:235], v[88:91], a[224:227]
    ds_read_b64_tr_b16 v[226:227], v18 offset:6144
    v_mfma_f32_16x16x32_bf16 a[228:231], v[236:239], v[40:43], a[228:231]
    v_mfma_f32_16x16x32_bf16 a[232:235], v[236:239], v[64:67], a[232:235]
    ds_read_b64_tr_b16 v[228:229], v19 offset:4096
    v_mfma_f32_16x16x32_bf16 a[236:239], v[236:239], v[88:91], a[236:239]
    ds_read_b64_tr_b16 v[230:231], v19 offset:6144
    s_waitcnt vmcnt(30)
    s_waitcnt lgkmcnt(8)
    v_mfma_f32_16x16x32_bf16 a[192:195], v[240:243], v[44:47], a[192:195]
    v_add_u32 v14, 0, v10
    v_add_u32 v15, 0, v11
    v_mfma_f32_16x16x32_bf16 a[196:199], v[240:243], v[68:71], a[196:199]
    ds_read_b64_tr_b16 v[232:233], v20 offset:4096
    v_add_u32 v16, 0, v12
    v_mfma_f32_16x16x32_bf16 a[200:203], v[240:243], v[92:95], a[200:203]
    ds_read_b64_tr_b16 v[234:235], v20 offset:6144
    v_add_u32 v17, 0, v13
    v_mfma_f32_16x16x32_bf16 a[204:207], v[244:247], v[44:47], a[204:207]
    v_mfma_f32_16x16x32_bf16 a[208:211], v[244:247], v[68:71], a[208:211]
    ds_read_b64_tr_b16 v[236:237], v21 offset:4096
    v_mfma_f32_16x16x32_bf16 a[212:215], v[244:247], v[92:95], a[212:215]
    ds_read_b64_tr_b16 v[238:239], v21 offset:6144
    s_waitcnt lgkmcnt(8)
    v_mfma_f32_16x16x32_bf16 a[216:219], v[248:251], v[44:47], a[216:219]
    v_mfma_f32_16x16x32_bf16 a[220:223], v[248:251], v[68:71], a[220:223]
    ds_read_b64_tr_b16 v[240:241], v18 offset:8192
    v_mfma_f32_16x16x32_bf16 a[224:227], v[248:251], v[92:95], a[224:227]
    ds_read_b64_tr_b16 v[242:243], v18 offset:10240
    v_mfma_f32_16x16x32_bf16 a[228:231], v[252:255], v[44:47], a[228:231]
    v_mfma_f32_16x16x32_bf16 a[232:235], v[252:255], v[68:71], a[232:235]
    ds_read_b64_tr_b16 v[244:245], v19 offset:8192
    v_mfma_f32_16x16x32_bf16 a[236:239], v[252:255], v[92:95], a[236:239]
    ds_read_b64_tr_b16 v[246:247], v19 offset:10240
    s_waitcnt vmcnt(26)
    s_waitcnt lgkmcnt(8)
    v_mfma_f32_16x16x32_bf16 a[192:195], v[224:227], v[48:51], a[192:195]
    v_mfma_f32_16x16x32_bf16 a[196:199], v[224:227], v[72:75], a[196:199]
    ds_read_b64_tr_b16 v[248:249], v20 offset:8192
    v_mfma_f32_16x16x32_bf16 a[200:203], v[224:227], v[96:99], a[200:203]
    ds_read_b64_tr_b16 v[250:251], v20 offset:10240
    v_mfma_f32_16x16x32_bf16 a[204:207], v[228:231], v[48:51], a[204:207]
    v_mfma_f32_16x16x32_bf16 a[208:211], v[228:231], v[72:75], a[208:211]
    ds_read_b64_tr_b16 v[252:253], v21 offset:8192
    v_mfma_f32_16x16x32_bf16 a[212:215], v[228:231], v[96:99], a[212:215]
    ds_read_b64_tr_b16 v[254:255], v21 offset:10240
    s_waitcnt lgkmcnt(8)
    v_mfma_f32_16x16x32_bf16 a[216:219], v[232:235], v[48:51], a[216:219]
    s_cmp_ge_u32 s28, 68
    s_cbranch_scc0 L_sl17
L_bk17:
    v_mfma_f32_16x16x32_bf16 a[220:223], v[232:235], v[72:75], a[220:223]
    ds_read_b64_tr_b16 v[224:225], v14 offset:0
    v_mfma_f32_16x16x32_bf16 a[224:227], v[232:235], v[96:99], a[224:227]
    ds_read_b64_tr_b16 v[226:227], v14 offset:2048
    v_mfma_f32_16x16x32_bf16 a[228:231], v[236:239], v[48:51], a[228:231]
    v_mfma_f32_16x16x32_bf16 a[232:235], v[236:239], v[72:75], a[232:235]
    ds_read_b64_tr_b16 v[228:229], v15 offset:0
    v_mfma_f32_16x16x32_bf16 a[236:239], v[236:239], v[96:99], a[236:239]
    ds_read_b64_tr_b16 v[230:231], v15 offset:2048
    s_waitcnt vmcnt(22)
    s_waitcnt lgkmcnt(8)
    v_mfma_f32_16x16x32_bf16 a[192:195], v[240:243], v[52:55], a[192:195]
    v_mfma_f32_16x16x32_bf16 a[196:199], v[240:243], v[76:79], a[196:199]
    ds_read_b64_tr_b16 v[232:233], v16 offset:0
    v_mfma_f32_16x16x32_bf16 a[200:203], v[240:243], v[100:103], a[200:203]
    ds_read_b64_tr_b16 v[234:235], v16 offset:2048
    v_mfma_f32_16x16x32_bf16 a[204:207], v[244:247], v[52:55], a[204:207]
    v_mfma_f32_16x16x32_bf16 a[208:211], v[244:247], v[76:79], a[208:211]
    ds_read_b64_tr_b16 v[236:237], v17 offset:0
    v_mfma_f32_16x16x32_bf16 a[212:215], v[244:247], v[100:103], a[212:215]
    ds_read_b64_tr_b16 v[238:239], v17 offset:2048
    s_waitcnt lgkmcnt(8)
    v_mfma_f32_16x16x32_bf16 a[216:219], v[248:251], v[52:55], a[216:219]
    v_mfma_f32_16x16x32_bf16 a[220:223], v[248:251], v[76:79], a[220:223]
    ds_read_b64_tr_b16 v[240:241], v14 offset:4096
    v_mfma_f32_16x16x32_bf16 a[224:227], v[248:251], v[100:103], a[224:227]
    ds_read_b64_tr_b16 v[242:243], v14 offset:6144
    v_mfma_f32_16x16x32_bf16 a[228:231], v[252:255], v[52:55], a[228:231]
    v_add_u32 v221, 2, v221
    ds_write_b32 v220, v221
    v_mfma_f32_16x16x32_bf16 a[232:235], v[252:255], v[76:79], a[232:235]
    ds_read_b64_tr_b16 v[244:245], v15 offset:4096
    v_mfma_f32_16x16x32_bf16 a[236:239], v[252:255], v[100:103], a[236:239]
    ds_read_b64_tr_b16 v[246:247], v15 offset:6144
    s_waitcnt vmcnt(17)
    s_waitcnt lgkmcnt(9)
    v_mfma_f32_16x16x32_bf16 a[192:195], v[224:227], a[48:51], a[192:195]
    v_add_u32 v18, 12288, v10
    v_add_u32 v19, 12288, v11
    v_mfma_f32_16x16x32_bf16 a[196:199], v[224:227], a[72:75], a[196:199]
    ds_read_b64_tr_b16 v[248:249], v16 offset:4096
    v_add_u32 v20, 12288, v12
    v_mfma_f32_16x16x32_bf16 a[200:203], v[224:227], a[96:99], a[200:203]
    ds_read_b64_tr_b16 v[250:251], v16 offset:6144
    v_add_u32 v21, 12288, v13
    v_mfma_f32_16x16x32_bf16 a[204:207], v[228:231], a[48:51], a[204:207]
    v_mfma_f32_16x16x32_bf16 a[208:211], v[228:231], a[72:75], a[208:211]
    ds_read_b64_tr_b16 v[252:253], v17 offset:4096
    v_mfma_f32_16x16x32_bf16 a[212:215], v[228:231], a[96:99], a[212:215]
    ds_read_b64_tr_b16 v[254:255], v17 offset:6144
    s_waitcnt lgkmcnt(9)
    v_mfma_f32_16x16x32_bf16 a[216:219], v[232:235], a[48:51], a[216:219]
    v_mfma_f32_16x16x32_bf16 a[220:223], v[232:235], a[72:75], a[220:223]
    ds_read_b64_tr_b16 v[224:225], v14 offset:8192
    v_mfma_f32_16x16x32_bf16 a[224:227], v[232:235], a[96:99], a[224:227]
    ds_read_b64_tr_b16 v[226:227], v14 offset:10240
    v_mfma_f32_16x16x32_bf16 a[228:231], v[236:239], a[48:51], a[228:231]
    v_mfma_f32_16x16x32_bf16 a[232:235], v[236:239], a[72:75], a[232:235]
    ds_read_b64_tr_b16 v[228:229], v15 offset:8192
    v_mfma_f32_16x16x32_bf16 a[236:239], v[236:239], a[96:99], a[236:239]
    ds_read_b64_tr_b16 v[230:231], v15 offset:10240
    s_waitcnt vmcnt(13)
    s_waitcnt lgkmcnt(8)
    v_mfma_f32_16x16x32_bf16 a[192:195], v[240:243], a[52:55], a[192:195]
    v_mfma_f32_16x16x32_bf16 a[196:199], v[240:243], a[76:79], a[196:199]
    ds_read_b64_tr_b16 v[232:233], v16 offset:8192
    v_mfma_f32_16x16x32_bf16 a[200:203], v[240:243], a[100:103], a[200:203]
    ds_read_b64_tr_b16 v[234:235], v16 offset:10240
    v_mfma_f32_16x16x32_bf16 a[204:207], v[244:247], a[52:55], a[204:207]
    v_mfma_f32_16x16x32_bf16 a[208:211], v[244:247], a[76:79], a[208:211]
    ds_read_b64_tr_b16 v[236:237], v17 offset:8192
    v_mfma_f32_16x16x32_bf16 a[212:215], v[244:247], a[100:103], a[212:215]
    ds_read_b64_tr_b16 v[238:239], v17 offset:10240
    s_waitcnt lgkmcnt(8)
    v_mfma_f32_16x16x32_bf16 a[216:219], v[248:251], a[52:55], a[216:219]
    v_mfma_f32_16x16x32_bf16 a[220:223], v[248:251], a[76:79], a[220:223]
    ds_read_b64_tr_b16 v[240:241], v18 offset:0
    v_mfma_f32_16x16x32_bf16 a[224:227], v[248:251], a[100:103], a[224:227]
    ds_read_b64_tr_b16 v[242:243], v18 offset:2048
    v_mfma_f32_16x16x32_bf16 a[228:231], v[252:255], a[52:55], a[228:231]
    v_mfma_f32_16x16x32_bf16 a[232:235], v[252:255], a[76:79], a[232:235]
    ds_read_b64_tr_b16 v[244:245], v19 offset:0
    v_mfma_f32_16x16x32_bf16 a[236:239], v[252:255], a[100:103], a[236:239]
    ds_read_b64_tr_b16 v[246:247], v19 offset:2048
    s_waitcnt vmcnt(10)
    s_waitcnt lgkmcnt(8)
    v_mfma_f32_16x16x32_bf16 a[192:195], v[224:227], a[56:59], a[192:195]
    v_mfma_f32_16x16x32_bf16 a[196:199], v[224:227], a[80:83], a[196:199]
    ds_read_b64_tr_b16 v[248:249], v20 offset:0
    v_mfma_f32_16x16x32_bf16 a[200:203], v[224:227], a[104:107], a[200:203]
    ds_read_b64_tr_b16 v[250:251], v20 offset:2048
    v_mfma_f32_16x16x32_bf16 a[204:207], v[228:231], a[56:59], a[204:207]
    v_mfma_f32_16x16x32_bf16 a[208:211], v[228:231], a[80:83], a[208:211]
    ds_read_b64_tr_b16 v[252:253], v21 offset:0
    v_mfma_f32_16x16x32_bf16 a[212:215], v[228:231], a[104:107], a[212:215]
    ds_read_b64_tr_b16 v[254:255], v21 offset:2048
    s_waitcnt lgkmcnt(8)
    v_mfma_f32_16x16x32_bf16 a[216:219], v[232:235], a[56:59], a[216:219]
    v_mfma_f32_16x16x32_bf16 a[220:223], v[232:235], a[80:83], a[220:223]
    ds_read_b64_tr_b16 v[224:225], v18 offset:4096
    v_mfma_f32_16x16x32_bf16 a[224:227], v[232:235], a[104:107], a[224:227]
    ds_read_b64_tr_b16 v[226:227], v18 offset:6144
    v_mfma_f32_16x16x32_bf16 a[228:231], v[236:239], a[56:59], a[228:231]
    v_mfma_f32_16x16x32_bf16 a[232:235], v[236:239], a[80:83], a[232:235]
    ds_read_b64_tr_b16 v[228:229], v19 offset:4096
    v_mfma_f32_16x16x32_bf16 a[236:239], v[236:239], a[104:107], a[236:239]
    ds_read_b64_tr_b16 v[230:231], v19 offset:6144
    s_waitcnt vmcnt(7)
    s_waitcnt lgkmcnt(8)
    v_mfma_f32_16x16x32_bf16 a[192:195], v[240:243], a[60:63], a[192:195]
    v_add_u32 v14, 24576, v10
    v_add_u32 v15, 24576, v11
    v_mfma_f32_16x16x32_bf16 a[196:199], v[240:243], a[84:87], a[196:199]
    ds_read_b64_tr_b16 v[232:233], v20 offset:4096
    v_add_u32 v16, 24576, v12
    v_mfma_f32_16x16x32_bf16 a[200:203], v[240:243], a[108:111], a[200:203]
    ds_read_b64_tr_b16 v[234:235], v20 offset:6144
    v_add_u32 v17, 24576, v13
    v_mfma_f32_16x16x32_bf16 a[204:207], v[244:247], a[60:63], a[204:207]
    v_mfma_f32_16x16x32_bf16 a[208:211], v[244:247], a[84:87], a[208:211]
    ds_read_b64_tr_b16 v[236:237], v21 offset:4096
    v_mfma_f32_16x16x32_bf16 a[212:215], v[244:247], a[108:111], a[212:215]
    ds_read_b64_tr_b16 v[238:239], v21 offset:6144
    s_waitcnt lgkmcnt(8)
    v_mfma_f32_16x16x32_bf16 a[216:219], v[248:251], a[60:63], a[216:219]
    v_mfma_f32_16x16x32_bf16 a[220:223], v[248:251], a[84:87], a[220:223]
    ds_read_b64_tr_b16 v[240:241], v18 offset:8192
    v_mfma_f32_16x16x32_bf16 a[224:227], v[248:251], a[108:111], a[224:227]
    ds_read_b64_tr_b16 v[242:243], v18 offset:10240
    v_mfma_f32_16x16x32_bf16 a[228:231], v[252:255], a[60:63], a[228:231]
    v_mfma_f32_16x16x32_bf16 a[232:235], v[252:255], a[84:87], a[232:235]
    ds_read_b64_tr_b16 v[244:245], v19 offset:8192
    v_mfma_f32_16x16x32_bf16 a[236:239], v[252:255], a[108:111], a[236:239]
    ds_read_b64_tr_b16 v[246:247], v19 offset:10240
    s_waitcnt vmcnt(4)
    s_waitcnt lgkmcnt(8)
    v_mfma_f32_16x16x32_bf16 a[192:195], v[224:227], a[64:67], a[192:195]
    v_mfma_f32_16x16x32_bf16 a[196:199], v[224:227], a[88:91], a[196:199]
    ds_read_b64_tr_b16 v[248:249], v20 offset:8192
    v_mfma_f32_16x16x32_bf16 a[200:203], v[224:227], a[112:115], a[200:203]
    ds_read_b64_tr_b16 v[250:251], v20 offset:10240
    v_mfma_f32_16x16x32_bf16 a[204:207], v[228:231], a[64:67], a[204:207]
    v_mfma_f32_16x16x32_bf16 a[208:211], v[228:231], a[88:91], a[208:211]
    ds_read_b64_tr_b16 v[252:253], v21 offset:8192
    v_mfma_f32_16x16x32_bf16 a[212:215], v[228:231], a[112:115], a[212:215]
    ds_read_b64_tr_b16 v[254:255], v21 offset:10240
    s_waitcnt lgkmcnt(8)
    v_mfma_f32_16x16x32_bf16 a[216:219], v[232:235], a[64:67], a[216:219]
    s_cmp_ge_u32 s28, 70
    s_cbranch_scc0 L_sl18
L_bk18:
    v_mfma_f32_16x16x32_bf16 a[220:223], v[232:235], a[88:91], a[220:223]
    ds_read_b64_tr_b16 v[224:225], v14 offset:0
    v_mfma_f32_16x16x32_bf16 a[224:227], v[232:235], a[112:115], a[224:227]
    ds_read_b64_tr_b16 v[226:227], v14 offset:2048
    v_mfma_f32_16x16x32_bf16 a[228:231], v[236:239], a[64:67], a[228:231]
    v_mfma_f32_16x16x32_bf16 a[232:235], v[236:239], a[88:91], a[232:235]
    ds_read_b64_tr_b16 v[228:229], v15 offset:0
    v_mfma_f32_16x16x32_bf16 a[236:239], v[236:239], a[112:115], a[236:239]
    ds_read_b64_tr_b16 v[230:231], v15 offset:2048
    s_waitcnt vmcnt(0)
    s_waitcnt lgkmcnt(8)
    v_mfma_f32_16x16x32_bf16 a[192:195], v[240:243], a[68:71], a[192:195]
    v_mfma_f32_16x16x32_bf16 a[196:199], v[240:243], a[92:95], a[196:199]
    ds_read_b64_tr_b16 v[232:233], v16 offset:0
    v_mfma_f32_16x16x32_bf16 a[200:203], v[240:243], a[116:119], a[200:203]
    ds_read_b64_tr_b16 v[234:235], v16 offset:2048
    v_mfma_f32_16x16x32_bf16 a[204:207], v[244:247], a[68:71], a[204:207]
    v_mfma_f32_16x16x32_bf16 a[208:211], v[244:247], a[92:95], a[208:211]
    ds_read_b64_tr_b16 v[236:237], v17 offset:0
    v_mfma_f32_16x16x32_bf16 a[212:215], v[244:247], a[116:119], a[212:215]
    ds_read_b64_tr_b16 v[238:239], v17 offset:2048
    s_waitcnt lgkmcnt(8)
    v_mfma_f32_16x16x32_bf16 a[216:219], v[248:251], a[68:71], a[216:219]
    v_mfma_f32_16x16x32_bf16 a[220:223], v[248:251], a[92:95], a[220:223]
    ds_read_b64_tr_b16 v[240:241], v14 offset:4096
    v_mfma_f32_16x16x32_bf16 a[224:227], v[248:251], a[116:119], a[224:227]
    ds_read_b64_tr_b16 v[242:243], v14 offset:6144
    v_mfma_f32_16x16x32_bf16 a[228:231], v[252:255], a[68:71], a[228:231]
    v_add_u32 v221, 2, v221
    ds_write_b32 v220, v221
    v_mfma_f32_16x16x32_bf16 a[232:235], v[252:255], a[92:95], a[232:235]
    ds_read_b64_tr_b16 v[244:245], v15 offset:4096
    v_mfma_f32_16x16x32_bf16 a[236:239], v[252:255], a[116:119], a[236:239]
    ds_read_b64_tr_b16 v[246:247], v15 offset:6144
    s_waitcnt lgkmcnt(9)
    v_mfma_f32_16x16x32_bf16 a[0:3], v[224:227], v[32:35], a[0:3]
    v_add_u32 v18, 36864, v10
    v_add_u32 v19, 36864, v11
    v_mfma_f32_16x16x32_bf16 a[4:7], v[224:227], v[56:59], a[4:7]
    ds_read_b64_tr_b16 v[248:249], v16 offset:4096
    v_add_u32 v20, 36864, v12
    v_mfma_f32_16x16x32_bf16 a[8:11], v[224:227], v[80:83], a[8:11]
    ds_read_b64_tr_b16 v[250:251], v16 offset:6144
    v_add_u32 v21, 36864, v13
    v_mfma_f32_16x16x32_bf16 a[12:15], v[228:231], v[32:35], a[12:15]
    v_accvgpr_read_b32 v176, a192
    v_accvgpr_read_b32 v177, a193
    v_accvgpr_read_b32 v178, a194
    v_accvgpr_read_b32 v179, a195
    v_mfma_f32_16x16x32_bf16 a[16:19], v[228:231], v[56:59], a[16:19]
    ds_read_b64_tr_b16 v[252:253], v17 offset:4096
    v_accvgpr_read_b32 v180, a204
    v_accvgpr_read_b32 v181, a205
    v_accvgpr_read_b32 v182, a206
    v_mfma_f32_16x16x32_bf16 a[20:23], v[228:231], v[80:83], a[20:23]
    ds_read_b64_tr_b16 v[254:255], v17 offset:6144
    s_waitcnt lgkmcnt(9)
    v_mfma_f32_16x16x32_bf16 a[24:27], v[232:235], v[32:35], a[24:27]
    v_accvgpr_read_b32 v183, a207
    v_cvt_pk_bf16_f32 v184, v176, v177
    v_mfma_f32_16x16x32_bf16 a[28:31], v[232:235], v[56:59], a[28:31]
    ds_read_b64_tr_b16 v[224:225], v14 offset:8192
    v_cvt_pk_bf16_f32 v185, v178, v179
    v_mfma_f32_16x16x32_bf16 a[32:35], v[232:235], v[80:83], a[32:35]
    ds_read_b64_tr_b16 v[226:227], v14 offset:10240
    v_cvt_pk_bf16_f32 v186, v180, v181
    v_mfma_f32_16x16x32_bf16 a[36:39], v[236:239], v[32:35], a[36:39]
    v_cvt_pk_bf16_f32 v187, v182, v183
    s_add_u32 s62, s45, 18432
    v_mfma_f32_16x16x32_bf16 a[40:43], v[236:239], v[56:59], a[40:43]
    ds_read_b64_tr_b16 v[228:229], v15 offset:8192
    buffer_store_dwordx4 v[184:187], v9, s[48:51], s62 offen offset:0 sc1
    v_mfma_f32_16x16x32_bf16 a[44:47], v[236:239], v[80:83], a[44:47]
    ds_read_b64_tr_b16 v[230:231], v15 offset:10240
    s_waitcnt lgkmcnt(8)
    v_mfma_f32_16x16x32_bf16 a[0:3], v[240:243], v[36:39], a[0:3]
    v_accvgpr_read_b32 v188, a216
    v_accvgpr_read_b32 v189, a217
    v_mfma_f32_16x16x32_bf16 a[4:7], v[240:243], v[60:63], a[4:7]
    ds_read_b64_tr_b16 v[232:233], v16 offset:8192
    v_accvgpr_read_b32 v190, a218
    v_mfma_f32_16x16x32_bf16 a[8:11], v[240:243], v[84:87], a[8:11]
    ds_read_b64_tr_b16 v[234:235], v16 offset:10240
    v_accvgpr_read_b32 v191, a219
    v_mfma_f32_16x16x32_bf16 a[12:15], v[244:247], v[36:39], a[12:15]
    v_accvgpr_read_b32 v192, a228
    v_accvgpr_read_b32 v193, a229
    v_mfma_f32_16x16x32_bf16 a[16:19], v[244:247], v[60:63], a[16:19]
    ds_read_b64_tr_b16 v[236:237], v17 offset:8192
    v_accvgpr_read_b32 v194, a230
    v_mfma_f32_16x16x32_bf16 a[20:23], v[244:247], v[84:87], a[20:23]
    ds_read_b64_tr_b16 v[238:239], v17 offset:10240
    s_waitcnt lgkmcnt(8)
    v_mfma_f32_16x16x32_bf16 a[24:27], v[248:251], v[36:39], a[24:27]
    v_accvgpr_read_b32 v195, a231
    v_cvt_pk_bf16_f32 v196, v188, v189
    v_mfma_f32_16x16x32_bf16 a[28:31], v[248:251], v[60:63], a[28:31]
    ds_read_b64_tr_b16 v[240:241], v18 offset:0
    v_cvt_pk_bf16_f32 v197, v190, v191
    v_mfma_f32_16x16x32_bf16 a[32:35], v[248:251], v[84:87], a[32:35]
    ds_read_b64_tr_b16 v[242:243], v18 offset:2048
    v_cvt_pk_bf16_f32 v198, v192, v193
    v_mfma_f32_16x16x32_bf16 a[36:39], v[252:255], v[36:39], a[36:39]
    v_cvt_pk_bf16_f32 v199, v194, v195
    buffer_store_dwordx4 v[196:199], v9, s[48:51], s62 offen offset:1024 sc1
    v_mfma_f32_16x16x32_bf16 a[40:43], v[252:255], v[60:63], a[40:43]
    ds_read_b64_tr_b16 v[244:245], v19 offset:0
    v_accvgpr_read_b32 v200, a196
    v_mfma_f32_16x16x32_bf16 a[44:47], v[252:255], v[84:87], a[44:47]
    ds_read_b64_tr_b16 v[246:247], v19 offset:2048
    s_waitcnt lgkmcnt(8)
    v_mfma_f32_16x16x32_bf16 a[0:3], v[224:227], v[40:43], a[0:3]
    v_accvgpr_read_b32 v201, a197
    v_accvgpr_read_b32 v202, a198
    v_mfma_f32_16x16x32_bf16 a[4:7], v[224:227], v[64:67], a[4:7]
    ds_read_b64_tr_b16 v[248:249], v20 offset:0
    v_accvgpr_read_b32 v203, a199
    v_mfma_f32_16x16x32_bf16 a[8:11], v[224:227], v[88:91], a[8:11]
    ds_read_b64_tr_b16 v[250:251], v20 offset:2048
    v_accvgpr_read_b32 v204, a208
    v_mfma_f32_16x16x32_bf16 a[12:15], v[228:231], v[40:43], a[12:15]
    v_accvgpr_read_b32 v205, a209
    v_accvgpr_read_b32 v206, a210
    v_mfma_f32_16x16x32_bf16 a[16:19], v[228:231], v[64:67], a[16:19]
    ds_read_b64_tr_b16 v[252:253], v21 offset:0
    v_accvgpr_read_b32 v207, a211
    v_cvt_pk_bf16_f32 v208, v200, v201
    v_mfma_f32_16x16x32_bf16 a[20:23], v[228:231], v[88:91], a[20:23]
    ds_read_b64_tr_b16 v[254:255], v21 offset:2048
    s_waitcnt lgkmcnt(8)
    v_mfma_f32_16x16x32_bf16 a[24:27], v[232:235], v[40:43], a[24:27]
    v_cvt_pk_bf16_f32 v209, v202, v203
    v_mfma_f32_16x16x32_bf16 a[28:31], v[232:235], v[64:67], a[28:31]
    ds_read_b64_tr_b16 v[224:225], v18 offset:4096
    v_cvt_pk_bf16_f32 v210, v204, v205
    v_mfma_f32_16x16x32_bf16 a[32:35], v[232:235], v[88:91], a[32:35]
    ds_read_b64_tr_b16 v[226:227], v18 offset:6144
    v_cvt_pk_bf16_f32 v211, v206, v207
    v_mfma_f32_16x16x32_bf16 a[36:39], v[236:239], v[40:43], a[36:39]
    s_add_u32 s62, s46, 18432
    buffer_store_dwordx4 v[208:211], v9, s[48:51], s62 offen offset:0 sc1
    v_mfma_f32_16x16x32_bf16 a[40:43], v[236:239], v[64:67], a[40:43]
    ds_read_b64_tr_b16 v[228:229], v19 offset:4096
    v_accvgpr_read_b32 v176, a220
    v_mfma_f32_16x16x32_bf16 a[44:47], v[236:239], v[88:91], a[44:47]
    ds_read_b64_tr_b16 v[230:231], v19 offset:6144
    s_waitcnt lgkmcnt(8)
    v_mfma_f32_16x16x32_bf16 a[0:3], v[240:243], v[44:47], a[0:3]
    v_add_u32 v14, 49152, v10
    v_add_u32 v15, 49152, v11
    v_accvgpr_read_b32 v177, a221
    v_accvgpr_read_b32 v178, a222
    v_mfma_f32_16x16x32_bf16 a[4:7], v[240:243], v[68:71], a[4:7]
    ds_read_b64_tr_b16 v[232:233], v20 offset:4096
    v_add_u32 v16, 49152, v12
    v_accvgpr_read_b32 v179, a223
    v_accvgpr_read_b32 v180, a232
    v_mfma_f32_16x16x32_bf16 a[8:11], v[240:243], v[92:95], a[8:11]
    ds_read_b64_tr_b16 v[234:235], v20 offset:6144
    v_add_u32 v17, 49152, v13
    v_accvgpr_read_b32 v181, a233
    v_mfma_f32_16x16x32_bf16 a[12:15], v[244:247], v[44:47], a[12:15]
    v_accvgpr_read_b32 v182, a234
    v_accvgpr_read_b32 v183, a235
    v_mfma_f32_16x16x32_bf16 a[16:19], v[244:247], v[68:71], a[16:19]
    ds_read_b64_tr_b16 v[236:237], v21 offset:4096
    v_cvt_pk_bf16_f32 v184, v176, v177
    v_mfma_f32_16x16x32_bf16 a[20:23], v[244:247], v[92:95], a[20:23]
    ds_read_b64_tr_b16 v[238:239], v21 offset:6144
    s_waitcnt lgkmcnt(8)
    v_mfma_f32_16x16x32_bf16 a[24:27], v[248:251], v[44:47], a[24:27]
    v_cvt_pk_bf16_f32 v185, v178, v179
    v_cvt_pk_bf16_f32 v186, v180, v181
    v_mfma_f32_16x16x32_bf16 a[28:31], v[248:251], v[68:71], a[28:31]
    ds_read_b64_tr_b16 v[240:241], v18 offset:8192
    v_cvt_pk_bf16_f32 v187, v182, v183
    v_mfma_f32_16x16x32_bf16 a[32:35], v[248:251], v[92:95], a[32:35]
    ds_read_b64_tr_b16 v[242:243], v18 offset:10240
    buffer_store_dwordx4 v[184:187], v9, s[48:51], s62 offen offset:1024 sc1
    v_mfma_f32_16x16x32_bf16 a[36:39], v[252:255], v[44:47], a[36:39]
    v_accvgpr_read_b32 v188, a200
    v_accvgpr_read_b32 v189, a201
    v_mfma_f32_16x16x32_bf16 a[40:43], v[252:255], v[68:71], a[40:43]
    ds_read_b64_tr_b16 v[244:245], v19 offset:8192
    v_accvgpr_read_b32 v190, a202
    v_mfma_f32_16x16x32_bf16 a[44:47], v[252:255], v[92:95], a[44:47]
    ds_read_b64_tr_b16 v[246:247], v19 offset:10240
    s_waitcnt lgkmcnt(8)
    v_mfma_f32_16x16x32_bf16 a[0:3], v[224:227], v[48:51], a[0:3]
    v_accvgpr_read_b32 v191, a203
    v_accvgpr_read_b32 v192, a212
    v_mfma_f32_16x16x32_bf16 a[4:7], v[224:227], v[72:75], a[4:7]
    ds_read_b64_tr_b16 v[248:249], v20 offset:8192
    v_accvgpr_read_b32 v193, a213
    v_mfma_f32_16x16x32_bf16 a[8:11], v[224:227], v[96:99], a[8:11]
    ds_read_b64_tr_b16 v[250:251], v20 offset:10240
    v_accvgpr_read_b32 v194, a214
    v_mfma_f32_16x16x32_bf16 a[12:15], v[228:231], v[48:51], a[12:15]
    v_accvgpr_read_b32 v195, a215
    v_cvt_pk_bf16_f32 v196, v188, v189
    v_mfma_f32_16x16x32_bf16 a[16:19], v[228:231], v[72:75], a[16:19]
    ds_read_b64_tr_b16 v[252:253], v21 offset:8192
    v_cvt_pk_bf16_f32 v197, v190, v191
    v_mfma_f32_16x16x32_bf16 a[20:23], v[228:231], v[96:99], a[20:23]
    ds_read_b64_tr_b16 v[254:255], v21 offset:10240
    s_waitcnt lgkmcnt(8)
    v_mfma_f32_16x16x32_bf16 a[24:27], v[232:235], v[48:51], a[24:27]
    s_cmp_ge_u32 s28, 72
    s_cbranch_scc0 L_sl19
L_bk19:
    v_mfma_f32_16x16x32_bf16 a[28:31], v[232:235], v[72:75], a[28:31]
    ds_read_b64_tr_b16 v[224:225], v14 offset:0
    v_cvt_pk_bf16_f32 v198, v192, v193
    v_mfma_f32_16x16x32_bf16 a[32:35], v[232:235], v[96:99], a[32:35]
    ds_read_b64_tr_b16 v[226:227], v14 offset:2048
    v_cvt_pk_bf16_f32 v199, v194, v195
    v_mfma_f32_16x16x32_bf16 a[36:39], v[236:239], v[48:51], a[36:39]
    s_add_u32 s62, s47, 18432
    buffer_store_dwordx4 v[196:199], v9, s[48:51], s62 offen offset:0 sc1
    v_mfma_f32_16x16x32_bf16 a[40:43], v[236:239], v[72:75], a[40:43]
    ds_read_b64_tr_b16 v[228:229], v15 offset:0
    v_accvgpr_read_b32 v200, a224
    v_mfma_f32_16x16x32_bf16 a[44:47], v[236:239], v[96:99], a[44:47]
    ds_read_b64_tr_b16 v[230:231], v15 offset:2048
    s_waitcnt lgkmcnt(8)
    v_mfma_f32_16x16x32_bf16 a[0:3], v[240:243], v[52:55], a[0:3]
    v_accvgpr_read_b32 v201, a225
    v_accvgpr_read_b32 v202, a226
    v_mfma_f32_16x16x32_bf16 a[4:7], v[240:243], v[76:79], a[4:7]
    ds_read_b64_tr_b16 v[232:233], v16 offset:0
    v_accvgpr_read_b32 v203, a227
    v_mfma_f32_16x16x32_bf16 a[8:11], v[240:243], v[100:103], a[8:11]
    ds_read_b64_tr_b16 v[234:235], v16 offset:2048
    v_accvgpr_read_b32 v204, a236
    v_mfma_f32_16x16x32_bf16 a[12:15], v[244:247], v[52:55], a[12:15]
    v_accvgpr_read_b32 v205, a237
    v_accvgpr_read_b32 v206, a238
    v_accvgpr_read_b32 v207, a239
    v_mfma_f32_16x16x32_bf16 a[16:19], v[244:247], v[76:79], a[16:19]
    ds_read_b64_tr_b16 v[236:237], v17 offset:0
    v_cvt_pk_bf16_f32 v208, v200, v201
    v_mfma_f32_16x16x32_bf16 a[20:23], v[244:247], v[100:103], a[20:23]
    ds_read_b64_tr_b16 v[238:239], v17 offset:2048
    s_waitcnt lgkmcnt(8)
    v_mfma_f32_16x16x32_bf16 a[24:27], v[248:251], v[52:55], a[24:27]
    v_cvt_pk_bf16_f32 v209, v202, v203
    v_mfma_f32_16x16x32_bf16 a[28:31], v[248:251], v[76:79], a[28:31]
    ds_read_b64_tr_b16 v[240:241], v14 offset:4096
    v_cvt_pk_bf16_f32 v210, v204, v205
    v_mfma_f32_16x16x32_bf16 a[32:35], v[248:251], v[100:103], a[32:35]
    ds_read_b64_tr_b16 v[242:243], v14 offset:6144
    v_cvt_pk_bf16_f32 v211, v206, v207
    v_mfma_f32_16x16x32_bf16 a[36:39], v[252:255], v[52:55], a[36:39]
    v_add_u32 v221, 2, v221
    ds_write_b32 v220, v221
    v_mfma_f32_16x16x32_bf16 a[40:43], v[252:255], v[76:79], a[40:43]
    ds_read_b64_tr_b16 v[244:245], v15 offset:4096
    buffer_store_dwordx4 v[208:211], v9, s[48:51], s62 offen offset:1024 sc1
    v_mfma_f32_16x16x32_bf16 a[44:47], v[252:255], v[100:103], a[44:47]
    ds_read_b64_tr_b16 v[246:247], v15 offset:6144
    s_waitcnt lgkmcnt(9)
    v_mfma_f32_16x16x32_bf16 a[0:3], v[224:227], a[48:51], a[0:3]
    v_add_u32 v18, 61440, v10
    v_add_u32 v19, 61440, v11
    v_mfma_f32_16x16x32_bf16 a[4:7], v[224:227], a[72:75], a[4:7]
    ds_read_b64_tr_b16 v[248:249], v16 offset:4096
    v_add_u32 v20, 61440, v12
    v_mfma_f32_16x16x32_bf16 a[8:11], v[224:227], a[96:99], a[8:11]
    ds_read_b64_tr_b16 v[250:251], v16 offset:6144
    v_add_u32 v21, 61440, v13
    v_mfma_f32_16x16x32_bf16 a[12:15], v[228:231], a[48:51], a[12:15]
    v_mfma_f32_16x16x32_bf16 a[16:19], v[228:231], a[72:75], a[16:19]
    ds_read_b64_tr_b16 v[252:253], v17 offset:4096
    v_mfma_f32_16x16x32_bf16 a[20:23], v[228:231], a[96:99], a[20:23]
    ds_read_b64_tr_b16 v[254:255], v17 offset:6144
    s_waitcnt lgkmcnt(9)
    v_mfma_f32_16x16x32_bf16 a[24:27], v[232:235], a[48:51], a[24:27]
    v_mfma_f32_16x16x32_bf16 a[28:31], v[232:235], a[72:75], a[28:31]
    ds_read_b64_tr_b16 v[224:225], v14 offset:8192
    v_mfma_f32_16x16x32_bf16 a[32:35], v[232:235], a[96:99], a[32:35]
    ds_read_b64_tr_b16 v[226:227], v14 offset:10240
    v_mfma_f32_16x16x32_bf16 a[36:39], v[236:239], a[48:51], a[36:39]
    v_mfma_f32_16x16x32_bf16 a[40:43], v[236:239], a[72:75], a[40:43]
    ds_read_b64_tr_b16 v[228:229], v15 offset:8192
    v_mfma_f32_16x16x32_bf16 a[44:47], v[236:239], a[96:99], a[44:47]
    ds_read_b64_tr_b16 v[230:231], v15 offset:10240
    s_waitcnt lgkmcnt(8)
    v_mfma_f32_16x16x32_bf16 a[0:3], v[240:243], a[52:55], a[0:3]
    v_mfma_f32_16x16x32_bf16 a[4:7], v[240:243], a[76:79], a[4:7]
    ds_read_b64_tr_b16 v[232:233], v16 offset:8192
    v_mfma_f32_16x16x32_bf16 a[8:11], v[240:243], a[100:103], a[8:11]
    ds_read_b64_tr_b16 v[234:235], v16 offset:10240
    v_mfma_f32_16x16x32_bf16 a[12:15], v[244:247], a[52:55], a[12:15]
    v_mfma_f32_16x16x32_bf16 a[16:19], v[244:247], a[76:79], a[16:19]
    ds_read_b64_tr_b16 v[236:237], v17 offset:8192
    v_mfma_f32_16x16x32_bf16 a[20:23], v[244:247], a[100:103], a[20:23]
    ds_read_b64_tr_b16 v[238:239], v17 offset:10240
    s_waitcnt lgkmcnt(8)
    v_mfma_f32_16x16x32_bf16 a[24:27], v[248:251], a[52:55], a[24:27]
    v_mfma_f32_16x16x32_bf16 a[28:31], v[248:251], a[76:79], a[28:31]
    ds_read_b64_tr_b16 v[240:241], v18 offset:0
    v_mfma_f32_16x16x32_bf16 a[32:35], v[248:251], a[100:103], a[32:35]
    ds_read_b64_tr_b16 v[242:243], v18 offset:2048
    v_mfma_f32_16x16x32_bf16 a[36:39], v[252:255], a[52:55], a[36:39]
    v_mfma_f32_16x16x32_bf16 a[40:43], v[252:255], a[76:79], a[40:43]
    ds_read_b64_tr_b16 v[244:245], v19 offset:0
    v_mfma_f32_16x16x32_bf16 a[44:47], v[252:255], a[100:103], a[44:47]
    ds_read_b64_tr_b16 v[246:247], v19 offset:2048
    s_waitcnt lgkmcnt(8)
    v_mfma_f32_16x16x32_bf16 a[0:3], v[224:227], a[56:59], a[0:3]
    v_mfma_f32_16x16x32_bf16 a[4:7], v[224:227], a[80:83], a[4:7]
    ds_read_b64_tr_b16 v[248:249], v18 offset:4096
    v_mfma_f32_16x16x32_bf16 a[8:11], v[224:227], a[104:107], a[8:11]
    ds_read_b64_tr_b16 v[250:251], v18 offset:6144
    v_mfma_f32_16x16x32_bf16 a[12:15], v[228:231], a[56:59], a[12:15]
    v_mfma_f32_16x16x32_bf16 a[16:19], v[228:231], a[80:83], a[16:19]
    ds_read_b64_tr_b16 v[252:253], v19 offset:4096
    s_waitcnt vmcnt(0)
    v_add_u32 v28, 2, v22
    buffer_store_dwordx2 v[28:29], v8, s[48:51], s55 offen sc1
    v_mfma_f32_16x16x32_bf16 a[20:23], v[228:231], a[104:107], a[20:23]
    ds_read_b64_tr_b16 v[254:255], v19 offset:6144
    s_waitcnt lgkmcnt(8)
    v_mfma_f32_16x16x32_bf16 a[24:27], v[232:235], a[56:59], a[24:27]
    v_mfma_f32_16x16x32_bf16 a[28:31], v[232:235], a[80:83], a[28:31]
    ds_read_b64_tr_b16 v[224:225], v18 offset:8192
    v_mfma_f32_16x16x32_bf16 a[32:35], v[232:235], a[104:107], a[32:35]
    ds_read_b64_tr_b16 v[226:227], v18 offset:10240
    v_mfma_f32_16x16x32_bf16 a[36:39], v[236:239], a[56:59], a[36:39]
    v_mfma_f32_16x16x32_bf16 a[40:43], v[236:239], a[80:83], a[40:43]
    ds_read_b64_tr_b16 v[228:229], v19 offset:8192
    v_mfma_f32_16x16x32_bf16 a[44:47], v[236:239], a[104:107], a[44:47]
    ds_read_b64_tr_b16 v[230:231], v19 offset:10240
    s_waitcnt lgkmcnt(8)
    v_mfma_f32_16x16x32_bf16 a[0:3], v[240:243], a[60:63], a[0:3]
    v_mfma_f32_16x16x32_bf16 a[4:7], v[240:243], a[84:87], a[4:7]
    ds_read_b64_tr_b16 v[232:233], v20 offset:0
    v_mfma_f32_16x16x32_bf16 a[8:11], v[240:243], a[108:111], a[8:11]
    ds_read_b64_tr_b16 v[234:235], v20 offset:2048
    v_mfma_f32_16x16x32_bf16 a[12:15], v[244:247], a[60:63], a[12:15]
    v_mfma_f32_16x16x32_bf16 a[16:19], v[244:247], a[84:87], a[16:19]
    ds_read_b64_tr_b16 v[236:237], v21 offset:0
    v_mfma_f32_16x16x32_bf16 a[20:23], v[244:247], a[108:111], a[20:23]
    ds_read_b64_tr_b16 v[238:239], v21 offset:2048
    s_waitcnt lgkmcnt(8)
    v_mfma_f32_16x16x32_bf16 a[0:3], v[248:251], a[64:67], a[0:3]
    v_mfma_f32_16x16x32_bf16 a[4:7], v[248:251], a[88:91], a[4:7]
    ds_read_b64_tr_b16 v[240:241], v20 offset:4096
    v_mfma_f32_16x16x32_bf16 a[8:11], v[248:251], a[112:115], a[8:11]
    ds_read_b64_tr_b16 v[242:243], v20 offset:6144
    v_mfma_f32_16x16x32_bf16 a[12:15], v[252:255], a[64:67], a[12:15]
    v_mfma_f32_16x16x32_bf16 a[16:19], v[252:255], a[88:91], a[16:19]
    ds_read_b64_tr_b16 v[244:245], v21 offset:4096
    v_mfma_f32_16x16x32_bf16 a[20:23], v[252:255], a[112:115], a[20:23]
    ds_read_b64_tr_b16 v[246:247], v21 offset:6144
    s_waitcnt lgkmcnt(8)
    v_mfma_f32_16x16x32_bf16 a[0:3], v[224:227], a[68:71], a[0:3]
    v_mfma_f32_16x16x32_bf16 a[4:7], v[224:227], a[92:95], a[4:7]
    ds_read_b64_tr_b16 v[248:249], v20 offset:8192
    v_mfma_f32_16x16x32_bf16 a[8:11], v[224:227], a[116:119], a[8:11]
    ds_read_b64_tr_b16 v[250:251], v20 offset:10240
    v_mfma_f32_16x16x32_bf16 a[12:15], v[228:231], a[68:71], a[12:15]
    v_mfma_f32_16x16x32_bf16 a[16:19], v[228:231], a[92:95], a[16:19]
    ds_read_b64_tr_b16 v[252:253], v21 offset:8192
    v_mfma_f32_16x16x32_bf16 a[20:23], v[228:231], a[116:119], a[20:23]
    ds_read_b64_tr_b16 v[254:255], v21 offset:10240
    s_waitcnt lgkmcnt(8)
    v_mfma_f32_16x16x32_bf16 a[24:27], v[232:235], a[60:63], a[24:27]
    v_mfma_f32_16x16x32_bf16 a[28:31], v[232:235], a[84:87], a[28:31]
    v_mfma_f32_16x16x32_bf16 a[32:35], v[232:235], a[108:111], a[32:35]
    v_accvgpr_read_b32 v176, a0
    v_accvgpr_read_b32 v177, a1
    v_accvgpr_read_b32 v178, a2
    v_accvgpr_read_b32 v179, a3
    v_mfma_f32_16x16x32_bf16 a[36:39], v[236:239], a[60:63], a[36:39]
    v_accvgpr_read_b32 v180, a12
    v_accvgpr_read_b32 v181, a13
    v_accvgpr_read_b32 v182, a14
    v_accvgpr_read_b32 v183, a15
    v_mfma_f32_16x16x32_bf16 a[40:43], v[236:239], a[84:87], a[40:43]
    v_cvt_pk_bf16_f32 v184, v176, v177
    v_cvt_pk_bf16_f32 v185, v178, v179
    v_cvt_pk_bf16_f32 v186, v180, v181
    v_mfma_f32_16x16x32_bf16 a[44:47], v[236:239], a[108:111], a[44:47]
    v_cvt_pk_bf16_f32 v187, v182, v183
    s_add_u32 s62, s45, 36864
    s_waitcnt lgkmcnt(4)
    v_mfma_f32_16x16x32_bf16 a[24:27], v[240:243], a[64:67], a[24:27]
    buffer_store_dwordx4 v[184:187], v9, s[48:51], s62 offen offset:0 sc1
    v_accvgpr_read_b32 v200, a4
    v_accvgpr_read_b32 v201, a5
    v_accvgpr_read_b32 v202, a6
    v_mfma_f32_16x16x32_bf16 a[28:31], v[240:243], a[88:91], a[28:31]
    v_accvgpr_read_b32 v203, a7
    v_accvgpr_read_b32 v204, a16
    v_accvgpr_read_b32 v205, a17
    v_accvgpr_read_b32 v206, a18
    v_mfma_f32_16x16x32_bf16 a[32:35], v[240:243], a[112:115], a[32:35]
    v_accvgpr_read_b32 v207, a19
    v_cvt_pk_bf16_f32 v208, v200, v201
    v_cvt_pk_bf16_f32 v209, v202, v203
    v_mfma_f32_16x16x32_bf16 a[36:39], v[244:247], a[64:67], a[36:39]
    v_cvt_pk_bf16_f32 v210, v204, v205
    v_cvt_pk_bf16_f32 v211, v206, v207
    s_add_u32 s62, s46, 36864
    v_mfma_f32_16x16x32_bf16 a[40:43], v[244:247], a[88:91], a[40:43]
    buffer_store_dwordx4 v[208:211], v9, s[48:51], s62 offen offset:0 sc1
    v_accvgpr_read_b32 v188, a8
    v_accvgpr_read_b32 v189, a9
    v_mfma_f32_16x16x32_bf16 a[44:47], v[244:247], a[112:115], a[44:47]
    v_accvgpr_read_b32 v190, a10
    s_waitcnt lgkmcnt(0)
    v_mfma_f32_16x16x32_bf16 a[24:27], v[248:251], a[68:71], a[24:27]
    v_accvgpr_read_b32 v191, a11
    v_accvgpr_read_b32 v192, a20
    v_mfma_f32_16x16x32_bf16 a[28:31], v[248:251], a[92:95], a[28:31]
    v_accvgpr_read_b32 v193, a21
    v_accvgpr_read_b32 v194, a22
    v_mfma_f32_16x16x32_bf16 a[32:35], v[248:251], a[116:119], a[32:35]
    v_accvgpr_read_b32 v195, a23
    v_cvt_pk_bf16_f32 v196, v188, v189
    v_mfma_f32_16x16x32_bf16 a[36:39], v[252:255], a[68:71], a[36:39]
    v_cvt_pk_bf16_f32 v197, v190, v191
    v_cvt_pk_bf16_f32 v198, v192, v193
    v_mfma_f32_16x16x32_bf16 a[40:43], v[252:255], a[92:95], a[40:43]
    v_cvt_pk_bf16_f32 v199, v194, v195
    s_add_u32 s62, s47, 36864
    v_mfma_f32_16x16x32_bf16 a[44:47], v[252:255], a[116:119], a[44:47]
    buffer_store_dwordx4 v[196:199], v9, s[48:51], s62 offen offset:0 sc1
    v_accvgpr_read_b32 v188, a24
    v_accvgpr_read_b32 v189, a25
    v_accvgpr_read_b32 v190, a26
    v_accvgpr_read_b32 v191, a27
    v_accvgpr_read_b32 v192, a36
    v_accvgpr_read_b32 v193, a37
    v_accvgpr_read_b32 v194, a38
    v_accvgpr_read_b32 v195, a39
    v_cvt_pk_bf16_f32 v196, v188, v189
    v_cvt_pk_bf16_f32 v197, v190, v191
    v_cvt_pk_bf16_f32 v198, v192, v193
    v_cvt_pk_bf16_f32 v199, v194, v195
    s_add_u32 s62, s45, 36864
    buffer_store_dwordx4 v[196:199], v9, s[48:51], s62 offen offset:1024 sc1
    v_accvgpr_read_b32 v176, a28
    v_accvgpr_read_b32 v177, a29
    v_accvgpr_read_b32 v178, a30
    v_accvgpr_read_b32 v179, a31
    v_accvgpr_read_b32 v180, a40
    v_accvgpr_read_b32 v181, a41
    v_accvgpr_read_b32 v182, a42
    v_accvgpr_read_b32 v183, a43
    v_cvt_pk_bf16_f32 v184, v176, v177
    v_cvt_pk_bf16_f32 v185, v178, v179
    v_cvt_pk_bf16_f32 v186, v180, v181
    v_cvt_pk_bf16_f32 v187, v182, v183
    s_add_u32 s62, s46, 36864
    buffer_store_dwordx4 v[184:187], v9, s[48:51], s62 offen offset:1024 sc1
    v_accvgpr_read_b32 v200, a32
    v_accvgpr_read_b32 v201, a33
    v_accvgpr_read_b32 v202, a34
    v_accvgpr_read_b32 v203, a35
    v_accvgpr_read_b32 v204, a44
    v_accvgpr_read_b32 v205, a45
    v_accvgpr_read_b32 v206, a46
    v_accvgpr_read_b32 v207, a47
    v_cvt_pk_bf16_f32 v208, v200, v201
    v_cvt_pk_bf16_f32 v209, v202, v203
    v_cvt_pk_bf16_f32 v210, v204, v205
    v_cvt_pk_bf16_f32 v211, v206, v207
    s_add_u32 s62, s47, 36864
    buffer_store_dwordx4 v[208:211], v9, s[48:51], s62 offen offset:1024 sc1
    s_mov_b32 s31, s55
    s_mov_b32 s44, s14
    s_mov_b32 s45, s15
    s_mov_b32 s46, 1474560
    s_mov_b32 s47, 0x20000
    s_lshr_b32 s40, s23, 1
    s_mul_i32 s40, s40, 640
    s_and_b32 s41, s23, 1
    s_lshl_b32 s41, s41, 8
    s_add_u32 s41, s41, s40
    s_add_u32 s42, s41, 128
    s_add_u32 s40, s40, 512
    v_and_b32 v3, 15, v1
    v_mul_u32_u24 v3, 1280, v3
    v_lshrrev_b32 v6, 4, v1
    v_lshl_add_u32 v3, v6, 3, v3
    v_and_b32 v2, 7, v1
    v_lshlrev_b32 v2, 7, v2
    v_and_b32 v6, 8, v1
    v_mul_u32_u24 v6, 384, v6
    v_add_u32 v6, v6, v2
    s_mov_b32 s56, 0x00003f80
    s_mov_b32 s57, 0x3f800000
    s_lshl_b32 s54, s22, 5
    s_add_u32 s53, s54, s23
    s_mul_i32 s53, s53, 55424
    s_add_u32 s53, s53, 16777216
    s_and_b32 s55, s23, 2
    s_add_u32 s54, s54, s55
    s_mul_i32 s54, s54, 55424
    s_add_u32 s54, s54, 16777216
    s_lshl_b32 s52, s22, 2
    s_add_u32 s55, s55, s52
    s_mul_i32 s55, s55, 3072
    s_add_u32 s55, s55, 46235648
    s_add_u32 s39, s52, s23
    s_mul_i32 s39, s39, 3072
    s_add_u32 s39, s39, 46235648
    s_mul_i32 s52, s22, 184320
    s_waitcnt vmcnt(0)
    v_add_u32 v28, 3, v22
    buffer_store_dwordx2 v[28:29], v8, s[48:51], s31 offen sc1
    s_lshl_b32 s61, s20, 3
    s_add_u32 s61, s61, s21
    s_add_u32 s62, s61, 36
    s_cmp_lt_u32 s61, 18
    s_cselect_b32 s61, s62, s61
    s_call_b64 s[66:67], L_unit8
L_cdone:
    s_endpgm
L_unit16:
    s_mul_hi_u32 s58, s61, 238609295
    s_mul_i32 s59, s58, 18
    s_sub_u32 s59, s61, s59
    s_mul_hi_u32 s60, s59, 715827883
    s_lshl_b32 s60, s60, 10
    s_add_u32 s60, s60, s55
    s_sub_u32 s63, 7, s58
    s_add_u32 s38, s58, s68
    s_add_u32 s38, s38, 1
    s_mov_b32 s62, 0
L_rs16:
    buffer_load_dwordx2 v[4:5], v6, s[48:51], s60 offen sc1
    s_add_u32 s62, s62, 1
    s_waitcnt vmcnt(0)
    v_subrev_u32 v4, s38, v4
    v_cmp_gt_u32 vcc, s63, v4
    s_nop 1
    v_cmp_eq_u32 s[64:65], s69, v5
    s_and_b64 vcc, vcc, s[64:65]
    s_cmp_eq_u64 vcc, -1
    s_cbranch_scc1 L_rg16
    s_sleep 4
    s_cmp_lt_u32 s62, 200000
    s_cbranch_scc1 L_rs16
L_rg16:
    s_lshl_b32 s60, s61, 10
    s_add_u32 s60, s60, s54
    buffer_load_dwordx4 v[32:35], v9, s[48:51], s60 offen sc1
    s_add_u32 s60, s60, 55424
    buffer_load_dwordx4 v[36:39], v9, s[48:51], s60 offen sc1
    s_add_u32 s60, s60, 166272
    buffer_load_dwordx4 v[40:43], v9, s[48:51], s60 offen sc1
    s_add_u32 s60, s60, 55424
    buffer_load_dwordx4 v[44:47], v9, s[48:51], s60 offen sc1
    s_add_u32 s60, s60, 166272
    buffer_load_dwordx4 v[48:51], v9, s[48:51], s60 offen sc1
    s_add_u32 s60, s60, 55424
    buffer_load_dwordx4 v[52:55], v9, s[48:51], s60 offen sc1
    s_add_u32 s60, s60, 166272
    buffer_load_dwordx4 v[56:59], v9, s[48:51], s60 offen sc1
    s_add_u32 s60, s60, 55424
    buffer_load_dwordx4 v[60:63], v9, s[48:51], s60 offen sc1
    s_add_u32 s60, s60, 166272
    buffer_load_dwordx4 v[64:67], v9, s[48:51], s60 offen sc1
    s_add_u32 s60, s60, 55424
    buffer_load_dwordx4 v[68:71], v9, s[48:51], s60 offen sc1
    s_add_u32 s60, s60, 166272
    buffer_load_dwordx4 v[72:75], v9, s[48:51], s60 offen sc1
    s_add_u32 s60, s60, 55424
    buffer_load_dwordx4 v[76:79], v9, s[48:51], s60 offen sc1
    s_add_u32 s60, s60, 166272
    buffer_load_dwordx4 v[80:83], v9, s[48:51], s60 offen sc1
    s_add_u32 s60, s60, 55424
    buffer_load_dwordx4 v[84:87], v9, s[48:51], s60 offen sc1
    s_add_u32 s60, s60, 166272
    buffer_load_dwordx4 v[88:91], v9, s[48:51], s60 offen sc1
    s_add_u32 s60, s60, 55424
    buffer_load_dwordx4 v[92:95], v9, s[48:51], s60 offen sc1
    s_cmp_eq_u32 s58, 1
    s_cselect_b32 s60, s41, s40
    s_cmp_eq_u32 s58, 2
    s_cselect_b32 s60, s42, s60
    s_add_u32 s60, s60, s52
    s_lshr_b32 s58, s59, 1
    s_mul_i32 s58, s58, 20480
    s_add_u32 s60, s60, s58
    s_and_b32 s58, s59, 1
    s_lshl_b32 s58, s58, 6
    s_add_u32 s60, s60, s58
    v_mov_b32 v16, 0
    v_mov_b32 v17, 0
    v_mov_b32 v18, 0
    v_mov_b32 v19, 0
    v_mov_b32 v20, 0
    v_mov_b32 v21, 0
    v_mov_b32 v22, 0
    v_mov_b32 v23, 0
    s_waitcnt vmcnt(15)
    v_dot2c_f32_bf16 v16, s56, v32
    v_dot2c_f32_bf16 v17, s57, v32
    v_dot2c_f32_bf16 v18, s56, v33
    v_dot2c_f32_bf16 v19, s57, v33
    v_dot2c_f32_bf16 v20, s56, v34
    v_dot2c_f32_bf16 v21, s57, v34
    v_dot2c_f32_bf16 v22, s56, v35
    v_dot2c_f32_bf16 v23, s57, v35
    s_waitcnt vmcnt(14)
    v_dot2c_f32_bf16 v16, s56, v36
    v_dot2c_f32_bf16 v17, s57, v36
    v_dot2c_f32_bf16 v18, s56, v37
    v_dot2c_f32_bf16 v19, s57, v37
    v_dot2c_f32_bf16 v20, s56, v38
    v_dot2c_f32_bf16 v21, s57, v38
    v_dot2c_f32_bf16 v22, s56, v39
    v_dot2c_f32_bf16 v23, s57, v39
    s_waitcnt vmcnt(13)
    v_dot2c_f32_bf16 v16, s56, v40
    v_dot2c_f32_bf16 v17, s57, v40
    v_dot2c_f32_bf16 v18, s56, v41
    v_dot2c_f32_bf16 v19, s57, v41
    v_dot2c_f32_bf16 v20, s56, v42
    v_dot2c_f32_bf16 v21, s57, v42
    v_dot2c_f32_bf16 v22, s56, v43
    v_dot2c_f32_bf16 v23, s57, v43
    s_waitcnt vmcnt(12)
    v_dot2c_f32_bf16 v16, s56, v44
    v_dot2c_f32_bf16 v17, s57, v44
    v_dot2c_f32_bf16 v18, s56, v45
    v_dot2c_f32_bf16 v19, s57, v45
    v_dot2c_f32_bf16 v20, s56, v46
    v_dot2c_f32_bf16 v21, s57, v46
    v_dot2c_f32_bf16 v22, s56, v47
    v_dot2c_f32_bf16 v23, s57, v47
    s_waitcnt vmcnt(11)
    v_dot2c_f32_bf16 v16, s56, v48
    v_dot2c_f32_bf16 v17, s57, v48
    v_dot2c_f32_bf16 v18, s56, v49
    v_dot2c_f32_bf16 v19, s57, v49
    v_dot2c_f32_bf16 v20, s56, v50
    v_dot2c_f32_bf16 v21, s57, v50
    v_dot2c_f32_bf16 v22, s56, v51
    v_dot2c_f32_bf16 v23, s57, v51
    s_waitcnt vmcnt(10)
    v_dot2c_f32_bf16 v16, s56, v52
    v_dot2c_f32_bf16 v17, s57, v52
    v_dot2c_f32_bf16 v18, s56, v53
    v_dot2c_f32_bf16 v19, s57, v53
    v_dot2c_f32_bf16 v20, s56, v54
    v_dot2c_f32_bf16 v21, s57, v54
    v_dot2c_f32_bf16 v22, s56, v55
    v_dot2c_f32_bf16 v23, s57, v55
    s_waitcnt vmcnt(9)
    v_dot2c_f32_bf16 v16, s56, v56
    v_dot2c_f32_bf16 v17, s57, v56
    v_dot2c_f32_bf16 v18, s56, v57
    v_dot2c_f32_bf16 v19, s57, v57
    v_dot2c_f32_bf16 v20, s56, v58
    v_dot2c_f32_bf16 v21, s57, v58
    v_dot2c_f32_bf16 v22, s56, v59
    v_dot2c_f32_bf16 v23, s57, v59
    s_waitcnt vmcnt(8)
    v_dot2c_f32_bf16 v16, s56, v60
    v_dot2c_f32_bf16 v17, s57, v60
    v_dot2c_f32_bf16 v18, s56, v61
    v_dot2c_f32_bf16 v19, s57, v61
    v_dot2c_f32_bf16 v20, s56, v62
    v_dot2c_f32_bf16 v21, s57, v62
    v_dot2c_f32_bf16 v22, s56, v63
    v_dot2c_f32_bf16 v23, s57, v63
    s_waitcnt vmcnt(7)
    v_dot2c_f32_bf16 v16, s56, v64
    v_dot2c_f32_bf16 v17, s57, v64
    v_dot2c_f32_bf16 v18, s56, v65
    v_dot2c_f32_bf16 v19, s57, v65
    v_dot2c_f32_bf16 v20, s56, v66
    v_dot2c_f32_bf16 v21, s57, v66
    v_dot2c_f32_bf16 v22, s56, v67
    v_dot2c_f32_bf16 v23, s57, v67
    s_waitcnt vmcnt(6)
    v_dot2c_f32_bf16 v16, s56, v68
    v_dot2c_f32_bf16 v17, s57, v68
    v_dot2c_f32_bf16 v18, s56, v69
    v_dot2c_f32_bf16 v19, s57, v69
    v_dot2c_f32_bf16 v20, s56, v70
    v_dot2c_f32_bf16 v21, s57, v70
    v_dot2c_f32_bf16 v22, s56, v71
    v_dot2c_f32_bf16 v23, s57, v71
    s_waitcnt vmcnt(5)
    v_dot2c_f32_bf16 v16, s56, v72
    v_dot2c_f32_bf16 v17, s57, v72
    v_dot2c_f32_bf16 v18, s56, v73
    v_dot2c_f32_bf16 v19, s57, v73
    v_dot2c_f32_bf16 v20, s56, v74
    v_dot2c_f32_bf16 v21, s57, v74
    v_dot2c_f32_bf16 v22, s56, v75
    v_dot2c_f32_bf16 v23, s57, v75
    s_waitcnt vmcnt(4)
    v_dot2c_f32_bf16 v16, s56, v76
    v_dot2c_f32_bf16 v17, s57, v76
    v_dot2c_f32_bf16 v18, s56, v77
    v_dot2c_f32_bf16 v19, s57, v77
    v_dot2c_f32_bf16 v20, s56, v78
    v_dot2c_f32_bf16 v21, s57, v78
    v_dot2c_f32_bf16 v22, s56, v79
    v_dot2c_f32_bf16 v23, s57, v79
    s_waitcnt vmcnt(3)
    v_dot2c_f32_bf16 v16, s56, v80
    v_dot2c_f32_bf16 v17, s57, v80
    v_dot2c_f32_bf16 v18, s56, v81
    v_dot2c_f32_bf16 v19, s57, v81
    v_dot2c_f32_bf16 v20, s56, v82
    v_dot2c_f32_bf16 v21, s57, v82
    v_dot2c_f32_bf16 v22, s56, v83
    v_dot2c_f32_bf16 v23, s57, v83
    s_waitcnt vmcnt(2)
    v_dot2c_f32_bf16 v16, s56, v84
    v_dot2c_f32_bf16 v17, s57, v84
    v_dot2c_f32_bf16 v18, s56, v85
    v_dot2c_f32_bf16 v19, s57, v85
    v_dot2c_f32_bf16 v20, s56, v86
    v_dot2c_f32_bf16 v21, s57, v86
    v_dot2c_f32_bf16 v22, s56, v87
    v_dot2c_f32_bf16 v23, s57, v87
    s_waitcnt vmcnt(1)
    v_dot2c_f32_bf16 v16, s56, v88
    v_dot2c_f32_bf16 v17, s57, v88
    v_dot2c_f32_bf16 v18, s56, v89
    v_dot2c_f32_bf16 v19, s57, v89
    v_dot2c_f32_bf16 v20, s56, v90
    v_dot2c_f32_bf16 v21, s57, v90
    v_dot2c_f32_bf16 v22, s56, v91
    v_dot2c_f32_bf16 v23, s57, v91
    s_waitcnt vmcnt(0)
    v_dot2c_f32_bf16 v16, s56, v92
    v_dot2c_f32_bf16 v17, s57, v92
    v_dot2c_f32_bf16 v18, s56, v93
    v_dot2c_f32_bf16 v19, s57, v93
    v_dot2c_f32_bf16 v20, s56, v94
    v_dot2c_f32_bf16 v21, s57, v94
    v_dot2c_f32_bf16 v22, s56, v95
    v_dot2c_f32_bf16 v23, s57, v95
    s_nop 2
    v_cvt_pk_bf16_f32 v24, v16, v17
    v_cvt_pk_bf16_f32 v25, v18, v19
    v_cvt_pk_bf16_f32 v26, v20, v21
    v_cvt_pk_bf16_f32 v27, v22, v23
    buffer_store_dwordx2 v[24:25], v3, s[44:47], s60 offen
    buffer_store_dwordx2 v[26:27], v3, s[44:47], s60 offen offset:32
    s_setpc_b64 s[66:67]
L_unit8:
    s_mul_hi_u32 s58, s61, 238609295
    s_mul_i32 s59, s58, 18
    s_sub_u32 s59, s61, s59
    s_mul_hi_u32 s60, s59, 715827883
    s_lshl_b32 s60, s60, 10
    s_add_u32 s60, s60, s39
    s_sub_u32 s63, 7, s58
    s_add_u32 s38, s58, s68
    s_add_u32 s38, s38, 1
    s_mov_b32 s62, 0
L_rs8:
    buffer_load_dwordx2 v[4:5], v2, s[48:51], s60 offen sc1
    s_add_u32 s62, s62, 1
    s_waitcnt vmcnt(0)
    v_subrev_u32 v4, s38, v4
    v_cmp_gt_u32 vcc, s63, v4
    s_nop 1
    v_cmp_eq_u32 s[64:65], s69, v5
    s_and_b64 vcc, vcc, s[64:65]
    s_cmp_eq_u64 vcc, -1
    s_cbranch_scc1 L_rg8
    s_sleep 2
    s_cmp_lt_u32 s62, 200000
    s_cbranch_scc1 L_rs8
L_rg8:
    s_lshl_b32 s60, s61, 10
    s_add_u32 s60, s60, s53
    buffer_load_dwordx4 v[32:35], v9, s[48:51], s60 offen sc1
    s_add_u32 s60, s60, 221696
    buffer_load_dwordx4 v[36:39], v9, s[48:51], s60 offen sc1
    s_add_u32 s60, s60, 221696
    buffer_load_dwordx4 v[40:43], v9, s[48:51], s60 offen sc1
    s_add_u32 s60, s60, 221696
    buffer_load_dwordx4 v[44:47], v9, s[48:51], s60 offen sc1
    s_add_u32 s60, s60, 221696
    buffer_load_dwordx4 v[48:51], v9, s[48:51], s60 offen sc1
    s_add_u32 s60, s60, 221696
    buffer_load_dwordx4 v[52:55], v9, s[48:51], s60 offen sc1
    s_add_u32 s60, s60, 221696
    buffer_load_dwordx4 v[56:59], v9, s[48:51], s60 offen sc1
    s_add_u32 s60, s60, 221696
    buffer_load_dwordx4 v[60:63], v9, s[48:51], s60 offen sc1
    s_cmp_eq_u32 s58, 1
    s_cselect_b32 s60, s41, s40
    s_cmp_eq_u32 s58, 2
    s_cselect_b32 s60, s42, s60
    s_add_u32 s60, s60, s52
    s_lshr_b32 s58, s59, 1
    s_mul_i32 s58, s58, 20480
    s_add_u32 s60, s60, s58
    s_and_b32 s58, s59, 1
    s_lshl_b32 s58, s58, 6
    s_add_u32 s60, s60, s58
    v_mov_b32 v16, 0
    v_mov_b32 v17, 0
    v_mov_b32 v18, 0
    v_mov_b32 v19, 0
    v_mov_b32 v20, 0
    v_mov_b32 v21, 0
    v_mov_b32 v22, 0
    v_mov_b32 v23, 0
    s_waitcnt vmcnt(7)
    v_dot2c_f32_bf16 v16, s56, v32
    v_dot2c_f32_bf16 v17, s57, v32
    v_dot2c_f32_bf16 v18, s56, v33
    v_dot2c_f32_bf16 v19, s57, v33
    v_dot2c_f32_bf16 v20, s56, v34
    v_dot2c_f32_bf16 v21, s57, v34
    v_dot2c_f32_bf16 v22, s56, v35
    v_dot2c_f32_bf16 v23, s57, v35
    s_waitcnt vmcnt(6)
    v_dot2c_f32_bf16 v16, s56, v36
    v_dot2c_f32_bf16 v17, s57, v36
    v_dot2c_f32_bf16 v18, s56, v37
    v_dot2c_f32_bf16 v19, s57, v37
    v_dot2c_f32_bf16 v20, s56, v38
    v_dot2c_f32_bf16 v21, s57, v38
    v_dot2c_f32_bf16 v22, s56, v39
    v_dot2c_f32_bf16 v23, s57, v39
    s_waitcnt vmcnt(5)
    v_dot2c_f32_bf16 v16, s56, v40
    v_dot2c_f32_bf16 v17, s57, v40
    v_dot2c_f32_bf16 v18, s56, v41
    v_dot2c_f32_bf16 v19, s57, v41
    v_dot2c_f32_bf16 v20, s56, v42
    v_dot2c_f32_bf16 v21, s57, v42
    v_dot2c_f32_bf16 v22, s56, v43
    v_dot2c_f32_bf16 v23, s57, v43
    s_waitcnt vmcnt(4)
    v_dot2c_f32_bf16 v16, s56, v44
    v_dot2c_f32_bf16 v17, s57, v44
    v_dot2c_f32_bf16 v18, s56, v45
    v_dot2c_f32_bf16 v19, s57, v45
    v_dot2c_f32_bf16 v20, s56, v46
    v_dot2c_f32_bf16 v21, s57, v46
    v_dot2c_f32_bf16 v22, s56, v47
    v_dot2c_f32_bf16 v23, s57, v47
    s_waitcnt vmcnt(3)
    v_dot2c_f32_bf16 v16, s56, v48
    v_dot2c_f32_bf16 v17, s57, v48
    v_dot2c_f32_bf16 v18, s56, v49
    v_dot2c_f32_bf16 v19, s57, v49
    v_dot2c_f32_bf16 v20, s56, v50
    v_dot2c_f32_bf16 v21, s57, v50
    v_dot2c_f32_bf16 v22, s56, v51
    v_dot2c_f32_bf16 v23, s57, v51
    s_waitcnt vmcnt(2)
    v_dot2c_f32_bf16 v16, s56, v52
    v_dot2c_f32_bf16 v17, s57, v52
    v_dot2c_f32_bf16 v18, s56, v53
    v_dot2c_f32_bf16 v19, s57, v53
    v_dot2c_f32_bf16 v20, s56, v54
    v_dot2c_f32_bf16 v21, s57, v54
    v_dot2c_f32_bf16 v22, s56, v55
    v_dot2c_f32_bf16 v23, s57, v55
    s_waitcnt vmcnt(1)
    v_dot2c_f32_bf16 v16, s56, v56
    v_dot2c_f32_bf16 v17, s57, v56
    v_dot2c_f32_bf16 v18, s56, v57
    v_dot2c_f32_bf16 v19, s57, v57
    v_dot2c_f32_bf16 v20, s56, v58
    v_dot2c_f32_bf16 v21, s57, v58
    v_dot2c_f32_bf16 v22, s56, v59
    v_dot2c_f32_bf16 v23, s57, v59
    s_waitcnt vmcnt(0)
    v_dot2c_f32_bf16 v16, s56, v60
    v_dot2c_f32_bf16 v17, s57, v60
    v_dot2c_f32_bf16 v18, s56, v61
    v_dot2c_f32_bf16 v19, s57, v61
    v_dot2c_f32_bf16 v20, s56, v62
    v_dot2c_f32_bf16 v21, s57, v62
    v_dot2c_f32_bf16 v22, s56, v63
    v_dot2c_f32_bf16 v23, s57, v63
    s_nop 2
    v_cvt_pk_bf16_f32 v24, v16, v17
    v_cvt_pk_bf16_f32 v25, v18, v19
    v_cvt_pk_bf16_f32 v26, v20, v21
    v_cvt_pk_bf16_f32 v27, v22, v23
    buffer_store_dwordx2 v[24:25], v3, s[44:47], s60 offen
    buffer_store_dwordx2 v[26:27], v3, s[44:47], s60 offen offset:32
    s_setpc_b64 s[66:67]
L_sl1:
    s_mov_b32 s29, 22
    s_call_b64 s[66:67], L_wait
    s_branch L_bk1
L_sl2:
    s_mov_b32 s29, 24
    s_call_b64 s[66:67], L_wait
    s_branch L_bk2
L_sl3:
    s_mov_b32 s29, 26
    s_call_b64 s[66:67], L_wait
    s_branch L_bk3
L_sl4:
    s_mov_b32 s29, 28
    s_call_b64 s[66:67], L_wait
    s_branch L_bk4
L_sl5:
    s_call_b64 s[66:67], L_wait
    s_branch L_bk5
L_sl6:
    s_call_b64 s[66:67], L_wait
    s_branch L_bk6
L_sl7:
    s_call_b64 s[66:67], L_wait
    s_branch L_bk7
L_sl8:
    s_call_b64 s[66:67], L_wait
    s_branch L_bk8
L_sl9:
    s_mov_b32 s29, 52
    s_call_b64 s[66:67], L_wait
    s_branch L_bk9
L_sl10:
    s_mov_b32 s29, 54
    s_call_b64 s[66:67], L_wait
    s_branch L_bk10
L_sl11:
    s_mov_b32 s29, 56
    s_call_b64 s[66:67], L_wait
    s_branch L_bk11
L_sl12:
    s_mov_b32 s29, 58
    s_call_b64 s[66:67], L_wait
    s_branch L_bk12
L_sl13:
    s_mov_b32 s29, 60
    s_call_b64 s[66:67], L_wait
    s_branch L_bk13
L_sl14:
    s_mov_b32 s29, 62
    s_call_b64 s[66:67], L_wait
    s_branch L_bk14
L_sl15:
    s_mov_b32 s29, 64
    s_call_b64 s[66:67], L_wait
    s_branch L_bk15
L_sl16:
    s_mov_b32 s29, 66
    s_call_b64 s[66:67], L_wait
    s_branch L_bk16
L_sl17:
    s_mov_b32 s29, 68
    s_call_b64 s[66:67], L_wait
    s_branch L_bk17
L_sl18:
    s_mov_b32 s29, 70
    s_call_b64 s[66:67], L_wait
    s_branch L_bk18
L_sl19:
    s_mov_b32 s29, 72
    s_call_b64 s[66:67], L_wait
    s_branch L_bk19
L_wait:
    s_mov_b32 s31, 0
L_wait1:
    ds_read_b32 v223, v222
    s_add_u32 s31, s31, 1
    s_waitcnt lgkmcnt(0)
    v_readfirstlane_b32 s28, v223
    s_cmp_ge_u32 s28, s29
    s_cbranch_scc1 L_wait2
    s_cmp_lt_u32 s31, 3200000
    s_cbranch_scc1 L_wait1
L_wait2:
    s_setpc_b64 s[66:67]
L_loadBa:
    buffer_load_dwordx4 v[104:107], v9, s[48:51], s42 offen offset:0 sc1
    buffer_load_dwordx4 v[128:131], v9, s[48:51], s43 offen offset:0 sc1
    buffer_load_dwordx4 v[152:155], v9, s[48:51], s44 offen offset:0 sc1
    buffer_load_dwordx4 v[108:111], v9, s[48:51], s42 offen offset:1024 sc1
    buffer_load_dwordx4 v[132:135], v9, s[48:51], s43 offen offset:1024 sc1
    buffer_load_dwordx4 v[156:159], v9, s[48:51], s44 offen offset:1024 sc1
    buffer_load_dwordx4 v[112:115], v9, s[48:51], s42 offen offset:2048 sc1
    buffer_load_dwordx4 v[136:139], v9, s[48:51], s43 offen offset:2048 sc1
    buffer_load_dwordx4 v[160:163], v9, s[48:51], s44 offen offset:2048 sc1
    s_mov_b32 s63, 1
    s_setpc_b64 s[66:67]
L_loadBb:
    buffer_load_dwordx4 v[116:119], v9, s[48:51], s42 offen offset:3072 sc1
    buffer_load_dwordx4 v[140:143], v9, s[48:51], s43 offen offset:3072 sc1
    buffer_load_dwordx4 v[164:167], v9, s[48:51], s44 offen offset:3072 sc1
    s_add_u32 s64, s42, 4096
    buffer_load_dwordx4 v[120:123], v9, s[48:51], s64 offen offset:0 sc1
    s_add_u32 s64, s43, 4096
    buffer_load_dwordx4 v[144:147], v9, s[48:51], s64 offen offset:0 sc1
    s_add_u32 s64, s44, 4096
    buffer_load_dwordx4 v[168:171], v9, s[48:51], s64 offen offset:0 sc1
    s_add_u32 s64, s42, 4096
    buffer_load_dwordx4 v[124:127], v9, s[48:51], s64 offen offset:1024 sc1
    s_add_u32 s64, s43, 4096
    buffer_load_dwordx4 v[148:151], v9, s[48:51], s64 offen offset:1024 sc1
    s_add_u32 s64, s44, 4096
    buffer_load_dwordx4 v[172:175], v9, s[48:51], s64 offen offset:1024 sc1
    s_mov_b32 s63, 2
    s_setpc_b64 s[66:67]
L_rare0:
    s_nop 7
    s_nop 7
    v_mov_b32 v176, v172
    s_nop 1
    v_permlane32_swap_b32 v172, v176
    s_nop 1
    v_max_f32 v172, v172, v176
    v_mov_b32 v176, v172
    s_nop 1
    v_permlane16_swap_b32 v172, v176
    s_nop 1
    v_max_f32 v172, v172, v176
    v_max_f32 v172, 0, v172
    v_sub_f32 v160, v160, v172
    v_sub_f32 v161, v161, v172
    v_sub_f32 v162, v162, v172
    v_sub_f32 v163, v163, v172
    v_sub_f32 v40, v40, v172
    v_sub_f32 v41, v41, v172
    v_sub_f32 v42, v42, v172
    v_sub_f32 v43, v43, v172
    v_sub_f32 v52, v52, v172
    v_sub_f32 v53, v53, v172
    v_sub_f32 v54, v54, v172
    v_sub_f32 v55, v55, v172
    v_sub_f32 v64, v64, v172
    v_sub_f32 v65, v65, v172
    v_sub_f32 v66, v66, v172
    v_sub_f32 v67, v67, v172
    v_sub_f32 v76, v76, v172
    v_sub_f32 v77, v77, v172
    v_sub_f32 v78, v78, v172
    v_sub_f32 v79, v79, v172
    v_mov_b32 v176, v173
    s_nop 1
    v_permlane32_swap_b32 v173, v176
    s_nop 1
    v_max_f32 v173, v173, v176
    v_mov_b32 v176, v173
    s_nop 1
    v_permlane16_swap_b32 v173, v176
    s_nop 1
    v_max_f32 v173, v173, v176
    v_max_f32 v173, 0, v173
    v_sub_f32 v164, v164, v173
    v_sub_f32 v165, v165, v173
    v_sub_f32 v166, v166, v173
    v_sub_f32 v167, v167, v173
    v_sub_f32 v44, v44, v173
    v_sub_f32 v45, v45, v173
    v_sub_f32 v46, v46, v173
    v_sub_f32 v47, v47, v173
    v_sub_f32 v56, v56, v173
    v_sub_f32 v57, v57, v173
    v_sub_f32 v58, v58, v173
    v_sub_f32 v59, v59, v173
    v_sub_f32 v68, v68, v173
    v_sub_f32 v69, v69, v173
    v_sub_f32 v70, v70, v173
    v_sub_f32 v71, v71, v173
    v_sub_f32 v80, v80, v173
    v_sub_f32 v81, v81, v173
    v_sub_f32 v82, v82, v173
    v_sub_f32 v83, v83, v173
    v_mov_b32 v176, v174
    s_nop 1
    v_permlane32_swap_b32 v174, v176
    s_nop 1
    v_max_f32 v174, v174, v176
    v_mov_b32 v176, v174
    s_nop 1
    v_permlane16_swap_b32 v174, v176
    s_nop 1
    v_max_f32 v174, v174, v176
    v_max_f32 v174, 0, v174
    v_sub_f32 v168, v168, v174
    v_sub_f32 v169, v169, v174
    v_sub_f32 v170, v170, v174
    v_sub_f32 v171, v171, v174
    v_sub_f32 v48, v48, v174
    v_sub_f32 v49, v49, v174
    v_sub_f32 v50, v50, v174
    v_sub_f32 v51, v51, v174
    v_sub_f32 v60, v60, v174
    v_sub_f32 v61, v61, v174
    v_sub_f32 v62, v62, v174
    v_sub_f32 v63, v63, v174
    v_sub_f32 v72, v72, v174
    v_sub_f32 v73, v73, v174
    v_sub_f32 v74, v74, v174
    v_sub_f32 v75, v75, v174
    v_sub_f32 v84, v84, v174
    v_sub_f32 v85, v85, v174
    v_sub_f32 v86, v86, v174
    v_sub_f32 v87, v87, v174
    v_sub_f32 v172, 0, v172
    v_exp_f32 v172, v172
    v_accvgpr_read_b32 v176, a0
    v_mul_f32 v176, v176, v172
    v_accvgpr_write_b32 a0, v176
    v_accvgpr_read_b32 v177, a1
    v_mul_f32 v177, v177, v172
    v_accvgpr_write_b32 a1, v177
    v_accvgpr_read_b32 v178, a2
    v_mul_f32 v178, v178, v172
    v_accvgpr_write_b32 a2, v178
    v_accvgpr_read_b32 v179, a3
    v_mul_f32 v179, v179, v172
    v_accvgpr_write_b32 a3, v179
    v_accvgpr_read_b32 v176, a12
    v_mul_f32 v176, v176, v172
    v_accvgpr_write_b32 a12, v176
    v_accvgpr_read_b32 v177, a13
    v_mul_f32 v177, v177, v172
    v_accvgpr_write_b32 a13, v177
    v_accvgpr_read_b32 v178, a14
    v_mul_f32 v178, v178, v172
    v_accvgpr_write_b32 a14, v178
    v_accvgpr_read_b32 v179, a15
    v_mul_f32 v179, v179, v172
    v_accvgpr_write_b32 a15, v179
    v_accvgpr_read_b32 v176, a24
    v_mul_f32 v176, v176, v172
    v_accvgpr_write_b32 a24, v176
    v_accvgpr_read_b32 v177, a25
    v_mul_f32 v177, v177, v172
    v_accvgpr_write_b32 a25, v177
    v_accvgpr_read_b32 v178, a26
    v_mul_f32 v178, v178, v172
    v_accvgpr_write_b32 a26, v178
    v_accvgpr_read_b32 v179, a27
    v_mul_f32 v179, v179, v172
    v_accvgpr_write_b32 a27, v179
    v_accvgpr_read_b32 v176, a36
    v_mul_f32 v176, v176, v172
    v_accvgpr_write_b32 a36, v176
    v_accvgpr_read_b32 v177, a37
    v_mul_f32 v177, v177, v172
    v_accvgpr_write_b32 a37, v177
    v_accvgpr_read_b32 v178, a38
    v_mul_f32 v178, v178, v172
    v_accvgpr_write_b32 a38, v178
    v_accvgpr_read_b32 v179, a39
    v_mul_f32 v179, v179, v172
    v_accvgpr_write_b32 a39, v179
    v_accvgpr_read_b32 v176, a48
    v_mul_f32 v176, v176, v172
    v_accvgpr_write_b32 a48, v176
    v_accvgpr_read_b32 v177, a49
    v_mul_f32 v177, v177, v172
    v_accvgpr_write_b32 a49, v177
    v_accvgpr_read_b32 v178, a50
    v_mul_f32 v178, v178, v172
    v_accvgpr_write_b32 a50, v178
    v_accvgpr_read_b32 v179, a51
    v_mul_f32 v179, v179, v172
    v_accvgpr_write_b32 a51, v179
    v_accvgpr_read_b32 v176, a60
    v_mul_f32 v176, v176, v172
    v_accvgpr_write_b32 a60, v176
    v_accvgpr_read_b32 v177, a61
    v_mul_f32 v177, v177, v172
    v_accvgpr_write_b32 a61, v177
    v_accvgpr_read_b32 v178, a62
    v_mul_f32 v178, v178, v172
    v_accvgpr_write_b32 a62, v178
    v_accvgpr_read_b32 v179, a63
    v_mul_f32 v179, v179, v172
    v_accvgpr_write_b32 a63, v179
    v_accvgpr_read_b32 v176, a72
    v_mul_f32 v176, v176, v172
    v_accvgpr_write_b32 a72, v176
    v_accvgpr_read_b32 v177, a73
    v_mul_f32 v177, v177, v172
    v_accvgpr_write_b32 a73, v177
    v_accvgpr_read_b32 v178, a74
    v_mul_f32 v178, v178, v172
    v_accvgpr_write_b32 a74, v178
    v_accvgpr_read_b32 v179, a75
    v_mul_f32 v179, v179, v172
    v_accvgpr_write_b32 a75, v179
    v_accvgpr_read_b32 v176, a84
    v_mul_f32 v176, v176, v172
    v_accvgpr_write_b32 a84, v176
    v_accvgpr_read_b32 v177, a85
    v_mul_f32 v177, v177, v172
    v_accvgpr_write_b32 a85, v177
    v_accvgpr_read_b32 v178, a86
    v_mul_f32 v178, v178, v172
    v_accvgpr_write_b32 a86, v178
    v_accvgpr_read_b32 v179, a87
    v_mul_f32 v179, v179, v172
    v_accvgpr_write_b32 a87, v179
    v_accvgpr_read_b32 v176, a96
    v_mul_f32 v176, v176, v172
    v_accvgpr_write_b32 a96, v176
    v_accvgpr_read_b32 v177, a97
    v_mul_f32 v177, v177, v172
    v_accvgpr_write_b32 a97, v177
    v_accvgpr_read_b32 v178, a98
    v_mul_f32 v178, v178, v172
    v_accvgpr_write_b32 a98, v178
    v_accvgpr_read_b32 v179, a99
    v_mul_f32 v179, v179, v172
    v_accvgpr_write_b32 a99, v179
    v_accvgpr_read_b32 v176, a108
    v_mul_f32 v176, v176, v172
    v_accvgpr_write_b32 a108, v176
    v_accvgpr_read_b32 v177, a109
    v_mul_f32 v177, v177, v172
    v_accvgpr_write_b32 a109, v177
    v_accvgpr_read_b32 v178, a110
    v_mul_f32 v178, v178, v172
    v_accvgpr_write_b32 a110, v178
    v_accvgpr_read_b32 v179, a111
    v_mul_f32 v179, v179, v172
    v_accvgpr_write_b32 a111, v179
    v_accvgpr_read_b32 v176, a120
    v_mul_f32 v176, v176, v172
    v_accvgpr_write_b32 a120, v176
    v_accvgpr_read_b32 v177, a121
    v_mul_f32 v177, v177, v172
    v_accvgpr_write_b32 a121, v177
    v_accvgpr_read_b32 v178, a122
    v_mul_f32 v178, v178, v172
    v_accvgpr_write_b32 a122, v178
    v_accvgpr_read_b32 v179, a123
    v_mul_f32 v179, v179, v172
    v_accvgpr_write_b32 a123, v179
    v_accvgpr_read_b32 v176, a132
    v_mul_f32 v176, v176, v172
    v_accvgpr_write_b32 a132, v176
    v_accvgpr_read_b32 v177, a133
    v_mul_f32 v177, v177, v172
    v_accvgpr_write_b32 a133, v177
    v_accvgpr_read_b32 v178, a134
    v_mul_f32 v178, v178, v172
    v_accvgpr_write_b32 a134, v178
    v_accvgpr_read_b32 v179, a135
    v_mul_f32 v179, v179, v172
    v_accvgpr_write_b32 a135, v179
    v_accvgpr_read_b32 v176, a144
    v_mul_f32 v176, v176, v172
    v_accvgpr_write_b32 a144, v176
    v_accvgpr_read_b32 v177, a145
    v_mul_f32 v177, v177, v172
    v_accvgpr_write_b32 a145, v177
    v_accvgpr_read_b32 v178, a146
    v_mul_f32 v178, v178, v172
    v_accvgpr_write_b32 a146, v178
    v_accvgpr_read_b32 v179, a147
    v_mul_f32 v179, v179, v172
    v_accvgpr_write_b32 a147, v179
    v_sub_f32 v173, 0, v173
    v_exp_f32 v173, v173
    v_accvgpr_read_b32 v176, a4
    v_mul_f32 v176, v176, v173
    v_accvgpr_write_b32 a4, v176
    v_accvgpr_read_b32 v177, a5
    v_mul_f32 v177, v177, v173
    v_accvgpr_write_b32 a5, v177
    v_accvgpr_read_b32 v178, a6
    v_mul_f32 v178, v178, v173
    v_accvgpr_write_b32 a6, v178
    v_accvgpr_read_b32 v179, a7
    v_mul_f32 v179, v179, v173
    v_accvgpr_write_b32 a7, v179
    v_accvgpr_read_b32 v176, a16
    v_mul_f32 v176, v176, v173
    v_accvgpr_write_b32 a16, v176
    v_accvgpr_read_b32 v177, a17
    v_mul_f32 v177, v177, v173
    v_accvgpr_write_b32 a17, v177
    v_accvgpr_read_b32 v178, a18
    v_mul_f32 v178, v178, v173
    v_accvgpr_write_b32 a18, v178
    v_accvgpr_read_b32 v179, a19
    v_mul_f32 v179, v179, v173
    v_accvgpr_write_b32 a19, v179
    v_accvgpr_read_b32 v176, a28
    v_mul_f32 v176, v176, v173
    v_accvgpr_write_b32 a28, v176
    v_accvgpr_read_b32 v177, a29
    v_mul_f32 v177, v177, v173
    v_accvgpr_write_b32 a29, v177
    v_accvgpr_read_b32 v178, a30
    v_mul_f32 v178, v178, v173
    v_accvgpr_write_b32 a30, v178
    v_accvgpr_read_b32 v179, a31
    v_mul_f32 v179, v179, v173
    v_accvgpr_write_b32 a31, v179
    v_accvgpr_read_b32 v176, a40
    v_mul_f32 v176, v176, v173
    v_accvgpr_write_b32 a40, v176
    v_accvgpr_read_b32 v177, a41
    v_mul_f32 v177, v177, v173
    v_accvgpr_write_b32 a41, v177
    v_accvgpr_read_b32 v178, a42
    v_mul_f32 v178, v178, v173
    v_accvgpr_write_b32 a42, v178
    v_accvgpr_read_b32 v179, a43
    v_mul_f32 v179, v179, v173
    v_accvgpr_write_b32 a43, v179
    v_accvgpr_read_b32 v176, a52
    v_mul_f32 v176, v176, v173
    v_accvgpr_write_b32 a52, v176
    v_accvgpr_read_b32 v177, a53
    v_mul_f32 v177, v177, v173
    v_accvgpr_write_b32 a53, v177
    v_accvgpr_read_b32 v178, a54
    v_mul_f32 v178, v178, v173
    v_accvgpr_write_b32 a54, v178
    v_accvgpr_read_b32 v179, a55
    v_mul_f32 v179, v179, v173
    v_accvgpr_write_b32 a55, v179
    v_accvgpr_read_b32 v176, a64
    v_mul_f32 v176, v176, v173
    v_accvgpr_write_b32 a64, v176
    v_accvgpr_read_b32 v177, a65
    v_mul_f32 v177, v177, v173
    v_accvgpr_write_b32 a65, v177
    v_accvgpr_read_b32 v178, a66
    v_mul_f32 v178, v178, v173
    v_accvgpr_write_b32 a66, v178
    v_accvgpr_read_b32 v179, a67
    v_mul_f32 v179, v179, v173
    v_accvgpr_write_b32 a67, v179
    v_accvgpr_read_b32 v176, a76
    v_mul_f32 v176, v176, v173
    v_accvgpr_write_b32 a76, v176
    v_accvgpr_read_b32 v177, a77
    v_mul_f32 v177, v177, v173
    v_accvgpr_write_b32 a77, v177
    v_accvgpr_read_b32 v178, a78
    v_mul_f32 v178, v178, v173
    v_accvgpr_write_b32 a78, v178
    v_accvgpr_read_b32 v179, a79
    v_mul_f32 v179, v179, v173
    v_accvgpr_write_b32 a79, v179
    v_accvgpr_read_b32 v176, a88
    v_mul_f32 v176, v176, v173
    v_accvgpr_write_b32 a88, v176
    v_accvgpr_read_b32 v177, a89
    v_mul_f32 v177, v177, v173
    v_accvgpr_write_b32 a89, v177
    v_accvgpr_read_b32 v178, a90
    v_mul_f32 v178, v178, v173
    v_accvgpr_write_b32 a90, v178
    v_accvgpr_read_b32 v179, a91
    v_mul_f32 v179, v179, v173
    v_accvgpr_write_b32 a91, v179
    v_accvgpr_read_b32 v176, a100
    v_mul_f32 v176, v176, v173
    v_accvgpr_write_b32 a100, v176
    v_accvgpr_read_b32 v177, a101
    v_mul_f32 v177, v177, v173
    v_accvgpr_write_b32 a101, v177
    v_accvgpr_read_b32 v178, a102
    v_mul_f32 v178, v178, v173
    v_accvgpr_write_b32 a102, v178
    v_accvgpr_read_b32 v179, a103
    v_mul_f32 v179, v179, v173
    v_accvgpr_write_b32 a103, v179
    v_accvgpr_read_b32 v176, a112
    v_mul_f32 v176, v176, v173
    v_accvgpr_write_b32 a112, v176
    v_accvgpr_read_b32 v177, a113
    v_mul_f32 v177, v177, v173
    v_accvgpr_write_b32 a113, v177
    v_accvgpr_read_b32 v178, a114
    v_mul_f32 v178, v178, v173
    v_accvgpr_write_b32 a114, v178
    v_accvgpr_read_b32 v179, a115
    v_mul_f32 v179, v179, v173
    v_accvgpr_write_b32 a115, v179
    v_accvgpr_read_b32 v176, a124
    v_mul_f32 v176, v176, v173
    v_accvgpr_write_b32 a124, v176
    v_accvgpr_read_b32 v177, a125
    v_mul_f32 v177, v177, v173
    v_accvgpr_write_b32 a125, v177
    v_accvgpr_read_b32 v178, a126
    v_mul_f32 v178, v178, v173
    v_accvgpr_write_b32 a126, v178
    v_accvgpr_read_b32 v179, a127
    v_mul_f32 v179, v179, v173
    v_accvgpr_write_b32 a127, v179
    v_accvgpr_read_b32 v176, a136
    v_mul_f32 v176, v176, v173
    v_accvgpr_write_b32 a136, v176
    v_accvgpr_read_b32 v177, a137
    v_mul_f32 v177, v177, v173
    v_accvgpr_write_b32 a137, v177
    v_accvgpr_read_b32 v178, a138
    v_mul_f32 v178, v178, v173
    v_accvgpr_write_b32 a138, v178
    v_accvgpr_read_b32 v179, a139
    v_mul_f32 v179, v179, v173
    v_accvgpr_write_b32 a139, v179
    v_accvgpr_read_b32 v176, a148
    v_mul_f32 v176, v176, v173
    v_accvgpr_write_b32 a148, v176
    v_accvgpr_read_b32 v177, a149
    v_mul_f32 v177, v177, v173
    v_accvgpr_write_b32 a149, v177
    v_accvgpr_read_b32 v178, a150
    v_mul_f32 v178, v178, v173
    v_accvgpr_write_b32 a150, v178
    v_accvgpr_read_b32 v179, a151
    v_mul_f32 v179, v179, v173
    v_accvgpr_write_b32 a151, v179
    v_sub_f32 v174, 0, v174
    v_exp_f32 v174, v174
    v_accvgpr_read_b32 v176, a8
    v_mul_f32 v176, v176, v174
    v_accvgpr_write_b32 a8, v176
    v_accvgpr_read_b32 v177, a9
    v_mul_f32 v177, v177, v174
    v_accvgpr_write_b32 a9, v177
    v_accvgpr_read_b32 v178, a10
    v_mul_f32 v178, v178, v174
    v_accvgpr_write_b32 a10, v178
    v_accvgpr_read_b32 v179, a11
    v_mul_f32 v179, v179, v174
    v_accvgpr_write_b32 a11, v179
    v_accvgpr_read_b32 v176, a20
    v_mul_f32 v176, v176, v174
    v_accvgpr_write_b32 a20, v176
    v_accvgpr_read_b32 v177, a21
    v_mul_f32 v177, v177, v174
    v_accvgpr_write_b32 a21, v177
    v_accvgpr_read_b32 v178, a22
    v_mul_f32 v178, v178, v174
    v_accvgpr_write_b32 a22, v178
    v_accvgpr_read_b32 v179, a23
    v_mul_f32 v179, v179, v174
    v_accvgpr_write_b32 a23, v179
    v_accvgpr_read_b32 v176, a32
    v_mul_f32 v176, v176, v174
    v_accvgpr_write_b32 a32, v176
    v_accvgpr_read_b32 v177, a33
    v_mul_f32 v177, v177, v174
    v_accvgpr_write_b32 a33, v177
    v_accvgpr_read_b32 v178, a34
    v_mul_f32 v178, v178, v174
    v_accvgpr_write_b32 a34, v178
    v_accvgpr_read_b32 v179, a35
    v_mul_f32 v179, v179, v174
    v_accvgpr_write_b32 a35, v179
    v_accvgpr_read_b32 v176, a44
    v_mul_f32 v176, v176, v174
    v_accvgpr_write_b32 a44, v176
    v_accvgpr_read_b32 v177, a45
    v_mul_f32 v177, v177, v174
    v_accvgpr_write_b32 a45, v177
    v_accvgpr_read_b32 v178, a46
    v_mul_f32 v178, v178, v174
    v_accvgpr_write_b32 a46, v178
    v_accvgpr_read_b32 v179, a47
    v_mul_f32 v179, v179, v174
    v_accvgpr_write_b32 a47, v179
    v_accvgpr_read_b32 v176, a56
    v_mul_f32 v176, v176, v174
    v_accvgpr_write_b32 a56, v176
    v_accvgpr_read_b32 v177, a57
    v_mul_f32 v177, v177, v174
    v_accvgpr_write_b32 a57, v177
    v_accvgpr_read_b32 v178, a58
    v_mul_f32 v178, v178, v174
    v_accvgpr_write_b32 a58, v178
    v_accvgpr_read_b32 v179, a59
    v_mul_f32 v179, v179, v174
    v_accvgpr_write_b32 a59, v179
    v_accvgpr_read_b32 v176, a68
    v_mul_f32 v176, v176, v174
    v_accvgpr_write_b32 a68, v176
    v_accvgpr_read_b32 v177, a69
    v_mul_f32 v177, v177, v174
    v_accvgpr_write_b32 a69, v177
    v_accvgpr_read_b32 v178, a70
    v_mul_f32 v178, v178, v174
    v_accvgpr_write_b32 a70, v178
    v_accvgpr_read_b32 v179, a71
    v_mul_f32 v179, v179, v174
    v_accvgpr_write_b32 a71, v179
    v_accvgpr_read_b32 v176, a80
    v_mul_f32 v176, v176, v174
    v_accvgpr_write_b32 a80, v176
    v_accvgpr_read_b32 v177, a81
    v_mul_f32 v177, v177, v174
    v_accvgpr_write_b32 a81, v177
    v_accvgpr_read_b32 v178, a82
    v_mul_f32 v178, v178, v174
    v_accvgpr_write_b32 a82, v178
    v_accvgpr_read_b32 v179, a83
    v_mul_f32 v179, v179, v174
    v_accvgpr_write_b32 a83, v179
    v_accvgpr_read_b32 v176, a92
    v_mul_f32 v176, v176, v174
    v_accvgpr_write_b32 a92, v176
    v_accvgpr_read_b32 v177, a93
    v_mul_f32 v177, v177, v174
    v_accvgpr_write_b32 a93, v177
    v_accvgpr_read_b32 v178, a94
    v_mul_f32 v178, v178, v174
    v_accvgpr_write_b32 a94, v178
    v_accvgpr_read_b32 v179, a95
    v_mul_f32 v179, v179, v174
    v_accvgpr_write_b32 a95, v179
    v_accvgpr_read_b32 v176, a104
    v_mul_f32 v176, v176, v174
    v_accvgpr_write_b32 a104, v176
    v_accvgpr_read_b32 v177, a105
    v_mul_f32 v177, v177, v174
    v_accvgpr_write_b32 a105, v177
    v_accvgpr_read_b32 v178, a106
    v_mul_f32 v178, v178, v174
    v_accvgpr_write_b32 a106, v178
    v_accvgpr_read_b32 v179, a107
    v_mul_f32 v179, v179, v174
    v_accvgpr_write_b32 a107, v179
    v_accvgpr_read_b32 v176, a116
    v_mul_f32 v176, v176, v174
    v_accvgpr_write_b32 a116, v176
    v_accvgpr_read_b32 v177, a117
    v_mul_f32 v177, v177, v174
    v_accvgpr_write_b32 a117, v177
    v_accvgpr_read_b32 v178, a118
    v_mul_f32 v178, v178, v174
    v_accvgpr_write_b32 a118, v178
    v_accvgpr_read_b32 v179, a119
    v_mul_f32 v179, v179, v174
    v_accvgpr_write_b32 a119, v179
    v_accvgpr_read_b32 v176, a128
    v_mul_f32 v176, v176, v174
    v_accvgpr_write_b32 a128, v176
    v_accvgpr_read_b32 v177, a129
    v_mul_f32 v177, v177, v174
    v_accvgpr_write_b32 a129, v177
    v_accvgpr_read_b32 v178, a130
    v_mul_f32 v178, v178, v174
    v_accvgpr_write_b32 a130, v178
    v_accvgpr_read_b32 v179, a131
    v_mul_f32 v179, v179, v174
    v_accvgpr_write_b32 a131, v179
    v_accvgpr_read_b32 v176, a140
    v_mul_f32 v176, v176, v174
    v_accvgpr_write_b32 a140, v176
    v_accvgpr_read_b32 v177, a141
    v_mul_f32 v177, v177, v174
    v_accvgpr_write_b32 a141, v177
    v_accvgpr_read_b32 v178, a142
    v_mul_f32 v178, v178, v174
    v_accvgpr_write_b32 a142, v178
    v_accvgpr_read_b32 v179, a143
    v_mul_f32 v179, v179, v174
    v_accvgpr_write_b32 a143, v179
    v_accvgpr_read_b32 v176, a152
    v_mul_f32 v176, v176, v174
    v_accvgpr_write_b32 a152, v176
    v_accvgpr_read_b32 v177, a153
    v_mul_f32 v177, v177, v174
    v_accvgpr_write_b32 a153, v177
    v_accvgpr_read_b32 v178, a154
    v_mul_f32 v178, v178, v174
    v_accvgpr_write_b32 a154, v178
    v_accvgpr_read_b32 v179, a155
    v_mul_f32 v179, v179, v174
    v_accvgpr_write_b32 a155, v179
L_rret0:
    s_nop 3
    s_setpc_b64 s[66:67]
L_rare1:
    s_nop 7
    s_nop 7
    v_mov_b32 v176, v172
    s_nop 1
    v_permlane32_swap_b32 v172, v176
    s_nop 1
    v_max_f32 v172, v172, v176
    v_mov_b32 v176, v172
    s_nop 1
    v_permlane16_swap_b32 v172, v176
    s_nop 1
    v_max_f32 v172, v172, v176
    v_max_f32 v172, 0, v172
    v_sub_f32 v160, v160, v172
    v_sub_f32 v161, v161, v172
    v_sub_f32 v162, v162, v172
    v_sub_f32 v163, v163, v172
    v_sub_f32 v88, v88, v172
    v_sub_f32 v89, v89, v172
    v_sub_f32 v90, v90, v172
    v_sub_f32 v91, v91, v172
    v_sub_f32 v100, v100, v172
    v_sub_f32 v101, v101, v172
    v_sub_f32 v102, v102, v172
    v_sub_f32 v103, v103, v172
    v_sub_f32 v112, v112, v172
    v_sub_f32 v113, v113, v172
    v_sub_f32 v114, v114, v172
    v_sub_f32 v115, v115, v172
    v_sub_f32 v124, v124, v172
    v_sub_f32 v125, v125, v172
    v_sub_f32 v126, v126, v172
    v_sub_f32 v127, v127, v172
    v_mov_b32 v176, v173
    s_nop 1
    v_permlane32_swap_b32 v173, v176
    s_nop 1
    v_max_f32 v173, v173, v176
    v_mov_b32 v176, v173
    s_nop 1
    v_permlane16_swap_b32 v173, v176
    s_nop 1
    v_max_f32 v173, v173, v176
    v_max_f32 v173, 0, v173
    v_sub_f32 v164, v164, v173
    v_sub_f32 v165, v165, v173
    v_sub_f32 v166, v166, v173
    v_sub_f32 v167, v167, v173
    v_sub_f32 v92, v92, v173
    v_sub_f32 v93, v93, v173
    v_sub_f32 v94, v94, v173
    v_sub_f32 v95, v95, v173
    v_sub_f32 v104, v104, v173
    v_sub_f32 v105, v105, v173
    v_sub_f32 v106, v106, v173
    v_sub_f32 v107, v107, v173
    v_sub_f32 v116, v116, v173
    v_sub_f32 v117, v117, v173
    v_sub_f32 v118, v118, v173
    v_sub_f32 v119, v119, v173
    v_sub_f32 v128, v128, v173
    v_sub_f32 v129, v129, v173
    v_sub_f32 v130, v130, v173
    v_sub_f32 v131, v131, v173
    v_mov_b32 v176, v174
    s_nop 1
    v_permlane32_swap_b32 v174, v176
    s_nop 1
    v_max_f32 v174, v174, v176
    v_mov_b32 v176, v174
    s_nop 1
    v_permlane16_swap_b32 v174, v176
    s_nop 1
    v_max_f32 v174, v174, v176
    v_max_f32 v174, 0, v174
    v_sub_f32 v168, v168, v174
    v_sub_f32 v169, v169, v174
    v_sub_f32 v170, v170, v174
    v_sub_f32 v171, v171, v174
    v_sub_f32 v96, v96, v174
    v_sub_f32 v97, v97, v174
    v_sub_f32 v98, v98, v174
    v_sub_f32 v99, v99, v174
    v_sub_f32 v108, v108, v174
    v_sub_f32 v109, v109, v174
    v_sub_f32 v110, v110, v174
    v_sub_f32 v111, v111, v174
    v_sub_f32 v120, v120, v174
    v_sub_f32 v121, v121, v174
    v_sub_f32 v122, v122, v174
    v_sub_f32 v123, v123, v174
    v_sub_f32 v132, v132, v174
    v_sub_f32 v133, v133, v174
    v_sub_f32 v134, v134, v174
    v_sub_f32 v135, v135, v174
    v_sub_f32 v172, 0, v172
    v_exp_f32 v172, v172
    v_accvgpr_read_b32 v176, a0
    v_mul_f32 v176, v176, v172
    v_accvgpr_write_b32 a0, v176
    v_accvgpr_read_b32 v177, a1
    v_mul_f32 v177, v177, v172
    v_accvgpr_write_b32 a1, v177
    v_accvgpr_read_b32 v178, a2
    v_mul_f32 v178, v178, v172
    v_accvgpr_write_b32 a2, v178
    v_accvgpr_read_b32 v179, a3
    v_mul_f32 v179, v179, v172
    v_accvgpr_write_b32 a3, v179
    v_accvgpr_read_b32 v176, a12
    v_mul_f32 v176, v176, v172
    v_accvgpr_write_b32 a12, v176
    v_accvgpr_read_b32 v177, a13
    v_mul_f32 v177, v177, v172
    v_accvgpr_write_b32 a13, v177
    v_accvgpr_read_b32 v178, a14
    v_mul_f32 v178, v178, v172
    v_accvgpr_write_b32 a14, v178
    v_accvgpr_read_b32 v179, a15
    v_mul_f32 v179, v179, v172
    v_accvgpr_write_b32 a15, v179
    v_accvgpr_read_b32 v176, a24
    v_mul_f32 v176, v176, v172
    v_accvgpr_write_b32 a24, v176
    v_accvgpr_read_b32 v177, a25
    v_mul_f32 v177, v177, v172
    v_accvgpr_write_b32 a25, v177
    v_accvgpr_read_b32 v178, a26
    v_mul_f32 v178, v178, v172
    v_accvgpr_write_b32 a26, v178
    v_accvgpr_read_b32 v179, a27
    v_mul_f32 v179, v179, v172
    v_accvgpr_write_b32 a27, v179
    v_accvgpr_read_b32 v176, a36
    v_mul_f32 v176, v176, v172
    v_accvgpr_write_b32 a36, v176
    v_accvgpr_read_b32 v177, a37
    v_mul_f32 v177, v177, v172
    v_accvgpr_write_b32 a37, v177
    v_accvgpr_read_b32 v178, a38
    v_mul_f32 v178, v178, v172
    v_accvgpr_write_b32 a38, v178
    v_accvgpr_read_b32 v179, a39
    v_mul_f32 v179, v179, v172
    v_accvgpr_write_b32 a39, v179
    v_accvgpr_read_b32 v176, a48
    v_mul_f32 v176, v176, v172
    v_accvgpr_write_b32 a48, v176
    v_accvgpr_read_b32 v177, a49
    v_mul_f32 v177, v177, v172
    v_accvgpr_write_b32 a49, v177
    v_accvgpr_read_b32 v178, a50
    v_mul_f32 v178, v178, v172
    v_accvgpr_write_b32 a50, v178
    v_accvgpr_read_b32 v179, a51
    v_mul_f32 v179, v179, v172
    v_accvgpr_write_b32 a51, v179
    v_accvgpr_read_b32 v176, a60
    v_mul_f32 v176, v176, v172
    v_accvgpr_write_b32 a60, v176
    v_accvgpr_read_b32 v177, a61
    v_mul_f32 v177, v177, v172
    v_accvgpr_write_b32 a61, v177
    v_accvgpr_read_b32 v178, a62
    v_mul_f32 v178, v178, v172
    v_accvgpr_write_b32 a62, v178
    v_accvgpr_read_b32 v179, a63
    v_mul_f32 v179, v179, v172
    v_accvgpr_write_b32 a63, v179
    v_accvgpr_read_b32 v176, a72
    v_mul_f32 v176, v176, v172
    v_accvgpr_write_b32 a72, v176
    v_accvgpr_read_b32 v177, a73
    v_mul_f32 v177, v177, v172
    v_accvgpr_write_b32 a73, v177
    v_accvgpr_read_b32 v178, a74
    v_mul_f32 v178, v178, v172
    v_accvgpr_write_b32 a74, v178
    v_accvgpr_read_b32 v179, a75
    v_mul_f32 v179, v179, v172
    v_accvgpr_write_b32 a75, v179
    v_accvgpr_read_b32 v176, a84
    v_mul_f32 v176, v176, v172
    v_accvgpr_write_b32 a84, v176
    v_accvgpr_read_b32 v177, a85
    v_mul_f32 v177, v177, v172
    v_accvgpr_write_b32 a85, v177
    v_accvgpr_read_b32 v178, a86
    v_mul_f32 v178, v178, v172
    v_accvgpr_write_b32 a86, v178
    v_accvgpr_read_b32 v179, a87
    v_mul_f32 v179, v179, v172
    v_accvgpr_write_b32 a87, v179
    v_accvgpr_read_b32 v176, a96
    v_mul_f32 v176, v176, v172
    v_accvgpr_write_b32 a96, v176
    v_accvgpr_read_b32 v177, a97
    v_mul_f32 v177, v177, v172
    v_accvgpr_write_b32 a97, v177
    v_accvgpr_read_b32 v178, a98
    v_mul_f32 v178, v178, v172
    v_accvgpr_write_b32 a98, v178
    v_accvgpr_read_b32 v179, a99
    v_mul_f32 v179, v179, v172
    v_accvgpr_write_b32 a99, v179
    v_accvgpr_read_b32 v176, a108
    v_mul_f32 v176, v176, v172
    v_accvgpr_write_b32 a108, v176
    v_accvgpr_read_b32 v177, a109
    v_mul_f32 v177, v177, v172
    v_accvgpr_write_b32 a109, v177
    v_accvgpr_read_b32 v178, a110
    v_mul_f32 v178, v178, v172
    v_accvgpr_write_b32 a110, v178
    v_accvgpr_read_b32 v179, a111
    v_mul_f32 v179, v179, v172
    v_accvgpr_write_b32 a111, v179
    v_accvgpr_read_b32 v176, a120
    v_mul_f32 v176, v176, v172
    v_accvgpr_write_b32 a120, v176
    v_accvgpr_read_b32 v177, a121
    v_mul_f32 v177, v177, v172
    v_accvgpr_write_b32 a121, v177
    v_accvgpr_read_b32 v178, a122
    v_mul_f32 v178, v178, v172
    v_accvgpr_write_b32 a122, v178
    v_accvgpr_read_b32 v179, a123
    v_mul_f32 v179, v179, v172
    v_accvgpr_write_b32 a123, v179
    v_accvgpr_read_b32 v176, a132
    v_mul_f32 v176, v176, v172
    v_accvgpr_write_b32 a132, v176
    v_accvgpr_read_b32 v177, a133
    v_mul_f32 v177, v177, v172
    v_accvgpr_write_b32 a133, v177
    v_accvgpr_read_b32 v178, a134
    v_mul_f32 v178, v178, v172
    v_accvgpr_write_b32 a134, v178
    v_accvgpr_read_b32 v179, a135
    v_mul_f32 v179, v179, v172
    v_accvgpr_write_b32 a135, v179
    v_accvgpr_read_b32 v176, a144
    v_mul_f32 v176, v176, v172
    v_accvgpr_write_b32 a144, v176
    v_accvgpr_read_b32 v177, a145
    v_mul_f32 v177, v177, v172
    v_accvgpr_write_b32 a145, v177
    v_accvgpr_read_b32 v178, a146
    v_mul_f32 v178, v178, v172
    v_accvgpr_write_b32 a146, v178
    v_accvgpr_read_b32 v179, a147
    v_mul_f32 v179, v179, v172
    v_accvgpr_write_b32 a147, v179
    v_sub_f32 v173, 0, v173
    v_exp_f32 v173, v173
    v_accvgpr_read_b32 v176, a4
    v_mul_f32 v176, v176, v173
    v_accvgpr_write_b32 a4, v176
    v_accvgpr_read_b32 v177, a5
    v_mul_f32 v177, v177, v173
    v_accvgpr_write_b32 a5, v177
    v_accvgpr_read_b32 v178, a6
    v_mul_f32 v178, v178, v173
    v_accvgpr_write_b32 a6, v178
    v_accvgpr_read_b32 v179, a7
    v_mul_f32 v179, v179, v173
    v_accvgpr_write_b32 a7, v179
    v_accvgpr_read_b32 v176, a16
    v_mul_f32 v176, v176, v173
    v_accvgpr_write_b32 a16, v176
    v_accvgpr_read_b32 v177, a17
    v_mul_f32 v177, v177, v173
    v_accvgpr_write_b32 a17, v177
    v_accvgpr_read_b32 v178, a18
    v_mul_f32 v178, v178, v173
    v_accvgpr_write_b32 a18, v178
    v_accvgpr_read_b32 v179, a19
    v_mul_f32 v179, v179, v173
    v_accvgpr_write_b32 a19, v179
    v_accvgpr_read_b32 v176, a28
    v_mul_f32 v176, v176, v173
    v_accvgpr_write_b32 a28, v176
    v_accvgpr_read_b32 v177, a29
    v_mul_f32 v177, v177, v173
    v_accvgpr_write_b32 a29, v177
    v_accvgpr_read_b32 v178, a30
    v_mul_f32 v178, v178, v173
    v_accvgpr_write_b32 a30, v178
    v_accvgpr_read_b32 v179, a31
    v_mul_f32 v179, v179, v173
    v_accvgpr_write_b32 a31, v179
    v_accvgpr_read_b32 v176, a40
    v_mul_f32 v176, v176, v173
    v_accvgpr_write_b32 a40, v176
    v_accvgpr_read_b32 v177, a41
    v_mul_f32 v177, v177, v173
    v_accvgpr_write_b32 a41, v177
    v_accvgpr_read_b32 v178, a42
    v_mul_f32 v178, v178, v173
    v_accvgpr_write_b32 a42, v178
    v_accvgpr_read_b32 v179, a43
    v_mul_f32 v179, v179, v173
    v_accvgpr_write_b32 a43, v179
    v_accvgpr_read_b32 v176, a52
    v_mul_f32 v176, v176, v173
    v_accvgpr_write_b32 a52, v176
    v_accvgpr_read_b32 v177, a53
    v_mul_f32 v177, v177, v173
    v_accvgpr_write_b32 a53, v177
    v_accvgpr_read_b32 v178, a54
    v_mul_f32 v178, v178, v173
    v_accvgpr_write_b32 a54, v178
    v_accvgpr_read_b32 v179, a55
    v_mul_f32 v179, v179, v173
    v_accvgpr_write_b32 a55, v179
    v_accvgpr_read_b32 v176, a64
    v_mul_f32 v176, v176, v173
    v_accvgpr_write_b32 a64, v176
    v_accvgpr_read_b32 v177, a65
    v_mul_f32 v177, v177, v173
    v_accvgpr_write_b32 a65, v177
    v_accvgpr_read_b32 v178, a66
    v_mul_f32 v178, v178, v173
    v_accvgpr_write_b32 a66, v178
    v_accvgpr_read_b32 v179, a67
    v_mul_f32 v179, v179, v173
    v_accvgpr_write_b32 a67, v179
    v_accvgpr_read_b32 v176, a76
    v_mul_f32 v176, v176, v173
    v_accvgpr_write_b32 a76, v176
    v_accvgpr_read_b32 v177, a77
    v_mul_f32 v177, v177, v173
    v_accvgpr_write_b32 a77, v177
    v_accvgpr_read_b32 v178, a78
    v_mul_f32 v178, v178, v173
    v_accvgpr_write_b32 a78, v178
    v_accvgpr_read_b32 v179, a79
    v_mul_f32 v179, v179, v173
    v_accvgpr_write_b32 a79, v179
    v_accvgpr_read_b32 v176, a88
    v_mul_f32 v176, v176, v173
    v_accvgpr_write_b32 a88, v176
    v_accvgpr_read_b32 v177, a89
    v_mul_f32 v177, v177, v173
    v_accvgpr_write_b32 a89, v177
    v_accvgpr_read_b32 v178, a90
    v_mul_f32 v178, v178, v173
    v_accvgpr_write_b32 a90, v178
    v_accvgpr_read_b32 v179, a91
    v_mul_f32 v179, v179, v173
    v_accvgpr_write_b32 a91, v179
    v_accvgpr_read_b32 v176, a100
    v_mul_f32 v176, v176, v173
    v_accvgpr_write_b32 a100, v176
    v_accvgpr_read_b32 v177, a101
    v_mul_f32 v177, v177, v173
    v_accvgpr_write_b32 a101, v177
    v_accvgpr_read_b32 v178, a102
    v_mul_f32 v178, v178, v173
    v_accvgpr_write_b32 a102, v178
    v_accvgpr_read_b32 v179, a103
    v_mul_f32 v179, v179, v173
    v_accvgpr_write_b32 a103, v179
    v_accvgpr_read_b32 v176, a112
    v_mul_f32 v176, v176, v173
    v_accvgpr_write_b32 a112, v176
    v_accvgpr_read_b32 v177, a113
    v_mul_f32 v177, v177, v173
    v_accvgpr_write_b32 a113, v177
    v_accvgpr_read_b32 v178, a114
    v_mul_f32 v178, v178, v173
    v_accvgpr_write_b32 a114, v178
    v_accvgpr_read_b32 v179, a115
    v_mul_f32 v179, v179, v173
    v_accvgpr_write_b32 a115, v179
    v_accvgpr_read_b32 v176, a124
    v_mul_f32 v176, v176, v173
    v_accvgpr_write_b32 a124, v176
    v_accvgpr_read_b32 v177, a125
    v_mul_f32 v177, v177, v173
    v_accvgpr_write_b32 a125, v177
    v_accvgpr_read_b32 v178, a126
    v_mul_f32 v178, v178, v173
    v_accvgpr_write_b32 a126, v178
    v_accvgpr_read_b32 v179, a127
    v_mul_f32 v179, v179, v173
    v_accvgpr_write_b32 a127, v179
    v_accvgpr_read_b32 v176, a136
    v_mul_f32 v176, v176, v173
    v_accvgpr_write_b32 a136, v176
    v_accvgpr_read_b32 v177, a137
    v_mul_f32 v177, v177, v173
    v_accvgpr_write_b32 a137, v177
    v_accvgpr_read_b32 v178, a138
    v_mul_f32 v178, v178, v173
    v_accvgpr_write_b32 a138, v178
    v_accvgpr_read_b32 v179, a139
    v_mul_f32 v179, v179, v173
    v_accvgpr_write_b32 a139, v179
    v_accvgpr_read_b32 v176, a148
    v_mul_f32 v176, v176, v173
    v_accvgpr_write_b32 a148, v176
    v_accvgpr_read_b32 v177, a149
    v_mul_f32 v177, v177, v173
    v_accvgpr_write_b32 a149, v177
    v_accvgpr_read_b32 v178, a150
    v_mul_f32 v178, v178, v173
    v_accvgpr_write_b32 a150, v178
    v_accvgpr_read_b32 v179, a151
    v_mul_f32 v179, v179, v173
    v_accvgpr_write_b32 a151, v179
    v_sub_f32 v174, 0, v174
    v_exp_f32 v174, v174
    v_accvgpr_read_b32 v176, a8
    v_mul_f32 v176, v176, v174
    v_accvgpr_write_b32 a8, v176
    v_accvgpr_read_b32 v177, a9
    v_mul_f32 v177, v177, v174
    v_accvgpr_write_b32 a9, v177
    v_accvgpr_read_b32 v178, a10
    v_mul_f32 v178, v178, v174
    v_accvgpr_write_b32 a10, v178
    v_accvgpr_read_b32 v179, a11
    v_mul_f32 v179, v179, v174
    v_accvgpr_write_b32 a11, v179
    v_accvgpr_read_b32 v176, a20
    v_mul_f32 v176, v176, v174
    v_accvgpr_write_b32 a20, v176
    v_accvgpr_read_b32 v177, a21
    v_mul_f32 v177, v177, v174
    v_accvgpr_write_b32 a21, v177
    v_accvgpr_read_b32 v178, a22
    v_mul_f32 v178, v178, v174
    v_accvgpr_write_b32 a22, v178
    v_accvgpr_read_b32 v179, a23
    v_mul_f32 v179, v179, v174
    v_accvgpr_write_b32 a23, v179
    v_accvgpr_read_b32 v176, a32
    v_mul_f32 v176, v176, v174
    v_accvgpr_write_b32 a32, v176
    v_accvgpr_read_b32 v177, a33
    v_mul_f32 v177, v177, v174
    v_accvgpr_write_b32 a33, v177
    v_accvgpr_read_b32 v178, a34
    v_mul_f32 v178, v178, v174
    v_accvgpr_write_b32 a34, v178
    v_accvgpr_read_b32 v179, a35
    v_mul_f32 v179, v179, v174
    v_accvgpr_write_b32 a35, v179
    v_accvgpr_read_b32 v176, a44
    v_mul_f32 v176, v176, v174
    v_accvgpr_write_b32 a44, v176
    v_accvgpr_read_b32 v177, a45
    v_mul_f32 v177, v177, v174
    v_accvgpr_write_b32 a45, v177
    v_accvgpr_read_b32 v178, a46
    v_mul_f32 v178, v178, v174
    v_accvgpr_write_b32 a46, v178
    v_accvgpr_read_b32 v179, a47
    v_mul_f32 v179, v179, v174
    v_accvgpr_write_b32 a47, v179
    v_accvgpr_read_b32 v176, a56
    v_mul_f32 v176, v176, v174
    v_accvgpr_write_b32 a56, v176
    v_accvgpr_read_b32 v177, a57
    v_mul_f32 v177, v177, v174
    v_accvgpr_write_b32 a57, v177
    v_accvgpr_read_b32 v178, a58
    v_mul_f32 v178, v178, v174
    v_accvgpr_write_b32 a58, v178
    v_accvgpr_read_b32 v179, a59
    v_mul_f32 v179, v179, v174
    v_accvgpr_write_b32 a59, v179
    v_accvgpr_read_b32 v176, a68
    v_mul_f32 v176, v176, v174
    v_accvgpr_write_b32 a68, v176
    v_accvgpr_read_b32 v177, a69
    v_mul_f32 v177, v177, v174
    v_accvgpr_write_b32 a69, v177
    v_accvgpr_read_b32 v178, a70
    v_mul_f32 v178, v178, v174
    v_accvgpr_write_b32 a70, v178
    v_accvgpr_read_b32 v179, a71
    v_mul_f32 v179, v179, v174
    v_accvgpr_write_b32 a71, v179
    v_accvgpr_read_b32 v176, a80
    v_mul_f32 v176, v176, v174
    v_accvgpr_write_b32 a80, v176
    v_accvgpr_read_b32 v177, a81
    v_mul_f32 v177, v177, v174
    v_accvgpr_write_b32 a81, v177
    v_accvgpr_read_b32 v178, a82
    v_mul_f32 v178, v178, v174
    v_accvgpr_write_b32 a82, v178
    v_accvgpr_read_b32 v179, a83
    v_mul_f32 v179, v179, v174
    v_accvgpr_write_b32 a83, v179
    v_accvgpr_read_b32 v176, a92
    v_mul_f32 v176, v176, v174
    v_accvgpr_write_b32 a92, v176
    v_accvgpr_read_b32 v177, a93
    v_mul_f32 v177, v177, v174
    v_accvgpr_write_b32 a93, v177
    v_accvgpr_read_b32 v178, a94
    v_mul_f32 v178, v178, v174
    v_accvgpr_write_b32 a94, v178
    v_accvgpr_read_b32 v179, a95
    v_mul_f32 v179, v179, v174
    v_accvgpr_write_b32 a95, v179
    v_accvgpr_read_b32 v176, a104
    v_mul_f32 v176, v176, v174
    v_accvgpr_write_b32 a104, v176
    v_accvgpr_read_b32 v177, a105
    v_mul_f32 v177, v177, v174
    v_accvgpr_write_b32 a105, v177
    v_accvgpr_read_b32 v178, a106
    v_mul_f32 v178, v178, v174
    v_accvgpr_write_b32 a106, v178
    v_accvgpr_read_b32 v179, a107
    v_mul_f32 v179, v179, v174
    v_accvgpr_write_b32 a107, v179
    v_accvgpr_read_b32 v176, a116
    v_mul_f32 v176, v176, v174
    v_accvgpr_write_b32 a116, v176
    v_accvgpr_read_b32 v177, a117
    v_mul_f32 v177, v177, v174
    v_accvgpr_write_b32 a117, v177
    v_accvgpr_read_b32 v178, a118
    v_mul_f32 v178, v178, v174
    v_accvgpr_write_b32 a118, v178
    v_accvgpr_read_b32 v179, a119
    v_mul_f32 v179, v179, v174
    v_accvgpr_write_b32 a119, v179
    v_accvgpr_read_b32 v176, a128
    v_mul_f32 v176, v176, v174
    v_accvgpr_write_b32 a128, v176
    v_accvgpr_read_b32 v177, a129
    v_mul_f32 v177, v177, v174
    v_accvgpr_write_b32 a129, v177
    v_accvgpr_read_b32 v178, a130
    v_mul_f32 v178, v178, v174
    v_accvgpr_write_b32 a130, v178
    v_accvgpr_read_b32 v179, a131
    v_mul_f32 v179, v179, v174
    v_accvgpr_write_b32 a131, v179
    v_accvgpr_read_b32 v176, a140
    v_mul_f32 v176, v176, v174
    v_accvgpr_write_b32 a140, v176
    v_accvgpr_read_b32 v177, a141
    v_mul_f32 v177, v177, v174
    v_accvgpr_write_b32 a141, v177
    v_accvgpr_read_b32 v178, a142
    v_mul_f32 v178, v178, v174
    v_accvgpr_write_b32 a142, v178
    v_accvgpr_read_b32 v179, a143
    v_mul_f32 v179, v179, v174
    v_accvgpr_write_b32 a143, v179
    v_accvgpr_read_b32 v176, a152
    v_mul_f32 v176, v176, v174
    v_accvgpr_write_b32 a152, v176
    v_accvgpr_read_b32 v177, a153
    v_mul_f32 v177, v177, v174
    v_accvgpr_write_b32 a153, v177
    v_accvgpr_read_b32 v178, a154
    v_mul_f32 v178, v178, v174
    v_accvgpr_write_b32 a154, v178
    v_accvgpr_read_b32 v179, a155
    v_mul_f32 v179, v179, v174
    v_accvgpr_write_b32 a155, v179
L_rret1:
    s_nop 3
    s_setpc_b64 s[66:67]
.p2align 8
.fill 2048, 4, 0xbf810000
.section .rodata,"a"
.p2align 6
.amdhsa_kernel standalone__gqa_block_cached__near_ridge_kernel
  .amdhsa_next_free_vgpr 512
  .amdhsa_next_free_sgpr 102
  .amdhsa_accum_offset 256
  .amdhsa_group_segment_fixed_size 0
  .amdhsa_kernarg_size 64
  .amdhsa_user_sgpr_count 2
  .amdhsa_user_sgpr_kernarg_segment_ptr 1
  .amdhsa_system_sgpr_workgroup_id_x 1
.end_amdhsa_kernel
```
